```python
import torch

def _softmax(x, axis=-1):
    return torch.softmax(x, dim=axis)
def _gelu(x):
    return torch.nn.functional.gelu(x, approximate="tanh")
def _silu(x):
    return torch.nn.functional.silu(x)
def _sigmoid(x):
    return torch.sigmoid(x)
def _layernorm(x, axis=-1, eps=1e-5):
    m = x.mean(dim=axis, keepdim=True)
    v = x.var(dim=axis, keepdim=True, unbiased=False)
    return (x - m) / torch.sqrt(v + eps)
def _scatter_add(tgt, idx, src, axis=0):
    return tgt.clone().index_add_(axis, idx, src)
def _segment_sum(src, seg, n):
    out = torch.zeros((n,) + src.shape[1:], dtype=src.dtype)
    return out.index_add_(0, seg, src)
def _pad(x, pw):
    flat = tuple(v for pair in reversed(pw) for v in pair)
    return torch.nn.functional.pad(x, flat)

kernel_name = 'parallel_sum__sliding_block__dense_activation_gelu__prompt'

def setup_inputs():

    _w = (lambda a: (lambda t: t.to(torch.bfloat16) if t.is_floating_point() else t)(torch.as_tensor(a)))
    def _A_setup():
        B, S, D = 1, 2048, 576
        return {
            "x": _w((lambda *s: torch.randn(*s, dtype=torch.bfloat16) * 0.05)(B, S, D)),
            "wqkv": _w((lambda *s: torch.randn(*s, dtype=torch.bfloat16) * 0.05)(D, 3 * D)),
            "wo": _w((lambda *s: torch.randn(*s, dtype=torch.bfloat16) * 0.05)(D, D)),
        }
    _A_in = _A_setup()

    def _B_setup():
        B, S, D, F = 1, 2048, 576, 4608
        return {
            "x": _w((lambda *s: torch.randn(*s, dtype=torch.bfloat16) * 0.05)(B, S, D)),
            "w1": _w((lambda *s: torch.randn(*s, dtype=torch.bfloat16) * 0.8)(D, F) * (D ** -0.5)),
            "b1": _w((lambda *s: torch.randn(*s, dtype=torch.bfloat16) * 0.8)(F) * 0.01),
            "w2": _w((lambda *s: torch.randn(*s, dtype=torch.bfloat16) * 0.8)(F, D) * (F ** -0.5)),
            "b2": _w((lambda *s: torch.randn(*s, dtype=torch.bfloat16) * 0.8)(D) * 0.01),
        }
    _B_in = _B_setup()

    return {
        "A_x": _A_in["x"],
        "A_wqkv": _A_in["wqkv"],
        "A_wo": _A_in["wo"],
        "B_x": _B_in["x"],
        "B_w1": _B_in["w1"],
        "B_b1": _B_in["b1"],
        "B_w2": _B_in["w2"],
        "B_b2": _B_in["b2"],
    }

def reference(A_x, A_wqkv, A_wo, B_x, B_w1, B_b1, B_w2, B_b2):
    def _A_ref(x, wqkv, wo):
        B, S, D = x.shape
        H = 32; Dh = D // H; W = 256
        qkv = (lambda x, *d: x.permute(*d))((x @ wqkv).reshape(B, S, 3, H, Dh), 2, 0, 3, 1, 4)
        q, k, v = qkv[0], qkv[1], qkv[2]
        scores = torch.einsum("bhqd,bhkd->bhqk", q, k) * (Dh ** -0.5)
        idx = torch.arange(S)
        mask = (idx[:, None] - idx[None, :] >= 0) & (idx[:, None] - idx[None, :] < W)
        scores = torch.where(mask[None, None], scores, -1e9)
        p = _softmax(scores, axis=-1)
        o = torch.einsum("bhqk,bhkd->bhqd", p, v)
        return (lambda x, *d: x.permute(*d))(o, 0, 2, 1, 3).reshape(B, S, D) @ wo

    def _B_ref(x, w1, b1, w2, b2):
        h = torch.einsum("bsd,df->bsf", x, w1) + b1
        h = _gelu(h)
        return torch.einsum("bsf,fd->bsd", h, w2) + b2

    x = A_x
    xn = _layernorm(x, axis=-1)
    return x + _A_ref(xn, A_wqkv, A_wo) + _B_ref(xn, B_w1, B_b1, B_w2, B_b2)
```

```asm
; @launch grid=(256,1,1) block=(512,1,1) lds=163840
.amdgcn_target "amdgcn-amd-amdhsa--gfx950"
.text
.globl parallel_sum__sliding_block__dense_activation_gelu__prompt_kernel
.p2align 8
.type parallel_sum__sliding_block__dense_activation_gelu__prompt_kernel,@function
parallel_sum__sliding_block__dense_activation_gelu__prompt_kernel:
s_cmp_ge_u32 s2, 256
s_cbranch_scc1 L_main_end
s_load_dwordx16 s[4:19], s[0:1], 0
s_load_dwordx4 s[20:23], s[0:1], 64
s_load_dwordx2 s[24:25], s[0:1], 80
s_memrealtime s[96:97]
v_and_b32 v1, 63, v0
v_lshrrev_b32 v248, 6, v0
v_and_b32 v2, 31, v0
v_readfirstlane_b32 s68, v248
v_bfe_u32 v3, v0, 5, 1
v_lshlrev_b32 v9, 4, v1
v_lshlrev_b32 v10, 4, v2
s_and_b32 s71, s2, 3
s_lshl_b32 s71, s71, 1
s_bfe_u32 s81, s2, 0x10003
s_add_u32 s71, s71, s81
s_lshr_b32 s72, s2, 4
s_bfe_u32 s81, s2, 0x10002
s_lshl_b32 s81, s81, 4
s_add_u32 s72, s72, s81
s_and_b32 s69, s68, 3
s_lshr_b32 s70, s68, 2
v_lshrrev_b32 v248, 3, v1
v_mul_u32_u24 v248, 1152, v248
v_and_b32 v249, 7, v1
v_lshl_add_u32 v248, v249, 4, v248
s_lshl_b32 s81, s72, 3
s_add_u32 s81, s81, s68
s_mul_i32 s81, s81, 9216
s_waitcnt lgkmcnt(0)
s_mov_b32 s28, s4
s_and_b32 s29, s5, 0xffff
s_mov_b32 s30, 2359296
s_mov_b32 s31, 0x20000
buffer_load_dwordx4 v[16:19], v248, s[28:31], s81 offen offset:0
buffer_load_dwordx4 v[20:23], v248, s[28:31], s81 offen offset:128
buffer_load_dwordx4 v[24:27], v248, s[28:31], s81 offen offset:256
buffer_load_dwordx4 v[28:31], v248, s[28:31], s81 offen offset:384
buffer_load_dwordx4 v[32:35], v248, s[28:31], s81 offen offset:512
buffer_load_dwordx4 v[36:39], v248, s[28:31], s81 offen offset:640
buffer_load_dwordx4 v[40:43], v248, s[28:31], s81 offen offset:768
buffer_load_dwordx4 v[44:47], v248, s[28:31], s81 offen offset:896
buffer_load_dwordx4 v[48:51], v248, s[28:31], s81 offen offset:1024
s_mov_b32 s60, s22
s_and_b32 s61, s23, 0xffff
s_mov_b32 s62, 256
s_mov_b32 s63, 0x20000
s_or_b32 s96, s96, 1
v_mov_b32 v252, s96
s_or_b32 s82, s68, s2
s_cselect_b32 s82, 0x1000, 0
v_mov_b32 v253, s82
s_mov_b64 exec, 1
buffer_store_dword v252, v253, s[60:63], 0 offen sc1
s_mov_b64 exec, -1
s_getpc_b64 s[40:41]
L_pc:
s_and_b32 s41, s41, 0xffff
s_mov_b32 s42, L_code_end - L_pc
s_mov_b32 s43, 0x20000
s_bfe_u32 s82, s2, 0x30003
s_lshl_b32 s82, s82, 13
s_cmp_eq_u32 s68, 7
s_cselect_b32 s82, s82, 0x100000
v_lshlrev_b32 v252, 7, v1
buffer_load_dword v162, v252, s[40:43], s82 offen
s_mov_b32 s44, s14
s_and_b32 s45, s15, 0xffff
s_mov_b32 s46, 9216
s_mov_b32 s47, 0x20000
v_lshlrev_b32 v250, 2, v0
s_mul_i32 s81, s71, 1152
buffer_load_dword v246, v250, s[44:47], s81 offen
s_mov_b32 s32, s6
s_and_b32 s33, s7, 0xffff
s_mov_b32 s34, 1990656
s_mov_b32 s35, 0x20000
s_mov_b32 s48, s8
s_and_b32 s49, s9, 0xffff
s_mov_b32 s50, 663552
s_mov_b32 s51, 0x20000
s_mov_b32 s36, s12
s_and_b32 s37, s13, 0xffff
s_mov_b32 s38, 5308416
s_mov_b32 s39, 0x20000
s_mov_b32 s52, s16
s_and_b32 s53, s17, 0xffff
s_mov_b32 s54, 5308416
s_mov_b32 s55, 0x20000
s_mov_b32 s56, s24
s_and_b32 s57, s25, 0xffff
s_mov_b32 s58, 268435456
s_mov_b32 s59, 0x20000
s_mov_b32 s64, s20
s_and_b32 s65, s21, 0xffff
s_mov_b32 s66, 2359296
s_mov_b32 s67, 0x20000
s_mov_b32 s16, s18
s_and_b32 s17, s19, 0xffff
s_mov_b32 s18, 1152
s_mov_b32 s19, 0x20000
s_mul_i32 s81, s71, 294912
s_add_u32 s40, s24, s81
s_addc_u32 s41, s25, 0
s_and_b32 s41, s41, 0xffff
s_mov_b32 s42, 8388608
s_mov_b32 s43, 0x20000
v_bfe_u32 v248, v1, 2, 2
v_lshlrev_b32 v4, 6, v248
v_bfe_u32 v249, v1, 4, 1
v_lshl_add_u32 v4, v249, 5, v4
v_and_b32 v252, 3, v1
v_lshl_add_u32 v4, v252, 3, v4
v_mul_u32_u24 v248, 3456, v248
v_lshrrev_b32 v249, 4, v1
v_lshl_add_u32 v249, v249, 2, v252
v_lshl_add_u32 v248, v249, 4, v248
v_cmp_lt_u32 vcc, 8, v249
v_mov_b32 v252, 1008
v_mov_b32 v253, 1216
v_cndmask_b32 v252, 0, v252, vcc
v_add_u32 v7, v248, v252
v_cmp_lt_u32 vcc, 3, v249
v_mov_b32 v252, 240
s_mul_i32 s93, s71, 16384
s_add_u32 s93, s93, 4194304
v_cndmask_b32 v252, v252, v253, vcc
v_add_u32 v8, v248, v252
s_mov_b32 vcc_lo, 4294914867
s_mov_b32 vcc_hi, 286392319
v_mov_b32 v252, 0x40000000
v_cndmask_b32 v8, v252, v8, vcc
s_and_b32 s87, s69, 1
s_xor_b32 s87, s87, s70
s_lshl_b32 s82, s87, 2
s_add_u32 s82, s82, s69
s_lshl_b32 s89, s82, 11
s_lshl_b32 s13, s69, 11
s_mul_i32 s90, s70, 36864
s_add_u32 s90, s90, 81920
s_mul_i32 s73, s82, 13824
s_mul_i32 s81, s71, 144
s_add_u32 s73, s73, s81
s_and_b32 s21, s72, 15
s_mul_i32 s81, s72, 57
s_lshr_b32 s81, s81, 9
s_mul_i32 s81, s81, 9
s_sub_u32 s81, s72, s81
s_lshl_b32 s4, s81, 7
s_add_u32 s5, s4, 128
s_cmp_eq_u32 s5, 1152
s_cselect_b32 s5, 0, s5
s_add_u32 s6, s5, 128
s_cmp_eq_u32 s6, 1152
s_cselect_b32 s6, 0, s6
s_add_u32 s7, s6, 128
s_cmp_eq_u32 s7, 1152
s_cselect_b32 s7, 0, s7
s_add_u32 s8, s7, 128
s_cmp_eq_u32 s8, 1152
s_cselect_b32 s8, 0, s8
s_add_u32 s9, s8, 128
s_cmp_eq_u32 s9, 1152
s_cselect_b32 s9, 0, s9
s_add_u32 s10, s9, 128
s_cmp_eq_u32 s10, 1152
s_cselect_b32 s10, 0, s10
s_add_u32 s11, s10, 128
s_cmp_eq_u32 s11, 1152
s_cselect_b32 s11, 0, s11
s_add_u32 s12, s11, 128
s_cmp_eq_u32 s12, 1152
s_cselect_b32 s12, 0, s12
s_lshl_b32 s20, s12, 5
s_add_u32 s20, s20, s90
s_mul_i32 s82, s69, 147456
s_mul_i32 s81, s71, 1152
s_add_u32 s74, s82, s81
s_mul_i32 s82, s87, 589824
s_add_u32 s75, s74, s82
s_mul_i32 s82, s69, 18432
s_mul_i32 s81, s71, 663552
s_add_u32 s76, s82, s81
s_mul_i32 s82, s87, 73728
s_add_u32 s77, s76, s82
s_mul_i32 s82, s71, 72
s_mul_i32 s81, s69, 18
s_add_u32 s81, s81, s82
s_mul_i32 s78, s81, 1152
s_add_u32 s82, s76, 589824
s_cmp_lg_u32 s87, 0
s_cselect_b32 s79, s78, s82
s_cselect_b64 s[60:61], s[48:49], s[52:53]
s_cselect_b32 s62, s50, s54
s_mov_b32 s63, 0x20000
s_lshl_b32 s81, s71, 5
s_add_u32 s81, s81, s72
s_mul_i32 s86, s81, 73728
s_lshl_b32 s81, s70, 11
s_add_u32 s86, s86, s81
s_lshr_b32 s81, s69, 1
s_lshl_b32 s81, s81, 12
s_add_u32 s86, s86, s81
s_add_u32 s86, s86, 16777216
s_lshl_b32 s82, s72, 1
s_sub_u32 s82, s82, 8
s_mul_i32 s82, s82, 4608
s_add_u32 s82, s82, s13
v_add_u32 v14, s82, v9
s_mov_b32 s88, 0x3eae1a93
v_mov_b32 v11, 0xbdd2d3e8
s_mul_i32 s81, s68, 27
v_add_u32 v248, s81, v1
v_mul_u32_u24 v249, 171, v248
v_lshrrev_b32 v249, 10, v249
v_mul_u32_u24 v252, 6, v249
v_sub_u32 v252, v248, v252
v_mul_u32_u24 v249, 3456, v249
v_lshrrev_b32 v253, 1, v252
v_mul_u32_u24 v253, 1152, v253
v_and_b32 v252, 1, v252
v_mul_u32_u24 v252, 140, v252
v_add3_u32 v249, v249, v252, v253
s_mul_i32 s81, s21, 124416
s_mul_i32 s82, s71, 144
s_add_u32 s81, s81, s82
s_mov_b64 exec, 0x7ffffff
buffer_load_dword v244, v249, s[32:35], s81 offen
s_mov_b64 exec, -1
s_mul_i32 s81, s68, 41
v_add_u32 v248, s81, v1
v_mul_u32_u24 v249, 911, v248
v_lshrrev_b32 v249, 13, v249
v_mul_u32_u24 v249, 8064, v249
v_lshl_add_u32 v249, v248, 7, v249
s_mul_i32 s81, s21, 331776
s_mul_i32 s82, s71, 1152
s_add_u32 s81, s81, s82
v_mov_b32 v164, 0x7fffff00
v_mov_b32 v165, 0x7fffff00
v_mov_b32 v166, 0x7fffff00
v_mov_b32 v167, 0x7fffff00
v_mov_b32 v168, 0x7fffff00
v_mov_b32 v169, 0x7fffff00
v_mov_b32 v170, 0x7fffff00
v_mov_b32 v171, 0x7fffff00
v_mov_b32 v163, v249
v_lshlrev_b32 v247, 3, v0
s_waitcnt vmcnt(12)
v_lshlrev_b32 v64, 16, v16
v_and_b32 v65, 0xffff0000, v16
v_lshlrev_b32 v66, 16, v17
v_and_b32 v67, 0xffff0000, v17
v_lshlrev_b32 v68, 16, v18
v_and_b32 v69, 0xffff0000, v18
v_lshlrev_b32 v70, 16, v19
v_and_b32 v71, 0xffff0000, v19
v_pk_mul_f32 v[56:57], v[64:65], v[64:65]
v_pk_mul_f32 v[58:59], v[66:67], v[66:67]
v_pk_fma_f32 v[56:57], v[68:69], v[68:69], v[56:57]
v_pk_add_f32 v[248:249], v[64:65], v[68:69]
v_pk_fma_f32 v[58:59], v[70:71], v[70:71], v[58:59]
v_pk_add_f32 v[250:251], v[66:67], v[70:71]
s_add_u32 m0, s89, 0
s_add_u32 s91, s73, 0
buffer_load_dwordx4 v7, s[32:35], s91 offen lds
buffer_load_dwordx4 v8, s[32:35], s91 offen offset:1024 lds
s_add_u32 m0, s89, 16384
s_add_u32 s91, s73, 110592
buffer_load_dwordx4 v7, s[32:35], s91 offen lds
buffer_load_dwordx4 v8, s[32:35], s91 offen offset:1024 lds
s_waitcnt vmcnt(15)
v_lshlrev_b32 v72, 16, v20
v_and_b32 v73, 0xffff0000, v20
v_lshlrev_b32 v74, 16, v21
v_and_b32 v75, 0xffff0000, v21
v_lshlrev_b32 v76, 16, v22
v_and_b32 v77, 0xffff0000, v22
v_lshlrev_b32 v78, 16, v23
v_and_b32 v79, 0xffff0000, v23
v_pk_fma_f32 v[56:57], v[72:73], v[72:73], v[56:57]
v_pk_add_f32 v[248:249], v[248:249], v[72:73]
v_pk_fma_f32 v[58:59], v[74:75], v[74:75], v[58:59]
v_pk_add_f32 v[250:251], v[250:251], v[74:75]
v_pk_fma_f32 v[56:57], v[76:77], v[76:77], v[56:57]
v_pk_add_f32 v[248:249], v[248:249], v[76:77]
v_pk_fma_f32 v[58:59], v[78:79], v[78:79], v[58:59]
v_pk_add_f32 v[250:251], v[250:251], v[78:79]
s_waitcnt vmcnt(14)
v_lshlrev_b32 v80, 16, v24
v_and_b32 v81, 0xffff0000, v24
v_lshlrev_b32 v82, 16, v25
v_and_b32 v83, 0xffff0000, v25
v_lshlrev_b32 v84, 16, v26
v_and_b32 v85, 0xffff0000, v26
v_lshlrev_b32 v86, 16, v27
v_and_b32 v87, 0xffff0000, v27
v_pk_fma_f32 v[56:57], v[80:81], v[80:81], v[56:57]
v_pk_add_f32 v[248:249], v[248:249], v[80:81]
v_pk_fma_f32 v[58:59], v[82:83], v[82:83], v[58:59]
v_pk_add_f32 v[250:251], v[250:251], v[82:83]
v_pk_fma_f32 v[56:57], v[84:85], v[84:85], v[56:57]
v_pk_add_f32 v[248:249], v[248:249], v[84:85]
v_pk_fma_f32 v[58:59], v[86:87], v[86:87], v[58:59]
v_pk_add_f32 v[250:251], v[250:251], v[86:87]
s_waitcnt vmcnt(13)
v_lshlrev_b32 v88, 16, v28
v_and_b32 v89, 0xffff0000, v28
v_lshlrev_b32 v90, 16, v29
v_and_b32 v91, 0xffff0000, v29
v_lshlrev_b32 v92, 16, v30
v_and_b32 v93, 0xffff0000, v30
v_lshlrev_b32 v94, 16, v31
v_and_b32 v95, 0xffff0000, v31
v_pk_fma_f32 v[56:57], v[88:89], v[88:89], v[56:57]
v_pk_add_f32 v[248:249], v[248:249], v[88:89]
v_pk_fma_f32 v[58:59], v[90:91], v[90:91], v[58:59]
v_pk_add_f32 v[250:251], v[250:251], v[90:91]
v_pk_fma_f32 v[56:57], v[92:93], v[92:93], v[56:57]
v_pk_add_f32 v[248:249], v[248:249], v[92:93]
v_pk_fma_f32 v[58:59], v[94:95], v[94:95], v[58:59]
v_pk_add_f32 v[250:251], v[250:251], v[94:95]
s_waitcnt vmcnt(12)
v_lshlrev_b32 v96, 16, v32
v_and_b32 v97, 0xffff0000, v32
v_lshlrev_b32 v98, 16, v33
v_and_b32 v99, 0xffff0000, v33
v_lshlrev_b32 v100, 16, v34
v_and_b32 v101, 0xffff0000, v34
v_lshlrev_b32 v102, 16, v35
v_and_b32 v103, 0xffff0000, v35
v_pk_fma_f32 v[56:57], v[96:97], v[96:97], v[56:57]
v_pk_add_f32 v[248:249], v[248:249], v[96:97]
v_pk_fma_f32 v[58:59], v[98:99], v[98:99], v[58:59]
v_pk_add_f32 v[250:251], v[250:251], v[98:99]
v_pk_fma_f32 v[56:57], v[100:101], v[100:101], v[56:57]
v_pk_add_f32 v[248:249], v[248:249], v[100:101]
v_pk_fma_f32 v[58:59], v[102:103], v[102:103], v[58:59]
v_pk_add_f32 v[250:251], v[250:251], v[102:103]
s_add_u32 m0, s89, 32768
s_add_u32 s91, s73, 221184
buffer_load_dwordx4 v7, s[32:35], s91 offen lds
buffer_load_dwordx4 v8, s[32:35], s91 offen offset:1024 lds
s_waitcnt vmcnt(13)
v_lshlrev_b32 v104, 16, v36
v_and_b32 v105, 0xffff0000, v36
v_lshlrev_b32 v106, 16, v37
v_and_b32 v107, 0xffff0000, v37
v_lshlrev_b32 v108, 16, v38
v_and_b32 v109, 0xffff0000, v38
v_lshlrev_b32 v110, 16, v39
v_and_b32 v111, 0xffff0000, v39
v_pk_fma_f32 v[56:57], v[104:105], v[104:105], v[56:57]
v_pk_add_f32 v[248:249], v[248:249], v[104:105]
v_pk_fma_f32 v[58:59], v[106:107], v[106:107], v[58:59]
v_pk_add_f32 v[250:251], v[250:251], v[106:107]
v_pk_fma_f32 v[56:57], v[108:109], v[108:109], v[56:57]
v_pk_add_f32 v[248:249], v[248:249], v[108:109]
v_pk_fma_f32 v[58:59], v[110:111], v[110:111], v[58:59]
v_pk_add_f32 v[250:251], v[250:251], v[110:111]
s_waitcnt vmcnt(12)
v_lshlrev_b32 v112, 16, v40
v_and_b32 v113, 0xffff0000, v40
v_lshlrev_b32 v114, 16, v41
v_and_b32 v115, 0xffff0000, v41
v_lshlrev_b32 v116, 16, v42
v_and_b32 v117, 0xffff0000, v42
v_lshlrev_b32 v118, 16, v43
v_and_b32 v119, 0xffff0000, v43
v_pk_fma_f32 v[56:57], v[112:113], v[112:113], v[56:57]
v_pk_add_f32 v[248:249], v[248:249], v[112:113]
v_pk_fma_f32 v[58:59], v[114:115], v[114:115], v[58:59]
v_pk_add_f32 v[250:251], v[250:251], v[114:115]
v_pk_fma_f32 v[56:57], v[116:117], v[116:117], v[56:57]
v_pk_add_f32 v[248:249], v[248:249], v[116:117]
v_pk_fma_f32 v[58:59], v[118:119], v[118:119], v[58:59]
v_pk_add_f32 v[250:251], v[250:251], v[118:119]
s_waitcnt vmcnt(11)
v_lshlrev_b32 v120, 16, v44
v_and_b32 v121, 0xffff0000, v44
v_lshlrev_b32 v122, 16, v45
v_and_b32 v123, 0xffff0000, v45
v_lshlrev_b32 v124, 16, v46
v_and_b32 v125, 0xffff0000, v46
v_lshlrev_b32 v126, 16, v47
v_and_b32 v127, 0xffff0000, v47
v_pk_fma_f32 v[56:57], v[120:121], v[120:121], v[56:57]
v_pk_add_f32 v[248:249], v[248:249], v[120:121]
v_pk_fma_f32 v[58:59], v[122:123], v[122:123], v[58:59]
v_pk_add_f32 v[250:251], v[250:251], v[122:123]
v_pk_fma_f32 v[56:57], v[124:125], v[124:125], v[56:57]
v_pk_add_f32 v[248:249], v[248:249], v[124:125]
v_pk_fma_f32 v[58:59], v[126:127], v[126:127], v[58:59]
v_pk_add_f32 v[250:251], v[250:251], v[126:127]
s_waitcnt vmcnt(10)
v_lshlrev_b32 v128, 16, v48
v_and_b32 v129, 0xffff0000, v48
v_lshlrev_b32 v130, 16, v49
v_and_b32 v131, 0xffff0000, v49
v_lshlrev_b32 v132, 16, v50
v_and_b32 v133, 0xffff0000, v50
v_lshlrev_b32 v134, 16, v51
v_and_b32 v135, 0xffff0000, v51
v_pk_fma_f32 v[56:57], v[128:129], v[128:129], v[56:57]
v_pk_add_f32 v[248:249], v[248:249], v[128:129]
v_pk_fma_f32 v[58:59], v[130:131], v[130:131], v[58:59]
v_pk_add_f32 v[250:251], v[250:251], v[130:131]
v_pk_fma_f32 v[56:57], v[132:133], v[132:133], v[56:57]
v_pk_add_f32 v[248:249], v[248:249], v[132:133]
v_pk_fma_f32 v[58:59], v[134:135], v[134:135], v[58:59]
v_pk_add_f32 v[250:251], v[250:251], v[134:135]
s_add_u32 m0, s89, 49152
s_add_u32 s91, s73, 331776
buffer_load_dwordx4 v7, s[32:35], s91 offen lds
buffer_load_dwordx4 v8, s[32:35], s91 offen offset:1024 lds
v_pk_add_f32 v[248:249], v[248:249], v[250:251]
v_add_f32 v252, v248, v249
s_nop 1
v_add_f32_dpp v252, v252, v252 quad_perm:[1,0,3,2] row_mask:0xf bank_mask:0xf
s_nop 1
v_add_f32_dpp v252, v252, v252 quad_perm:[2,3,0,1] row_mask:0xf bank_mask:0xf
s_nop 1
v_add_f32_dpp v252, v252, v252 row_half_mirror row_mask:0xf bank_mask:0xf
v_mov_b32 v248, v56
v_mov_b32 v249, v57
v_mov_b32 v250, v58
v_mov_b32 v251, v59
v_pk_add_f32 v[248:249], v[248:249], v[250:251]
v_add_f32 v254, v248, v249
s_nop 1
v_add_f32_dpp v254, v254, v254 quad_perm:[1,0,3,2] row_mask:0xf bank_mask:0xf
s_nop 1
v_add_f32_dpp v254, v254, v254 quad_perm:[2,3,0,1] row_mask:0xf bank_mask:0xf
s_nop 1
v_add_f32_dpp v254, v254, v254 row_half_mirror row_mask:0xf bank_mask:0xf
v_mul_f32 v252, 0x3ae38e39, v252
v_mul_f32 v254, 0x3ae38e39, v254
v_fma_f32 v254, -v252, v252, v254
v_max_f32 v254, 0, v254
v_cvt_pk_bf16_f32 v252, v252, v252
v_lshlrev_b32 v252, 16, v252
v_cvt_pk_bf16_f32 v254, v254, v254
v_lshlrev_b32 v254, 16, v254
v_add_f32 v254, 0x3727c5ac, v254
v_cvt_pk_bf16_f32 v254, v254, v254
v_lshlrev_b32 v254, 16, v254
v_sqrt_f32 v254, v254
s_nop 0
v_cvt_pk_bf16_f32 v254, v254, v254
v_lshlrev_b32 v254, 16, v254
v_rcp_f32 v254, v254
v_sub_f32 v252, 0, v252
v_mov_b32 v255, v254
v_mov_b32 v253, v252
v_mul_f32 v252, v252, v254
v_mov_b32 v253, v252
v_pk_fma_f32 v[64:65], v[64:65], v[254:255], v[252:253]
v_pk_fma_f32 v[66:67], v[66:67], v[254:255], v[252:253]
v_pk_fma_f32 v[68:69], v[68:69], v[254:255], v[252:253]
v_pk_fma_f32 v[70:71], v[70:71], v[254:255], v[252:253]
v_pk_fma_f32 v[72:73], v[72:73], v[254:255], v[252:253]
v_pk_fma_f32 v[74:75], v[74:75], v[254:255], v[252:253]
v_pk_fma_f32 v[76:77], v[76:77], v[254:255], v[252:253]
v_pk_fma_f32 v[78:79], v[78:79], v[254:255], v[252:253]
v_pk_fma_f32 v[80:81], v[80:81], v[254:255], v[252:253]
v_pk_fma_f32 v[82:83], v[82:83], v[254:255], v[252:253]
v_pk_fma_f32 v[84:85], v[84:85], v[254:255], v[252:253]
v_pk_fma_f32 v[86:87], v[86:87], v[254:255], v[252:253]
v_pk_fma_f32 v[88:89], v[88:89], v[254:255], v[252:253]
v_pk_fma_f32 v[90:91], v[90:91], v[254:255], v[252:253]
v_pk_fma_f32 v[92:93], v[92:93], v[254:255], v[252:253]
v_pk_fma_f32 v[94:95], v[94:95], v[254:255], v[252:253]
v_pk_fma_f32 v[96:97], v[96:97], v[254:255], v[252:253]
v_pk_fma_f32 v[98:99], v[98:99], v[254:255], v[252:253]
v_pk_fma_f32 v[100:101], v[100:101], v[254:255], v[252:253]
v_pk_fma_f32 v[102:103], v[102:103], v[254:255], v[252:253]
v_pk_fma_f32 v[104:105], v[104:105], v[254:255], v[252:253]
v_pk_fma_f32 v[106:107], v[106:107], v[254:255], v[252:253]
v_pk_fma_f32 v[108:109], v[108:109], v[254:255], v[252:253]
v_pk_fma_f32 v[110:111], v[110:111], v[254:255], v[252:253]
v_pk_fma_f32 v[112:113], v[112:113], v[254:255], v[252:253]
v_pk_fma_f32 v[114:115], v[114:115], v[254:255], v[252:253]
v_pk_fma_f32 v[116:117], v[116:117], v[254:255], v[252:253]
v_pk_fma_f32 v[118:119], v[118:119], v[254:255], v[252:253]
v_pk_fma_f32 v[120:121], v[120:121], v[254:255], v[252:253]
v_pk_fma_f32 v[122:123], v[122:123], v[254:255], v[252:253]
v_pk_fma_f32 v[124:125], v[124:125], v[254:255], v[252:253]
v_pk_fma_f32 v[126:127], v[126:127], v[254:255], v[252:253]
v_pk_fma_f32 v[128:129], v[128:129], v[254:255], v[252:253]
v_pk_fma_f32 v[130:131], v[130:131], v[254:255], v[252:253]
v_pk_fma_f32 v[132:133], v[132:133], v[254:255], v[252:253]
v_pk_fma_f32 v[134:135], v[134:135], v[254:255], v[252:253]
v_and_b32 v248, 7, v1
v_lshrrev_b32 v249, 3, v1
v_xor_b32 v249, v249, v248
v_lshlrev_b32 v248, 9, v248
v_lshl_add_u32 v248, v249, 4, v248
s_lshl_b32 s82, s69, 7
s_add_u32 s82, s82, s90
v_add_u32 v248, s82, v248
v_cvt_pk_bf16_f32 v16, v64, v65
v_cvt_pk_bf16_f32 v17, v66, v67
v_cvt_pk_bf16_f32 v18, v68, v69
v_cvt_pk_bf16_f32 v19, v70, v71
ds_write_b128 v248, v[16:19] offset:0
v_cvt_pk_bf16_f32 v20, v72, v73
v_cvt_pk_bf16_f32 v21, v74, v75
v_cvt_pk_bf16_f32 v22, v76, v77
v_cvt_pk_bf16_f32 v23, v78, v79
ds_write_b128 v248, v[20:23] offset:4096
v_cvt_pk_bf16_f32 v24, v80, v81
v_cvt_pk_bf16_f32 v25, v82, v83
v_cvt_pk_bf16_f32 v26, v84, v85
v_cvt_pk_bf16_f32 v27, v86, v87
ds_write_b128 v248, v[24:27] offset:8192
v_cvt_pk_bf16_f32 v28, v88, v89
v_cvt_pk_bf16_f32 v29, v90, v91
v_cvt_pk_bf16_f32 v30, v92, v93
v_cvt_pk_bf16_f32 v31, v94, v95
ds_write_b128 v248, v[28:31] offset:12288
v_cvt_pk_bf16_f32 v32, v96, v97
v_cvt_pk_bf16_f32 v33, v98, v99
v_cvt_pk_bf16_f32 v34, v100, v101
v_cvt_pk_bf16_f32 v35, v102, v103
ds_write_b128 v248, v[32:35] offset:16384
v_cvt_pk_bf16_f32 v36, v104, v105
v_cvt_pk_bf16_f32 v37, v106, v107
v_cvt_pk_bf16_f32 v38, v108, v109
v_cvt_pk_bf16_f32 v39, v110, v111
ds_write_b128 v248, v[36:39] offset:20480
v_cvt_pk_bf16_f32 v40, v112, v113
v_cvt_pk_bf16_f32 v41, v114, v115
v_cvt_pk_bf16_f32 v42, v116, v117
v_cvt_pk_bf16_f32 v43, v118, v119
ds_write_b128 v248, v[40:43] offset:24576
v_cvt_pk_bf16_f32 v44, v120, v121
v_cvt_pk_bf16_f32 v45, v122, v123
v_cvt_pk_bf16_f32 v46, v124, v125
v_cvt_pk_bf16_f32 v47, v126, v127
ds_write_b128 v248, v[44:47] offset:28672
v_cvt_pk_bf16_f32 v48, v128, v129
v_cvt_pk_bf16_f32 v49, v130, v131
v_cvt_pk_bf16_f32 v50, v132, v133
v_cvt_pk_bf16_f32 v51, v134, v135
ds_write_b128 v248, v[48:51] offset:32768
s_waitcnt vmcnt(9)
v_lshlrev_b32 v248, 16, v246
v_and_b32 v249, 0xffff0000, v246
v_cmp_gt_u32 vcc, 2304, v247
v_add_u32 v247, 155648, v247
s_and_saveexec_b64 s[82:83], vcc
ds_write_b64 v247, v[248:249]
s_mov_b64 exec, -1
v_add_u32 v248, 0, v3
v_xor_b32 v248, v248, v2
v_lshlrev_b32 v248, 4, v248
v_lshl_add_u32 v248, v3, 9, v248
v_add_u32 v248, s90, v248
v_add_u32 v249, 2, v3
v_xor_b32 v249, v249, v2
v_lshlrev_b32 v249, 4, v249
v_lshl_add_u32 v249, v3, 9, v249
v_add_u32 v249, s90, v249
v_add_u32 v250, 4, v3
v_xor_b32 v250, v250, v2
v_lshlrev_b32 v250, 4, v250
v_lshl_add_u32 v250, v3, 9, v250
v_add_u32 v250, s90, v250
v_add_u32 v251, 6, v3
v_xor_b32 v251, v251, v2
v_lshlrev_b32 v251, 4, v251
v_lshl_add_u32 v251, v3, 9, v251
v_add_u32 v251, s90, v251
v_lshl_add_u32 v5, v3, 12, v4
s_lshl_b32 s81, s69, 8
v_add_u32 v5, s81, v5
v_add_u32 v6, 0x10000, v5
s_cmp_eq_u32 s68, 1
s_cselect_b64 vcc, -1, 0
s_waitcnt lgkmcnt(0)
s_mov_b32 s44, s22
s_and_b32 s45, s23, 0xffff
s_mov_b32 s46, 256
s_mov_b32 s47, 0x20000
s_waitcnt vmcnt(6)
s_barrier
ds_read_b128 v[16:19], v248 offset:0
ds_read_b128 v[20:23], v249 offset:1024
ds_read_b64_tr_b16 v[212:213], v5 offset:0
ds_read_b64_tr_b16 v[214:215], v5 offset:2048
ds_read_b64_tr_b16 v[228:229], v5 offset:1024
ds_read_b64_tr_b16 v[230:231], v5 offset:3072
ds_read_b64_tr_b16 v[216:217], v5 offset:8192
ds_read_b64_tr_b16 v[218:219], v5 offset:10240
ds_read_b64_tr_b16 v[232:233], v5 offset:9216
ds_read_b64_tr_b16 v[234:235], v5 offset:11264
ds_read_b128 v[24:27], v250 offset:2048
ds_read_b128 v[28:31], v251 offset:3072
s_cmp_eq_u32 s69, 0
s_cbranch_scc0 L_qkv_sw
s_waitcnt lgkmcnt(11)
s_waitcnt vmcnt(4) lgkmcnt(8)
s_barrier
v_mfma_f32_32x32x16_bf16 v[180:195], v[212:215], v[16:19], 0
ds_read_b64_tr_b16 v[220:221], v5 offset:16384
ds_read_b64_tr_b16 v[222:223], v5 offset:18432
ds_read_b128 v[32:35], v248 offset:4096
ds_read_b128 v[36:39], v249 offset:5120
s_waitcnt lgkmcnt(10)
v_mfma_f32_32x32x16_bf16 v[196:211], v[228:231], v[16:19], 0
ds_read_b64_tr_b16 v[236:237], v5 offset:17408
ds_read_b64_tr_b16 v[238:239], v5 offset:19456
s_add_u32 m0, s89, 65536
s_add_u32 s91, s73, 442368
buffer_load_dwordx4 v7, s[32:35], s91 offen lds
s_waitcnt lgkmcnt(10)
v_mfma_f32_32x32x16_bf16 v[180:195], v[216:219], v[20:23], v[180:195]
ds_read_b64_tr_b16 v[224:225], v5 offset:24576
ds_read_b64_tr_b16 v[226:227], v5 offset:26624
ds_read_b128 v[40:43], v250 offset:6144
ds_read_b128 v[44:47], v251 offset:7168
buffer_load_dwordx4 v8, s[32:35], s91 offen offset:1024 lds
s_waitcnt lgkmcnt(12)
v_mfma_f32_32x32x16_bf16 v[196:211], v[232:235], v[20:23], v[196:211]
ds_read_b64_tr_b16 v[240:241], v5 offset:25600
ds_read_b64_tr_b16 v[242:243], v5 offset:27648
s_waitcnt lgkmcnt(13)
s_waitcnt vmcnt(4) lgkmcnt(10)
s_barrier
v_mfma_f32_32x32x16_bf16 v[180:195], v[220:223], v[24:27], v[180:195]
ds_read_b64_tr_b16 v[212:213], v5 offset:32768
ds_read_b64_tr_b16 v[214:215], v5 offset:34816
ds_read_b128 v[48:51], v248 offset:8192
ds_read_b128 v[52:55], v249 offset:9216
s_waitcnt lgkmcnt(10)
v_mfma_f32_32x32x16_bf16 v[196:211], v[236:239], v[24:27], v[196:211]
ds_read_b64_tr_b16 v[228:229], v5 offset:33792
ds_read_b64_tr_b16 v[230:231], v5 offset:35840
s_add_u32 m0, s89, 0
s_add_u32 s91, s73, 552960
buffer_load_dwordx4 v7, s[32:35], s91 offen lds
s_waitcnt lgkmcnt(10)
v_mfma_f32_32x32x16_bf16 v[180:195], v[224:227], v[28:31], v[180:195]
ds_read_b64_tr_b16 v[216:217], v5 offset:40960
ds_read_b64_tr_b16 v[218:219], v5 offset:43008
ds_read_b128 v[56:59], v250 offset:10240
ds_read_b128 v[60:63], v251 offset:11264
buffer_load_dwordx4 v8, s[32:35], s91 offen offset:1024 lds
s_waitcnt lgkmcnt(10)
v_mfma_f32_32x32x16_bf16 v[196:211], v[240:243], v[28:31], v[196:211]
ds_read_b64_tr_b16 v[232:233], v5 offset:41984
ds_read_b64_tr_b16 v[234:235], v5 offset:44032
s_waitcnt vmcnt(4) lgkmcnt(10)
s_barrier
v_mfma_f32_32x32x16_bf16 v[180:195], v[212:215], v[32:35], v[180:195]
ds_read_b64_tr_b16 v[220:221], v5 offset:49152
ds_read_b64_tr_b16 v[222:223], v5 offset:51200
ds_read_b128 v[64:67], v248 offset:12288
ds_read_b128 v[68:71], v249 offset:13312
s_waitcnt lgkmcnt(10)
v_mfma_f32_32x32x16_bf16 v[196:211], v[228:231], v[32:35], v[196:211]
ds_read_b64_tr_b16 v[236:237], v5 offset:50176
ds_read_b64_tr_b16 v[238:239], v5 offset:52224
s_add_u32 m0, s89, 16384
s_add_u32 s91, s73, 663552
buffer_load_dwordx4 v7, s[32:35], s91 offen lds
s_waitcnt lgkmcnt(10)
v_mfma_f32_32x32x16_bf16 v[180:195], v[216:219], v[36:39], v[180:195]
ds_read_b64_tr_b16 v[224:225], v5 offset:57344
ds_read_b64_tr_b16 v[226:227], v5 offset:59392
ds_read_b128 v[72:75], v250 offset:14336
ds_read_b128 v[76:79], v251 offset:15360
buffer_load_dwordx4 v8, s[32:35], s91 offen offset:1024 lds
s_waitcnt lgkmcnt(10)
v_mfma_f32_32x32x16_bf16 v[196:211], v[232:235], v[36:39], v[196:211]
ds_read_b64_tr_b16 v[240:241], v5 offset:58368
ds_read_b64_tr_b16 v[242:243], v5 offset:60416
s_waitcnt vmcnt(4) lgkmcnt(10)
s_barrier
v_mfma_f32_32x32x16_bf16 v[180:195], v[220:223], v[40:43], v[180:195]
ds_read_b64_tr_b16 v[212:213], v6 offset:0
ds_read_b64_tr_b16 v[214:215], v6 offset:2048
ds_read_b128 v[80:83], v248 offset:16384
ds_read_b128 v[84:87], v249 offset:17408
s_waitcnt lgkmcnt(10)
v_mfma_f32_32x32x16_bf16 v[196:211], v[236:239], v[40:43], v[196:211]
ds_read_b64_tr_b16 v[228:229], v6 offset:1024
ds_read_b64_tr_b16 v[230:231], v6 offset:3072
s_add_u32 m0, s89, 32768
s_add_u32 s91, s73, 774144
buffer_load_dwordx4 v7, s[32:35], s91 offen lds
s_waitcnt lgkmcnt(10)
v_mfma_f32_32x32x16_bf16 v[180:195], v[224:227], v[44:47], v[180:195]
ds_read_b64_tr_b16 v[216:217], v6 offset:8192
ds_read_b64_tr_b16 v[218:219], v6 offset:10240
ds_read_b128 v[88:91], v250 offset:18432
ds_read_b128 v[92:95], v251 offset:19456
buffer_load_dwordx4 v8, s[32:35], s91 offen offset:1024 lds
s_waitcnt lgkmcnt(10)
v_mfma_f32_32x32x16_bf16 v[196:211], v[240:243], v[44:47], v[196:211]
ds_read_b64_tr_b16 v[232:233], v6 offset:9216
ds_read_b64_tr_b16 v[234:235], v6 offset:11264
s_waitcnt vmcnt(4) lgkmcnt(10)
s_barrier
v_mfma_f32_32x32x16_bf16 v[180:195], v[212:215], v[48:51], v[180:195]
ds_read_b64_tr_b16 v[220:221], v5 offset:0
ds_read_b64_tr_b16 v[222:223], v5 offset:2048
ds_read_b128 v[96:99], v248 offset:20480
ds_read_b128 v[100:103], v249 offset:21504
s_waitcnt lgkmcnt(10)
v_mfma_f32_32x32x16_bf16 v[196:211], v[228:231], v[48:51], v[196:211]
ds_read_b64_tr_b16 v[236:237], v5 offset:1024
ds_read_b64_tr_b16 v[238:239], v5 offset:3072
s_add_u32 m0, s89, 49152
s_add_u32 s91, s73, 884736
buffer_load_dwordx4 v7, s[32:35], s91 offen lds
s_waitcnt lgkmcnt(10)
v_mfma_f32_32x32x16_bf16 v[180:195], v[216:219], v[52:55], v[180:195]
ds_read_b64_tr_b16 v[224:225], v5 offset:8192
ds_read_b64_tr_b16 v[226:227], v5 offset:10240
ds_read_b128 v[104:107], v250 offset:22528
ds_read_b128 v[108:111], v251 offset:23552
buffer_load_dwordx4 v8, s[32:35], s91 offen offset:1024 lds
s_waitcnt lgkmcnt(10)
v_mfma_f32_32x32x16_bf16 v[196:211], v[232:235], v[52:55], v[196:211]
ds_read_b64_tr_b16 v[240:241], v5 offset:9216
ds_read_b64_tr_b16 v[242:243], v5 offset:11264
s_waitcnt vmcnt(4) lgkmcnt(10)
s_barrier
v_mfma_f32_32x32x16_bf16 v[180:195], v[220:223], v[56:59], v[180:195]
ds_read_b64_tr_b16 v[212:213], v5 offset:16384
ds_read_b64_tr_b16 v[214:215], v5 offset:18432
ds_read_b128 v[112:115], v248 offset:24576
ds_read_b128 v[116:119], v249 offset:25600
s_waitcnt lgkmcnt(10)
v_mfma_f32_32x32x16_bf16 v[196:211], v[236:239], v[56:59], v[196:211]
ds_read_b64_tr_b16 v[228:229], v5 offset:17408
ds_read_b64_tr_b16 v[230:231], v5 offset:19456
s_add_u32 m0, s89, 65536
s_add_u32 s91, s73, 995328
buffer_load_dwordx4 v7, s[32:35], s91 offen lds
s_waitcnt lgkmcnt(10)
v_mfma_f32_32x32x16_bf16 v[180:195], v[224:227], v[60:63], v[180:195]
ds_read_b64_tr_b16 v[216:217], v5 offset:24576
ds_read_b64_tr_b16 v[218:219], v5 offset:26624
ds_read_b128 v[120:123], v250 offset:26624
ds_read_b128 v[124:127], v251 offset:27648
buffer_load_dwordx4 v8, s[32:35], s91 offen offset:1024 lds
s_waitcnt lgkmcnt(10)
v_mfma_f32_32x32x16_bf16 v[196:211], v[240:243], v[60:63], v[196:211]
ds_read_b64_tr_b16 v[232:233], v5 offset:25600
ds_read_b64_tr_b16 v[234:235], v5 offset:27648
s_waitcnt vmcnt(4) lgkmcnt(10)
s_barrier
v_mfma_f32_32x32x16_bf16 v[180:195], v[212:215], v[64:67], v[180:195]
ds_read_b64_tr_b16 v[220:221], v5 offset:32768
ds_read_b64_tr_b16 v[222:223], v5 offset:34816
ds_read_b128 v[128:131], v248 offset:28672
ds_read_b128 v[132:135], v249 offset:29696
s_waitcnt lgkmcnt(10)
v_mfma_f32_32x32x16_bf16 v[196:211], v[228:231], v[64:67], v[196:211]
ds_read_b64_tr_b16 v[236:237], v5 offset:33792
ds_read_b64_tr_b16 v[238:239], v5 offset:35840
s_add_u32 m0, s89, 0
s_add_u32 s91, s73, 1105920
buffer_load_dwordx4 v7, s[32:35], s91 offen lds
s_waitcnt lgkmcnt(10)
v_mfma_f32_32x32x16_bf16 v[180:195], v[216:219], v[68:71], v[180:195]
ds_read_b64_tr_b16 v[224:225], v5 offset:40960
ds_read_b64_tr_b16 v[226:227], v5 offset:43008
ds_read_b128 v[136:139], v250 offset:30720
ds_read_b128 v[140:143], v251 offset:31744
buffer_load_dwordx4 v8, s[32:35], s91 offen offset:1024 lds
s_waitcnt lgkmcnt(10)
v_mfma_f32_32x32x16_bf16 v[196:211], v[232:235], v[68:71], v[196:211]
ds_read_b64_tr_b16 v[240:241], v5 offset:41984
ds_read_b64_tr_b16 v[242:243], v5 offset:44032
s_waitcnt vmcnt(4) lgkmcnt(10)
s_barrier
v_mfma_f32_32x32x16_bf16 v[180:195], v[220:223], v[72:75], v[180:195]
ds_read_b64_tr_b16 v[212:213], v5 offset:49152
ds_read_b64_tr_b16 v[214:215], v5 offset:51200
ds_read_b128 v[144:147], v248 offset:32768
ds_read_b128 v[148:151], v249 offset:33792
s_waitcnt lgkmcnt(10)
v_mfma_f32_32x32x16_bf16 v[196:211], v[236:239], v[72:75], v[196:211]
ds_read_b64_tr_b16 v[228:229], v5 offset:50176
ds_read_b64_tr_b16 v[230:231], v5 offset:52224
s_add_u32 m0, s89, 16384
s_add_u32 s91, s73, 1216512
buffer_load_dwordx4 v7, s[32:35], s91 offen lds
s_waitcnt lgkmcnt(10)
v_mfma_f32_32x32x16_bf16 v[180:195], v[224:227], v[76:79], v[180:195]
ds_read_b64_tr_b16 v[216:217], v5 offset:57344
ds_read_b64_tr_b16 v[218:219], v5 offset:59392
ds_read_b128 v[152:155], v250 offset:34816
ds_read_b128 v[156:159], v251 offset:35840
buffer_load_dwordx4 v8, s[32:35], s91 offen offset:1024 lds
s_waitcnt lgkmcnt(10)
v_mfma_f32_32x32x16_bf16 v[196:211], v[240:243], v[76:79], v[196:211]
ds_read_b64_tr_b16 v[232:233], v5 offset:58368
ds_read_b64_tr_b16 v[234:235], v5 offset:60416
s_waitcnt vmcnt(4) lgkmcnt(10)
s_barrier
v_mfma_f32_32x32x16_bf16 v[180:195], v[212:215], v[80:83], v[180:195]
ds_read_b64_tr_b16 v[220:221], v6 offset:0
ds_read_b64_tr_b16 v[222:223], v6 offset:2048
s_waitcnt lgkmcnt(8)
v_mfma_f32_32x32x16_bf16 v[196:211], v[228:231], v[80:83], v[196:211]
ds_read_b64_tr_b16 v[236:237], v6 offset:1024
ds_read_b64_tr_b16 v[238:239], v6 offset:3072
s_add_u32 m0, s89, 32768
s_add_u32 s91, s73, 1327104
buffer_load_dwordx4 v7, s[32:35], s91 offen lds
s_waitcnt lgkmcnt(8)
v_mfma_f32_32x32x16_bf16 v[180:195], v[216:219], v[84:87], v[180:195]
ds_read_b64_tr_b16 v[224:225], v6 offset:8192
ds_read_b64_tr_b16 v[226:227], v6 offset:10240
buffer_load_dwordx4 v8, s[32:35], s91 offen offset:1024 lds
s_waitcnt lgkmcnt(6)
v_mfma_f32_32x32x16_bf16 v[196:211], v[232:235], v[84:87], v[196:211]
ds_read_b64_tr_b16 v[240:241], v6 offset:9216
ds_read_b64_tr_b16 v[242:243], v6 offset:11264
s_waitcnt vmcnt(4) lgkmcnt(6)
s_barrier
v_mfma_f32_32x32x16_bf16 v[180:195], v[220:223], v[88:91], v[180:195]
ds_read_b64_tr_b16 v[212:213], v5 offset:0
ds_read_b64_tr_b16 v[214:215], v5 offset:2048
s_waitcnt lgkmcnt(6)
v_mfma_f32_32x32x16_bf16 v[196:211], v[236:239], v[88:91], v[196:211]
ds_read_b64_tr_b16 v[228:229], v5 offset:1024
ds_read_b64_tr_b16 v[230:231], v5 offset:3072
s_add_u32 m0, s89, 49152
s_add_u32 s91, s73, 1437696
buffer_load_dwordx4 v7, s[32:35], s91 offen lds
s_waitcnt lgkmcnt(6)
v_mfma_f32_32x32x16_bf16 v[180:195], v[224:227], v[92:95], v[180:195]
ds_read_b64_tr_b16 v[216:217], v5 offset:8192
ds_read_b64_tr_b16 v[218:219], v5 offset:10240
buffer_load_dwordx4 v8, s[32:35], s91 offen offset:1024 lds
s_waitcnt lgkmcnt(6)
v_mfma_f32_32x32x16_bf16 v[196:211], v[240:243], v[92:95], v[196:211]
ds_read_b64_tr_b16 v[232:233], v5 offset:9216
ds_read_b64_tr_b16 v[234:235], v5 offset:11264
s_waitcnt vmcnt(4) lgkmcnt(6)
s_barrier
v_mfma_f32_32x32x16_bf16 v[180:195], v[212:215], v[96:99], v[180:195]
ds_read_b64_tr_b16 v[220:221], v5 offset:16384
ds_read_b64_tr_b16 v[222:223], v5 offset:18432
s_waitcnt lgkmcnt(6)
v_mfma_f32_32x32x16_bf16 v[196:211], v[228:231], v[96:99], v[196:211]
ds_read_b64_tr_b16 v[236:237], v5 offset:17408
ds_read_b64_tr_b16 v[238:239], v5 offset:19456
s_add_u32 m0, s89, 65536
s_add_u32 s91, s73, 1548288
buffer_load_dwordx4 v7, s[32:35], s91 offen lds
s_waitcnt lgkmcnt(6)
v_mfma_f32_32x32x16_bf16 v[180:195], v[216:219], v[100:103], v[180:195]
ds_read_b64_tr_b16 v[224:225], v5 offset:24576
ds_read_b64_tr_b16 v[226:227], v5 offset:26624
buffer_load_dwordx4 v8, s[32:35], s91 offen offset:1024 lds
s_waitcnt lgkmcnt(6)
v_mfma_f32_32x32x16_bf16 v[196:211], v[232:235], v[100:103], v[196:211]
ds_read_b64_tr_b16 v[240:241], v5 offset:25600
ds_read_b64_tr_b16 v[242:243], v5 offset:27648
s_waitcnt vmcnt(4) lgkmcnt(6)
s_barrier
v_mfma_f32_32x32x16_bf16 v[180:195], v[220:223], v[104:107], v[180:195]
ds_read_b64_tr_b16 v[212:213], v5 offset:32768
ds_read_b64_tr_b16 v[214:215], v5 offset:34816
s_waitcnt lgkmcnt(6)
v_mfma_f32_32x32x16_bf16 v[196:211], v[236:239], v[104:107], v[196:211]
ds_read_b64_tr_b16 v[228:229], v5 offset:33792
ds_read_b64_tr_b16 v[230:231], v5 offset:35840
s_add_u32 m0, s89, 0
s_add_u32 s91, s73, 1658880
buffer_load_dwordx4 v7, s[32:35], s91 offen lds
s_waitcnt lgkmcnt(6)
v_mfma_f32_32x32x16_bf16 v[180:195], v[224:227], v[108:111], v[180:195]
ds_read_b64_tr_b16 v[216:217], v5 offset:40960
ds_read_b64_tr_b16 v[218:219], v5 offset:43008
buffer_load_dwordx4 v8, s[32:35], s91 offen offset:1024 lds
s_waitcnt lgkmcnt(6)
v_mfma_f32_32x32x16_bf16 v[196:211], v[240:243], v[108:111], v[196:211]
ds_read_b64_tr_b16 v[232:233], v5 offset:41984
ds_read_b64_tr_b16 v[234:235], v5 offset:44032
s_waitcnt vmcnt(4) lgkmcnt(6)
s_barrier
v_mfma_f32_32x32x16_bf16 v[180:195], v[212:215], v[112:115], v[180:195]
ds_read_b64_tr_b16 v[220:221], v5 offset:49152
ds_read_b64_tr_b16 v[222:223], v5 offset:51200
s_waitcnt lgkmcnt(6)
v_mfma_f32_32x32x16_bf16 v[196:211], v[228:231], v[112:115], v[196:211]
ds_read_b64_tr_b16 v[236:237], v5 offset:50176
ds_read_b64_tr_b16 v[238:239], v5 offset:52224
s_add_u32 m0, s89, 16384
s_add_u32 s91, s73, 1769472
buffer_load_dwordx4 v7, s[32:35], s91 offen lds
s_waitcnt lgkmcnt(6)
v_mfma_f32_32x32x16_bf16 v[180:195], v[216:219], v[116:119], v[180:195]
ds_read_b64_tr_b16 v[224:225], v5 offset:57344
ds_read_b64_tr_b16 v[226:227], v5 offset:59392
buffer_load_dwordx4 v8, s[32:35], s91 offen offset:1024 lds
s_waitcnt lgkmcnt(6)
v_mfma_f32_32x32x16_bf16 v[196:211], v[232:235], v[116:119], v[196:211]
ds_read_b64_tr_b16 v[240:241], v5 offset:58368
ds_read_b64_tr_b16 v[242:243], v5 offset:60416
s_waitcnt vmcnt(4) lgkmcnt(6)
s_barrier
v_mfma_f32_32x32x16_bf16 v[180:195], v[220:223], v[120:123], v[180:195]
ds_read_b64_tr_b16 v[212:213], v6 offset:0
ds_read_b64_tr_b16 v[214:215], v6 offset:2048
s_waitcnt lgkmcnt(6)
v_mfma_f32_32x32x16_bf16 v[196:211], v[236:239], v[120:123], v[196:211]
ds_read_b64_tr_b16 v[228:229], v6 offset:1024
ds_read_b64_tr_b16 v[230:231], v6 offset:3072
s_add_u32 m0, s89, 32768
s_add_u32 s91, s73, 1880064
buffer_load_dwordx4 v7, s[32:35], s91 offen lds
s_waitcnt lgkmcnt(6)
v_mfma_f32_32x32x16_bf16 v[180:195], v[224:227], v[124:127], v[180:195]
ds_read_b64_tr_b16 v[216:217], v6 offset:8192
ds_read_b64_tr_b16 v[218:219], v6 offset:10240
buffer_load_dwordx4 v8, s[32:35], s91 offen offset:1024 lds
s_waitcnt lgkmcnt(6)
v_mfma_f32_32x32x16_bf16 v[196:211], v[240:243], v[124:127], v[196:211]
ds_read_b64_tr_b16 v[232:233], v6 offset:9216
ds_read_b64_tr_b16 v[234:235], v6 offset:11264
s_waitcnt vmcnt(4) lgkmcnt(6)
s_barrier
v_mfma_f32_32x32x16_bf16 v[180:195], v[212:215], v[128:131], v[180:195]
ds_read_b64_tr_b16 v[220:221], v5 offset:0
ds_read_b64_tr_b16 v[222:223], v5 offset:2048
s_waitcnt lgkmcnt(6)
v_mfma_f32_32x32x16_bf16 v[196:211], v[228:231], v[128:131], v[196:211]
ds_read_b64_tr_b16 v[236:237], v5 offset:1024
ds_read_b64_tr_b16 v[238:239], v5 offset:3072
v_bfe_u32 v254, v1, 2, 2
v_lshl_add_u32 v254, v3, 2, v254
v_mul_u32_u24 v254, 9216, v254
v_bfe_u32 v255, v1, 4, 1
v_lshl_add_u32 v254, v255, 6, v254
v_and_b32 v255, 3, v1
v_lshl_add_u32 v7, v255, 4, v254
v_add_u32 v8, 72704, v7
s_add_u32 m0, s89, 49152
s_add_u32 s91, s4, s75
s_add_u32 s91, s91, 0
buffer_load_dwordx4 v7, s[36:39], s91 offen lds
s_waitcnt lgkmcnt(6)
v_mfma_f32_32x32x16_bf16 v[180:195], v[216:219], v[132:135], v[180:195]
ds_read_b64_tr_b16 v[224:225], v5 offset:8192
ds_read_b64_tr_b16 v[226:227], v5 offset:10240
buffer_load_dwordx4 v8, s[36:39], s91 offen offset:1024 lds
s_waitcnt lgkmcnt(6)
v_mfma_f32_32x32x16_bf16 v[196:211], v[232:235], v[132:135], v[196:211]
ds_read_b64_tr_b16 v[240:241], v5 offset:9216
ds_read_b64_tr_b16 v[242:243], v5 offset:11264
s_waitcnt vmcnt(4) lgkmcnt(6)
s_barrier
v_mfma_f32_32x32x16_bf16 v[180:195], v[220:223], v[136:139], v[180:195]
ds_read_b64_tr_b16 v[212:213], v5 offset:16384
ds_read_b64_tr_b16 v[214:215], v5 offset:18432
s_waitcnt lgkmcnt(6)
v_mfma_f32_32x32x16_bf16 v[196:211], v[236:239], v[136:139], v[196:211]
ds_read_b64_tr_b16 v[228:229], v5 offset:17408
ds_read_b64_tr_b16 v[230:231], v5 offset:19456
s_add_u32 m0, s89, 65536
s_add_u32 s91, s4, s75
s_add_u32 s91, s91, 1179648
buffer_load_dwordx4 v7, s[36:39], s91 offen lds
s_waitcnt lgkmcnt(6)
v_mfma_f32_32x32x16_bf16 v[180:195], v[224:227], v[140:143], v[180:195]
ds_read_b64_tr_b16 v[216:217], v5 offset:24576
ds_read_b64_tr_b16 v[218:219], v5 offset:26624
buffer_load_dwordx4 v8, s[36:39], s91 offen offset:1024 lds
s_waitcnt lgkmcnt(6)
v_mfma_f32_32x32x16_bf16 v[196:211], v[240:243], v[140:143], v[196:211]
ds_read_b64_tr_b16 v[232:233], v5 offset:25600
ds_read_b64_tr_b16 v[234:235], v5 offset:27648
s_waitcnt vmcnt(4) lgkmcnt(6)
s_barrier
v_mfma_f32_32x32x16_bf16 v[180:195], v[212:215], v[144:147], v[180:195]
ds_read_b64_tr_b16 v[220:221], v5 offset:32768
ds_read_b64_tr_b16 v[222:223], v5 offset:34816
s_waitcnt lgkmcnt(6)
v_mfma_f32_32x32x16_bf16 v[196:211], v[228:231], v[144:147], v[196:211]
ds_read_b64_tr_b16 v[236:237], v5 offset:33792
ds_read_b64_tr_b16 v[238:239], v5 offset:35840
s_add_u32 m0, s89, 0
s_add_u32 s91, s4, s75
s_add_u32 s91, s91, 2359296
buffer_load_dwordx4 v7, s[36:39], s91 offen lds
s_waitcnt lgkmcnt(6)
v_mfma_f32_32x32x16_bf16 v[180:195], v[216:219], v[148:151], v[180:195]
ds_read_b64_tr_b16 v[224:225], v5 offset:40960
ds_read_b64_tr_b16 v[226:227], v5 offset:43008
buffer_load_dwordx4 v8, s[36:39], s91 offen offset:1024 lds
s_waitcnt lgkmcnt(6)
v_mfma_f32_32x32x16_bf16 v[196:211], v[232:235], v[148:151], v[196:211]
ds_read_b64_tr_b16 v[240:241], v5 offset:41984
ds_read_b64_tr_b16 v[242:243], v5 offset:44032
s_waitcnt vmcnt(4) lgkmcnt(6)
s_barrier
v_mfma_f32_32x32x16_bf16 v[180:195], v[220:223], v[152:155], v[180:195]
s_waitcnt lgkmcnt(4)
v_mfma_f32_32x32x16_bf16 v[196:211], v[236:239], v[152:155], v[196:211]
s_add_u32 m0, s89, 16384
s_add_u32 s91, s4, s75
s_add_u32 s91, s91, 3538944
buffer_load_dwordx4 v7, s[36:39], s91 offen lds
s_waitcnt lgkmcnt(2)
v_mfma_f32_32x32x16_bf16 v[180:195], v[224:227], v[156:159], v[180:195]
buffer_load_dwordx4 v8, s[36:39], s91 offen offset:1024 lds
s_waitcnt lgkmcnt(0)
v_mfma_f32_32x32x16_bf16 v[196:211], v[240:243], v[156:159], v[196:211]
s_branch L_qkv_done
L_qkv_sw:
s_waitcnt lgkmcnt(11)
s_waitcnt vmcnt(4) lgkmcnt(8)
s_barrier
v_mfma_f32_32x32x16_bf16 v[180:195], v[212:215], v[16:19], 0
ds_read_b64_tr_b16 v[220:221], v5 offset:16384
ds_read_b64_tr_b16 v[222:223], v5 offset:18432
ds_read_b128 v[32:35], v248 offset:4096
ds_read_b128 v[36:39], v249 offset:5120
s_waitcnt lgkmcnt(10)
v_mfma_f32_32x32x16_bf16 v[196:211], v[16:19], v[228:231], 0
ds_read_b64_tr_b16 v[236:237], v5 offset:17408
ds_read_b64_tr_b16 v[238:239], v5 offset:19456
s_add_u32 m0, s89, 65536
s_add_u32 s91, s73, 442368
buffer_load_dwordx4 v7, s[32:35], s91 offen lds
s_waitcnt lgkmcnt(10)
v_mfma_f32_32x32x16_bf16 v[180:195], v[216:219], v[20:23], v[180:195]
ds_read_b64_tr_b16 v[224:225], v5 offset:24576
ds_read_b64_tr_b16 v[226:227], v5 offset:26624
ds_read_b128 v[40:43], v250 offset:6144
ds_read_b128 v[44:47], v251 offset:7168
buffer_load_dwordx4 v8, s[32:35], s91 offen offset:1024 lds
s_waitcnt lgkmcnt(12)
v_mfma_f32_32x32x16_bf16 v[196:211], v[20:23], v[232:235], v[196:211]
ds_read_b64_tr_b16 v[240:241], v5 offset:25600
ds_read_b64_tr_b16 v[242:243], v5 offset:27648
s_waitcnt lgkmcnt(13)
s_waitcnt vmcnt(4) lgkmcnt(10)
s_barrier
v_mfma_f32_32x32x16_bf16 v[180:195], v[220:223], v[24:27], v[180:195]
ds_read_b64_tr_b16 v[212:213], v5 offset:32768
ds_read_b64_tr_b16 v[214:215], v5 offset:34816
ds_read_b128 v[48:51], v248 offset:8192
ds_read_b128 v[52:55], v249 offset:9216
s_waitcnt lgkmcnt(10)
v_mfma_f32_32x32x16_bf16 v[196:211], v[24:27], v[236:239], v[196:211]
ds_read_b64_tr_b16 v[228:229], v5 offset:33792
ds_read_b64_tr_b16 v[230:231], v5 offset:35840
s_add_u32 m0, s89, 0
s_add_u32 s91, s73, 552960
buffer_load_dwordx4 v7, s[32:35], s91 offen lds
s_waitcnt lgkmcnt(10)
v_mfma_f32_32x32x16_bf16 v[180:195], v[224:227], v[28:31], v[180:195]
ds_read_b64_tr_b16 v[216:217], v5 offset:40960
ds_read_b64_tr_b16 v[218:219], v5 offset:43008
ds_read_b128 v[56:59], v250 offset:10240
ds_read_b128 v[60:63], v251 offset:11264
buffer_load_dwordx4 v8, s[32:35], s91 offen offset:1024 lds
s_waitcnt lgkmcnt(10)
v_mfma_f32_32x32x16_bf16 v[196:211], v[28:31], v[240:243], v[196:211]
ds_read_b64_tr_b16 v[232:233], v5 offset:41984
ds_read_b64_tr_b16 v[234:235], v5 offset:44032
s_waitcnt vmcnt(4) lgkmcnt(10)
s_barrier
v_mfma_f32_32x32x16_bf16 v[180:195], v[212:215], v[32:35], v[180:195]
ds_read_b64_tr_b16 v[220:221], v5 offset:49152
ds_read_b64_tr_b16 v[222:223], v5 offset:51200
ds_read_b128 v[64:67], v248 offset:12288
ds_read_b128 v[68:71], v249 offset:13312
s_waitcnt lgkmcnt(10)
v_mfma_f32_32x32x16_bf16 v[196:211], v[32:35], v[228:231], v[196:211]
ds_read_b64_tr_b16 v[236:237], v5 offset:50176
ds_read_b64_tr_b16 v[238:239], v5 offset:52224
s_add_u32 m0, s89, 16384
s_add_u32 s91, s73, 663552
buffer_load_dwordx4 v7, s[32:35], s91 offen lds
s_waitcnt lgkmcnt(10)
v_mfma_f32_32x32x16_bf16 v[180:195], v[216:219], v[36:39], v[180:195]
ds_read_b64_tr_b16 v[224:225], v5 offset:57344
ds_read_b64_tr_b16 v[226:227], v5 offset:59392
ds_read_b128 v[72:75], v250 offset:14336
ds_read_b128 v[76:79], v251 offset:15360
buffer_load_dwordx4 v8, s[32:35], s91 offen offset:1024 lds
s_waitcnt lgkmcnt(10)
v_mfma_f32_32x32x16_bf16 v[196:211], v[36:39], v[232:235], v[196:211]
ds_read_b64_tr_b16 v[240:241], v5 offset:58368
ds_read_b64_tr_b16 v[242:243], v5 offset:60416
s_waitcnt vmcnt(4) lgkmcnt(10)
s_barrier
v_mfma_f32_32x32x16_bf16 v[180:195], v[220:223], v[40:43], v[180:195]
ds_read_b64_tr_b16 v[212:213], v6 offset:0
ds_read_b64_tr_b16 v[214:215], v6 offset:2048
ds_read_b128 v[80:83], v248 offset:16384
ds_read_b128 v[84:87], v249 offset:17408
s_waitcnt lgkmcnt(10)
v_mfma_f32_32x32x16_bf16 v[196:211], v[40:43], v[236:239], v[196:211]
ds_read_b64_tr_b16 v[228:229], v6 offset:1024
ds_read_b64_tr_b16 v[230:231], v6 offset:3072
s_add_u32 m0, s89, 32768
s_add_u32 s91, s73, 774144
buffer_load_dwordx4 v7, s[32:35], s91 offen lds
s_waitcnt lgkmcnt(10)
v_mfma_f32_32x32x16_bf16 v[180:195], v[224:227], v[44:47], v[180:195]
ds_read_b64_tr_b16 v[216:217], v6 offset:8192
ds_read_b64_tr_b16 v[218:219], v6 offset:10240
ds_read_b128 v[88:91], v250 offset:18432
ds_read_b128 v[92:95], v251 offset:19456
buffer_load_dwordx4 v8, s[32:35], s91 offen offset:1024 lds
s_waitcnt lgkmcnt(10)
v_mfma_f32_32x32x16_bf16 v[196:211], v[44:47], v[240:243], v[196:211]
ds_read_b64_tr_b16 v[232:233], v6 offset:9216
ds_read_b64_tr_b16 v[234:235], v6 offset:11264
s_waitcnt vmcnt(4) lgkmcnt(10)
s_barrier
v_mfma_f32_32x32x16_bf16 v[180:195], v[212:215], v[48:51], v[180:195]
ds_read_b64_tr_b16 v[220:221], v5 offset:0
ds_read_b64_tr_b16 v[222:223], v5 offset:2048
ds_read_b128 v[96:99], v248 offset:20480
ds_read_b128 v[100:103], v249 offset:21504
s_waitcnt lgkmcnt(10)
v_mfma_f32_32x32x16_bf16 v[196:211], v[48:51], v[228:231], v[196:211]
ds_read_b64_tr_b16 v[236:237], v5 offset:1024
ds_read_b64_tr_b16 v[238:239], v5 offset:3072
s_add_u32 m0, s89, 49152
s_add_u32 s91, s73, 884736
buffer_load_dwordx4 v7, s[32:35], s91 offen lds
s_waitcnt lgkmcnt(10)
v_mfma_f32_32x32x16_bf16 v[180:195], v[216:219], v[52:55], v[180:195]
ds_read_b64_tr_b16 v[224:225], v5 offset:8192
ds_read_b64_tr_b16 v[226:227], v5 offset:10240
ds_read_b128 v[104:107], v250 offset:22528
ds_read_b128 v[108:111], v251 offset:23552
buffer_load_dwordx4 v8, s[32:35], s91 offen offset:1024 lds
s_waitcnt lgkmcnt(10)
v_mfma_f32_32x32x16_bf16 v[196:211], v[52:55], v[232:235], v[196:211]
ds_read_b64_tr_b16 v[240:241], v5 offset:9216
ds_read_b64_tr_b16 v[242:243], v5 offset:11264
s_waitcnt vmcnt(4) lgkmcnt(10)
s_barrier
v_mfma_f32_32x32x16_bf16 v[180:195], v[220:223], v[56:59], v[180:195]
ds_read_b64_tr_b16 v[212:213], v5 offset:16384
ds_read_b64_tr_b16 v[214:215], v5 offset:18432
ds_read_b128 v[112:115], v248 offset:24576
ds_read_b128 v[116:119], v249 offset:25600
s_waitcnt lgkmcnt(10)
v_mfma_f32_32x32x16_bf16 v[196:211], v[56:59], v[236:239], v[196:211]
ds_read_b64_tr_b16 v[228:229], v5 offset:17408
ds_read_b64_tr_b16 v[230:231], v5 offset:19456
s_add_u32 m0, s89, 65536
s_add_u32 s91, s73, 995328
buffer_load_dwordx4 v7, s[32:35], s91 offen lds
s_waitcnt lgkmcnt(10)
v_mfma_f32_32x32x16_bf16 v[180:195], v[224:227], v[60:63], v[180:195]
ds_read_b64_tr_b16 v[216:217], v5 offset:24576
ds_read_b64_tr_b16 v[218:219], v5 offset:26624
ds_read_b128 v[120:123], v250 offset:26624
ds_read_b128 v[124:127], v251 offset:27648
buffer_load_dwordx4 v8, s[32:35], s91 offen offset:1024 lds
s_waitcnt lgkmcnt(10)
v_mfma_f32_32x32x16_bf16 v[196:211], v[60:63], v[240:243], v[196:211]
ds_read_b64_tr_b16 v[232:233], v5 offset:25600
ds_read_b64_tr_b16 v[234:235], v5 offset:27648
s_waitcnt vmcnt(4) lgkmcnt(10)
s_barrier
v_mfma_f32_32x32x16_bf16 v[180:195], v[212:215], v[64:67], v[180:195]
ds_read_b64_tr_b16 v[220:221], v5 offset:32768
ds_read_b64_tr_b16 v[222:223], v5 offset:34816
ds_read_b128 v[128:131], v248 offset:28672
ds_read_b128 v[132:135], v249 offset:29696
s_waitcnt lgkmcnt(10)
v_mfma_f32_32x32x16_bf16 v[196:211], v[64:67], v[228:231], v[196:211]
ds_read_b64_tr_b16 v[236:237], v5 offset:33792
ds_read_b64_tr_b16 v[238:239], v5 offset:35840
s_add_u32 m0, s89, 0
s_add_u32 s91, s73, 1105920
buffer_load_dwordx4 v7, s[32:35], s91 offen lds
s_waitcnt lgkmcnt(10)
v_mfma_f32_32x32x16_bf16 v[180:195], v[216:219], v[68:71], v[180:195]
ds_read_b64_tr_b16 v[224:225], v5 offset:40960
ds_read_b64_tr_b16 v[226:227], v5 offset:43008
ds_read_b128 v[136:139], v250 offset:30720
ds_read_b128 v[140:143], v251 offset:31744
buffer_load_dwordx4 v8, s[32:35], s91 offen offset:1024 lds
s_waitcnt lgkmcnt(10)
v_mfma_f32_32x32x16_bf16 v[196:211], v[68:71], v[232:235], v[196:211]
ds_read_b64_tr_b16 v[240:241], v5 offset:41984
ds_read_b64_tr_b16 v[242:243], v5 offset:44032
s_waitcnt vmcnt(4) lgkmcnt(10)
s_barrier
v_mfma_f32_32x32x16_bf16 v[180:195], v[220:223], v[72:75], v[180:195]
ds_read_b64_tr_b16 v[212:213], v5 offset:49152
ds_read_b64_tr_b16 v[214:215], v5 offset:51200
ds_read_b128 v[144:147], v248 offset:32768
ds_read_b128 v[148:151], v249 offset:33792
s_waitcnt lgkmcnt(10)
v_mfma_f32_32x32x16_bf16 v[196:211], v[72:75], v[236:239], v[196:211]
ds_read_b64_tr_b16 v[228:229], v5 offset:50176
ds_read_b64_tr_b16 v[230:231], v5 offset:52224
s_add_u32 m0, s89, 16384
s_add_u32 s91, s73, 1216512
buffer_load_dwordx4 v7, s[32:35], s91 offen lds
s_waitcnt lgkmcnt(10)
v_mfma_f32_32x32x16_bf16 v[180:195], v[224:227], v[76:79], v[180:195]
ds_read_b64_tr_b16 v[216:217], v5 offset:57344
ds_read_b64_tr_b16 v[218:219], v5 offset:59392
ds_read_b128 v[152:155], v250 offset:34816
ds_read_b128 v[156:159], v251 offset:35840
buffer_load_dwordx4 v8, s[32:35], s91 offen offset:1024 lds
s_waitcnt lgkmcnt(10)
v_mfma_f32_32x32x16_bf16 v[196:211], v[76:79], v[240:243], v[196:211]
ds_read_b64_tr_b16 v[232:233], v5 offset:58368
ds_read_b64_tr_b16 v[234:235], v5 offset:60416
s_waitcnt vmcnt(4) lgkmcnt(10)
s_barrier
v_mfma_f32_32x32x16_bf16 v[180:195], v[212:215], v[80:83], v[180:195]
ds_read_b64_tr_b16 v[220:221], v6 offset:0
ds_read_b64_tr_b16 v[222:223], v6 offset:2048
s_waitcnt lgkmcnt(8)
v_mfma_f32_32x32x16_bf16 v[196:211], v[80:83], v[228:231], v[196:211]
ds_read_b64_tr_b16 v[236:237], v6 offset:1024
ds_read_b64_tr_b16 v[238:239], v6 offset:3072
s_add_u32 m0, s89, 32768
s_add_u32 s91, s73, 1327104
buffer_load_dwordx4 v7, s[32:35], s91 offen lds
s_waitcnt lgkmcnt(8)
v_mfma_f32_32x32x16_bf16 v[180:195], v[216:219], v[84:87], v[180:195]
ds_read_b64_tr_b16 v[224:225], v6 offset:8192
ds_read_b64_tr_b16 v[226:227], v6 offset:10240
buffer_load_dwordx4 v8, s[32:35], s91 offen offset:1024 lds
s_waitcnt lgkmcnt(6)
v_mfma_f32_32x32x16_bf16 v[196:211], v[84:87], v[232:235], v[196:211]
ds_read_b64_tr_b16 v[240:241], v6 offset:9216
ds_read_b64_tr_b16 v[242:243], v6 offset:11264
s_waitcnt vmcnt(4) lgkmcnt(6)
s_barrier
v_mfma_f32_32x32x16_bf16 v[180:195], v[220:223], v[88:91], v[180:195]
ds_read_b64_tr_b16 v[212:213], v5 offset:0
ds_read_b64_tr_b16 v[214:215], v5 offset:2048
s_waitcnt lgkmcnt(6)
v_mfma_f32_32x32x16_bf16 v[196:211], v[88:91], v[236:239], v[196:211]
ds_read_b64_tr_b16 v[228:229], v5 offset:1024
ds_read_b64_tr_b16 v[230:231], v5 offset:3072
s_add_u32 m0, s89, 49152
s_add_u32 s91, s73, 1437696
buffer_load_dwordx4 v7, s[32:35], s91 offen lds
s_waitcnt lgkmcnt(6)
v_mfma_f32_32x32x16_bf16 v[180:195], v[224:227], v[92:95], v[180:195]
ds_read_b64_tr_b16 v[216:217], v5 offset:8192
ds_read_b64_tr_b16 v[218:219], v5 offset:10240
buffer_load_dwordx4 v8, s[32:35], s91 offen offset:1024 lds
s_waitcnt lgkmcnt(6)
v_mfma_f32_32x32x16_bf16 v[196:211], v[92:95], v[240:243], v[196:211]
ds_read_b64_tr_b16 v[232:233], v5 offset:9216
ds_read_b64_tr_b16 v[234:235], v5 offset:11264
s_waitcnt vmcnt(4) lgkmcnt(6)
s_barrier
v_mfma_f32_32x32x16_bf16 v[180:195], v[212:215], v[96:99], v[180:195]
ds_read_b64_tr_b16 v[220:221], v5 offset:16384
ds_read_b64_tr_b16 v[222:223], v5 offset:18432
s_waitcnt lgkmcnt(6)
v_mfma_f32_32x32x16_bf16 v[196:211], v[96:99], v[228:231], v[196:211]
ds_read_b64_tr_b16 v[236:237], v5 offset:17408
ds_read_b64_tr_b16 v[238:239], v5 offset:19456
s_add_u32 m0, s89, 65536
s_add_u32 s91, s73, 1548288
buffer_load_dwordx4 v7, s[32:35], s91 offen lds
s_waitcnt lgkmcnt(6)
v_mfma_f32_32x32x16_bf16 v[180:195], v[216:219], v[100:103], v[180:195]
ds_read_b64_tr_b16 v[224:225], v5 offset:24576
ds_read_b64_tr_b16 v[226:227], v5 offset:26624
buffer_load_dwordx4 v8, s[32:35], s91 offen offset:1024 lds
s_waitcnt lgkmcnt(6)
v_mfma_f32_32x32x16_bf16 v[196:211], v[100:103], v[232:235], v[196:211]
ds_read_b64_tr_b16 v[240:241], v5 offset:25600
ds_read_b64_tr_b16 v[242:243], v5 offset:27648
s_waitcnt vmcnt(4) lgkmcnt(6)
s_barrier
v_mfma_f32_32x32x16_bf16 v[180:195], v[220:223], v[104:107], v[180:195]
ds_read_b64_tr_b16 v[212:213], v5 offset:32768
ds_read_b64_tr_b16 v[214:215], v5 offset:34816
s_waitcnt lgkmcnt(6)
v_mfma_f32_32x32x16_bf16 v[196:211], v[104:107], v[236:239], v[196:211]
ds_read_b64_tr_b16 v[228:229], v5 offset:33792
ds_read_b64_tr_b16 v[230:231], v5 offset:35840
s_add_u32 m0, s89, 0
s_add_u32 s91, s73, 1658880
buffer_load_dwordx4 v7, s[32:35], s91 offen lds
s_waitcnt lgkmcnt(6)
v_mfma_f32_32x32x16_bf16 v[180:195], v[224:227], v[108:111], v[180:195]
ds_read_b64_tr_b16 v[216:217], v5 offset:40960
ds_read_b64_tr_b16 v[218:219], v5 offset:43008
buffer_load_dwordx4 v8, s[32:35], s91 offen offset:1024 lds
s_waitcnt lgkmcnt(6)
v_mfma_f32_32x32x16_bf16 v[196:211], v[108:111], v[240:243], v[196:211]
ds_read_b64_tr_b16 v[232:233], v5 offset:41984
ds_read_b64_tr_b16 v[234:235], v5 offset:44032
s_waitcnt vmcnt(4) lgkmcnt(6)
s_barrier
v_mfma_f32_32x32x16_bf16 v[180:195], v[212:215], v[112:115], v[180:195]
ds_read_b64_tr_b16 v[220:221], v5 offset:49152
ds_read_b64_tr_b16 v[222:223], v5 offset:51200
s_waitcnt lgkmcnt(6)
v_mfma_f32_32x32x16_bf16 v[196:211], v[112:115], v[228:231], v[196:211]
ds_read_b64_tr_b16 v[236:237], v5 offset:50176
ds_read_b64_tr_b16 v[238:239], v5 offset:52224
s_add_u32 m0, s89, 16384
s_add_u32 s91, s73, 1769472
buffer_load_dwordx4 v7, s[32:35], s91 offen lds
s_waitcnt lgkmcnt(6)
v_mfma_f32_32x32x16_bf16 v[180:195], v[216:219], v[116:119], v[180:195]
ds_read_b64_tr_b16 v[224:225], v5 offset:57344
ds_read_b64_tr_b16 v[226:227], v5 offset:59392
buffer_load_dwordx4 v8, s[32:35], s91 offen offset:1024 lds
s_waitcnt lgkmcnt(6)
v_mfma_f32_32x32x16_bf16 v[196:211], v[116:119], v[232:235], v[196:211]
ds_read_b64_tr_b16 v[240:241], v5 offset:58368
ds_read_b64_tr_b16 v[242:243], v5 offset:60416
s_waitcnt vmcnt(4) lgkmcnt(6)
s_barrier
v_mfma_f32_32x32x16_bf16 v[180:195], v[220:223], v[120:123], v[180:195]
ds_read_b64_tr_b16 v[212:213], v6 offset:0
ds_read_b64_tr_b16 v[214:215], v6 offset:2048
s_waitcnt lgkmcnt(6)
v_mfma_f32_32x32x16_bf16 v[196:211], v[120:123], v[236:239], v[196:211]
ds_read_b64_tr_b16 v[228:229], v6 offset:1024
ds_read_b64_tr_b16 v[230:231], v6 offset:3072
s_add_u32 m0, s89, 32768
s_add_u32 s91, s73, 1880064
buffer_load_dwordx4 v7, s[32:35], s91 offen lds
s_waitcnt lgkmcnt(6)
v_mfma_f32_32x32x16_bf16 v[180:195], v[224:227], v[124:127], v[180:195]
ds_read_b64_tr_b16 v[216:217], v6 offset:8192
ds_read_b64_tr_b16 v[218:219], v6 offset:10240
buffer_load_dwordx4 v8, s[32:35], s91 offen offset:1024 lds
s_waitcnt lgkmcnt(6)
v_mfma_f32_32x32x16_bf16 v[196:211], v[124:127], v[240:243], v[196:211]
ds_read_b64_tr_b16 v[232:233], v6 offset:9216
ds_read_b64_tr_b16 v[234:235], v6 offset:11264
s_waitcnt vmcnt(4) lgkmcnt(6)
s_barrier
v_mfma_f32_32x32x16_bf16 v[180:195], v[212:215], v[128:131], v[180:195]
ds_read_b64_tr_b16 v[220:221], v5 offset:0
ds_read_b64_tr_b16 v[222:223], v5 offset:2048
s_waitcnt lgkmcnt(6)
v_mfma_f32_32x32x16_bf16 v[196:211], v[128:131], v[228:231], v[196:211]
ds_read_b64_tr_b16 v[236:237], v5 offset:1024
ds_read_b64_tr_b16 v[238:239], v5 offset:3072
v_bfe_u32 v254, v1, 2, 2
v_lshl_add_u32 v254, v3, 2, v254
v_mul_u32_u24 v254, 9216, v254
v_bfe_u32 v255, v1, 4, 1
v_lshl_add_u32 v254, v255, 6, v254
v_and_b32 v255, 3, v1
v_lshl_add_u32 v7, v255, 4, v254
v_add_u32 v8, 72704, v7
s_add_u32 m0, s89, 49152
s_add_u32 s91, s4, s75
s_add_u32 s91, s91, 0
buffer_load_dwordx4 v7, s[36:39], s91 offen lds
s_waitcnt lgkmcnt(6)
v_mfma_f32_32x32x16_bf16 v[180:195], v[216:219], v[132:135], v[180:195]
ds_read_b64_tr_b16 v[224:225], v5 offset:8192
ds_read_b64_tr_b16 v[226:227], v5 offset:10240
buffer_load_dwordx4 v8, s[36:39], s91 offen offset:1024 lds
s_waitcnt lgkmcnt(6)
v_mfma_f32_32x32x16_bf16 v[196:211], v[132:135], v[232:235], v[196:211]
ds_read_b64_tr_b16 v[240:241], v5 offset:9216
ds_read_b64_tr_b16 v[242:243], v5 offset:11264
s_waitcnt vmcnt(4) lgkmcnt(6)
s_barrier
v_mfma_f32_32x32x16_bf16 v[180:195], v[220:223], v[136:139], v[180:195]
ds_read_b64_tr_b16 v[212:213], v5 offset:16384
ds_read_b64_tr_b16 v[214:215], v5 offset:18432
s_waitcnt lgkmcnt(6)
v_mfma_f32_32x32x16_bf16 v[196:211], v[136:139], v[236:239], v[196:211]
ds_read_b64_tr_b16 v[228:229], v5 offset:17408
ds_read_b64_tr_b16 v[230:231], v5 offset:19456
s_add_u32 m0, s89, 65536
s_add_u32 s91, s4, s75
s_add_u32 s91, s91, 1179648
buffer_load_dwordx4 v7, s[36:39], s91 offen lds
s_waitcnt lgkmcnt(6)
v_mfma_f32_32x32x16_bf16 v[180:195], v[224:227], v[140:143], v[180:195]
ds_read_b64_tr_b16 v[216:217], v5 offset:24576
ds_read_b64_tr_b16 v[218:219], v5 offset:26624
buffer_load_dwordx4 v8, s[36:39], s91 offen offset:1024 lds
s_waitcnt lgkmcnt(6)
v_mfma_f32_32x32x16_bf16 v[196:211], v[140:143], v[240:243], v[196:211]
ds_read_b64_tr_b16 v[232:233], v5 offset:25600
ds_read_b64_tr_b16 v[234:235], v5 offset:27648
s_waitcnt vmcnt(4) lgkmcnt(6)
s_barrier
v_mfma_f32_32x32x16_bf16 v[180:195], v[212:215], v[144:147], v[180:195]
ds_read_b64_tr_b16 v[220:221], v5 offset:32768
ds_read_b64_tr_b16 v[222:223], v5 offset:34816
s_waitcnt lgkmcnt(6)
v_mfma_f32_32x32x16_bf16 v[196:211], v[144:147], v[228:231], v[196:211]
ds_read_b64_tr_b16 v[236:237], v5 offset:33792
ds_read_b64_tr_b16 v[238:239], v5 offset:35840
s_add_u32 m0, s89, 0
s_add_u32 s91, s4, s75
s_add_u32 s91, s91, 2359296
buffer_load_dwordx4 v7, s[36:39], s91 offen lds
s_waitcnt lgkmcnt(6)
v_mfma_f32_32x32x16_bf16 v[180:195], v[216:219], v[148:151], v[180:195]
ds_read_b64_tr_b16 v[224:225], v5 offset:40960
ds_read_b64_tr_b16 v[226:227], v5 offset:43008
buffer_load_dwordx4 v8, s[36:39], s91 offen offset:1024 lds
s_waitcnt lgkmcnt(6)
v_mfma_f32_32x32x16_bf16 v[196:211], v[148:151], v[232:235], v[196:211]
ds_read_b64_tr_b16 v[240:241], v5 offset:41984
ds_read_b64_tr_b16 v[242:243], v5 offset:44032
s_waitcnt vmcnt(4) lgkmcnt(6)
s_barrier
v_mfma_f32_32x32x16_bf16 v[180:195], v[220:223], v[152:155], v[180:195]
s_waitcnt lgkmcnt(4)
v_mfma_f32_32x32x16_bf16 v[196:211], v[152:155], v[236:239], v[196:211]
s_add_u32 m0, s89, 16384
s_add_u32 s91, s4, s75
s_add_u32 s91, s91, 3538944
buffer_load_dwordx4 v7, s[36:39], s91 offen lds
s_waitcnt lgkmcnt(2)
v_mfma_f32_32x32x16_bf16 v[180:195], v[224:227], v[156:159], v[180:195]
buffer_load_dwordx4 v8, s[36:39], s91 offen offset:1024 lds
s_waitcnt lgkmcnt(0)
v_mfma_f32_32x32x16_bf16 v[196:211], v[156:159], v[240:243], v[196:211]
L_qkv_done:
v_lshl_add_u32 v5, v3, 10, v4
s_lshr_b32 s82, s69, 1
s_lshl_b32 s81, s82, 8
v_add_u32 v5, s81, v5
v_add_u32 v6, 0x10000, v5
s_lshl_b32 s81, s82, 7
s_add_u32 s81, s81, 155648
v_lshl_add_u32 v13, v3, 4, s81
s_lshl_b32 s81, s82, 11
s_add_u32 s81, s81, s90
v_add_u32 v12, s81, v9
s_cmp_lg_u32 s87, 0
s_cbranch_scc1 L_f1_B
s_lshl_b32 s82, s4, 1
v_add_u32 v254, s82, v13
ds_read_b128 v[228:231], v254 offset:0
ds_read_b128 v[232:235], v254 offset:32
ds_read_b128 v[236:239], v254 offset:64
ds_read_b128 v[240:243], v254 offset:96
ds_read_b64_tr_b16 v[212:213], v5 offset:49152
ds_read_b64_tr_b16 v[214:215], v5 offset:49664
ds_read_b64_tr_b16 v[216:217], v5 offset:51200
ds_read_b64_tr_b16 v[218:219], v5 offset:51712
ds_read_b64_tr_b16 v[220:221], v5 offset:53248
ds_read_b64_tr_b16 v[222:223], v5 offset:53760
s_waitcnt vmcnt(4)
s_barrier
s_waitcnt lgkmcnt(6)
s_waitcnt lgkmcnt(4)
v_mfma_f32_32x32x16_bf16 v[228:243], v[212:215], v[16:19], v[228:243]
ds_read_b64_tr_b16 v[224:225], v5 offset:55296
ds_read_b64_tr_b16 v[226:227], v5 offset:55808
s_waitcnt lgkmcnt(4)
v_mfma_f32_32x32x16_bf16 v[228:243], v[216:219], v[20:23], v[228:243]
ds_read_b64_tr_b16 v[212:213], v5 offset:57344
ds_read_b64_tr_b16 v[214:215], v5 offset:57856
s_waitcnt lgkmcnt(4)
v_mfma_f32_32x32x16_bf16 v[228:243], v[220:223], v[24:27], v[228:243]
ds_read_b64_tr_b16 v[216:217], v5 offset:59392
ds_read_b64_tr_b16 v[218:219], v5 offset:59904
s_waitcnt lgkmcnt(4)
v_mfma_f32_32x32x16_bf16 v[228:243], v[224:227], v[28:31], v[228:243]
ds_read_b64_tr_b16 v[220:221], v5 offset:61440
ds_read_b64_tr_b16 v[222:223], v5 offset:61952
s_waitcnt lgkmcnt(4)
v_mfma_f32_32x32x16_bf16 v[228:243], v[212:215], v[32:35], v[228:243]
ds_read_b64_tr_b16 v[224:225], v5 offset:63488
ds_read_b64_tr_b16 v[226:227], v5 offset:64000
s_waitcnt lgkmcnt(4)
v_mfma_f32_32x32x16_bf16 v[228:243], v[216:219], v[36:39], v[228:243]
ds_read_b64_tr_b16 v[212:213], v6 offset:0
ds_read_b64_tr_b16 v[214:215], v6 offset:512
s_waitcnt lgkmcnt(4)
v_mfma_f32_32x32x16_bf16 v[228:243], v[220:223], v[40:43], v[228:243]
ds_read_b64_tr_b16 v[216:217], v6 offset:2048
ds_read_b64_tr_b16 v[218:219], v6 offset:2560
s_waitcnt lgkmcnt(4)
v_mfma_f32_32x32x16_bf16 v[228:243], v[224:227], v[44:47], v[228:243]
ds_read_b64_tr_b16 v[220:221], v6 offset:4096
ds_read_b64_tr_b16 v[222:223], v6 offset:4608
s_waitcnt vmcnt(2) lgkmcnt(4)
s_barrier
v_mfma_f32_32x32x16_bf16 v[228:243], v[212:215], v[48:51], v[228:243]
ds_read_b64_tr_b16 v[224:225], v6 offset:6144
ds_read_b64_tr_b16 v[226:227], v6 offset:6656
s_waitcnt lgkmcnt(4)
v_mfma_f32_32x32x16_bf16 v[228:243], v[216:219], v[52:55], v[228:243]
ds_read_b64_tr_b16 v[212:213], v6 offset:8192
ds_read_b64_tr_b16 v[214:215], v6 offset:8704
s_waitcnt lgkmcnt(4)
v_mfma_f32_32x32x16_bf16 v[228:243], v[220:223], v[56:59], v[228:243]
ds_read_b64_tr_b16 v[216:217], v6 offset:10240
ds_read_b64_tr_b16 v[218:219], v6 offset:10752
s_waitcnt lgkmcnt(4)
v_mfma_f32_32x32x16_bf16 v[228:243], v[224:227], v[60:63], v[228:243]
ds_read_b64_tr_b16 v[220:221], v6 offset:12288
ds_read_b64_tr_b16 v[222:223], v6 offset:12800
s_waitcnt lgkmcnt(4)
v_mfma_f32_32x32x16_bf16 v[228:243], v[212:215], v[64:67], v[228:243]
ds_read_b64_tr_b16 v[224:225], v6 offset:14336
ds_read_b64_tr_b16 v[226:227], v6 offset:14848
s_waitcnt lgkmcnt(4)
v_mfma_f32_32x32x16_bf16 v[228:243], v[216:219], v[68:71], v[228:243]
ds_read_b64_tr_b16 v[212:213], v5 offset:0
ds_read_b64_tr_b16 v[214:215], v5 offset:512
s_waitcnt lgkmcnt(4)
v_mfma_f32_32x32x16_bf16 v[228:243], v[220:223], v[72:75], v[228:243]
ds_read_b64_tr_b16 v[216:217], v5 offset:2048
ds_read_b64_tr_b16 v[218:219], v5 offset:2560
s_waitcnt lgkmcnt(4)
v_mfma_f32_32x32x16_bf16 v[228:243], v[224:227], v[76:79], v[228:243]
ds_read_b64_tr_b16 v[220:221], v5 offset:4096
ds_read_b64_tr_b16 v[222:223], v5 offset:4608
s_waitcnt vmcnt(0) lgkmcnt(4)
s_barrier
v_mfma_f32_32x32x16_bf16 v[228:243], v[212:215], v[80:83], v[228:243]
ds_read_b64_tr_b16 v[224:225], v5 offset:6144
ds_read_b64_tr_b16 v[226:227], v5 offset:6656
s_waitcnt lgkmcnt(4)
v_mfma_f32_32x32x16_bf16 v[228:243], v[216:219], v[84:87], v[228:243]
ds_read_b64_tr_b16 v[212:213], v5 offset:8192
ds_read_b64_tr_b16 v[214:215], v5 offset:8704
s_waitcnt lgkmcnt(4)
v_mfma_f32_32x32x16_bf16 v[228:243], v[220:223], v[88:91], v[228:243]
ds_read_b64_tr_b16 v[216:217], v5 offset:10240
ds_read_b64_tr_b16 v[218:219], v5 offset:10752
s_waitcnt lgkmcnt(4)
v_mfma_f32_32x32x16_bf16 v[228:243], v[224:227], v[92:95], v[228:243]
ds_read_b64_tr_b16 v[220:221], v5 offset:12288
ds_read_b64_tr_b16 v[222:223], v5 offset:12800
s_waitcnt lgkmcnt(4)
v_mfma_f32_32x32x16_bf16 v[228:243], v[212:215], v[96:99], v[228:243]
ds_read_b64_tr_b16 v[224:225], v5 offset:14336
ds_read_b64_tr_b16 v[226:227], v5 offset:14848
s_waitcnt lgkmcnt(4)
v_mfma_f32_32x32x16_bf16 v[228:243], v[216:219], v[100:103], v[228:243]
ds_read_b64_tr_b16 v[212:213], v5 offset:16384
ds_read_b64_tr_b16 v[214:215], v5 offset:16896
s_waitcnt lgkmcnt(4)
v_mfma_f32_32x32x16_bf16 v[228:243], v[220:223], v[104:107], v[228:243]
ds_read_b64_tr_b16 v[216:217], v5 offset:18432
ds_read_b64_tr_b16 v[218:219], v5 offset:18944
s_waitcnt lgkmcnt(4)
v_mfma_f32_32x32x16_bf16 v[228:243], v[224:227], v[108:111], v[228:243]
ds_read_b64_tr_b16 v[220:221], v5 offset:20480
ds_read_b64_tr_b16 v[222:223], v5 offset:20992
s_waitcnt lgkmcnt(4)
s_barrier
v_mfma_f32_32x32x16_bf16 v[228:243], v[212:215], v[112:115], v[228:243]
ds_read_b64_tr_b16 v[224:225], v5 offset:22528
ds_read_b64_tr_b16 v[226:227], v5 offset:23040
s_waitcnt lgkmcnt(4)
v_mfma_f32_32x32x16_bf16 v[228:243], v[216:219], v[116:119], v[228:243]
ds_read_b64_tr_b16 v[212:213], v5 offset:24576
ds_read_b64_tr_b16 v[214:215], v5 offset:25088
s_waitcnt lgkmcnt(4)
v_mfma_f32_32x32x16_bf16 v[228:243], v[220:223], v[120:123], v[228:243]
ds_read_b64_tr_b16 v[216:217], v5 offset:26624
ds_read_b64_tr_b16 v[218:219], v5 offset:27136
s_waitcnt lgkmcnt(4)
v_mfma_f32_32x32x16_bf16 v[228:243], v[224:227], v[124:127], v[228:243]
ds_read_b64_tr_b16 v[220:221], v5 offset:28672
ds_read_b64_tr_b16 v[222:223], v5 offset:29184
s_waitcnt lgkmcnt(4)
v_mfma_f32_32x32x16_bf16 v[228:243], v[212:215], v[128:131], v[228:243]
ds_read_b64_tr_b16 v[224:225], v5 offset:30720
ds_read_b64_tr_b16 v[226:227], v5 offset:31232
s_waitcnt lgkmcnt(4)
v_mfma_f32_32x32x16_bf16 v[228:243], v[216:219], v[132:135], v[228:243]
ds_read_b64_tr_b16 v[212:213], v5 offset:32768
ds_read_b64_tr_b16 v[214:215], v5 offset:33280
s_waitcnt lgkmcnt(4)
v_mfma_f32_32x32x16_bf16 v[228:243], v[220:223], v[136:139], v[228:243]
ds_read_b64_tr_b16 v[216:217], v5 offset:34816
ds_read_b64_tr_b16 v[218:219], v5 offset:35328
s_waitcnt lgkmcnt(4)
v_mfma_f32_32x32x16_bf16 v[228:243], v[224:227], v[140:143], v[228:243]
ds_read_b64_tr_b16 v[220:221], v5 offset:36864
ds_read_b64_tr_b16 v[222:223], v5 offset:37376
s_waitcnt lgkmcnt(4)
s_barrier
v_mfma_f32_32x32x16_bf16 v[228:243], v[212:215], v[144:147], v[228:243]
ds_read_b64_tr_b16 v[224:225], v5 offset:38912
ds_read_b64_tr_b16 v[226:227], v5 offset:39424
s_waitcnt lgkmcnt(4)
v_mfma_f32_32x32x16_bf16 v[228:243], v[216:219], v[148:151], v[228:243]
s_waitcnt lgkmcnt(2)
v_mfma_f32_32x32x16_bf16 v[228:243], v[220:223], v[152:155], v[228:243]
s_waitcnt lgkmcnt(0)
v_mfma_f32_32x32x16_bf16 v[228:243], v[224:227], v[156:159], v[228:243]
s_add_u32 m0, s13, 24576
s_add_u32 s3, s5, s74
s_add_u32 s3, s3, 4718592
buffer_load_dwordx4 v7, s[36:39], s3 offen lds
s_nop 7
s_nop 3
v_mul_f32 v248, v228, v228
v_mul_f32 v249, v229, v229
v_mul_f32 v250, v230, v230
buffer_load_dwordx4 v8, s[36:39], s3 offen offset:1024 lds
v_mul_f32 v251, v231, v231
v_fmaak_f32 v248, v248, v11, 0xc0135761
v_fmaak_f32 v249, v249, v11, 0xc0135761
v_fmaak_f32 v250, v250, v11, 0xc0135761
v_fmaak_f32 v251, v251, v11, 0xc0135761
v_mul_f32 v248, v228, v248
s_barrier
s_add_u32 m0, s13, 32768
s_add_u32 s3, s6, s74
buffer_load_dwordx4 v7, s[36:39], s3 offen lds
v_mul_f32 v249, v229, v249
v_mul_f32 v250, v230, v250
v_mul_f32 v251, v231, v251
v_exp_f32 v248, v248
v_exp_f32 v249, v249
v_exp_f32 v250, v250
s_lshl_b32 s84, s70, 9
s_add_u32 s84, s84, 157952
v_xor_b32 v171, 1, v3
s_cmp_eq_u32 s69, 1
s_cbranch_scc1 L_ep1A0
s_cmp_eq_u32 s69, 2
s_cbranch_scc1 L_ep2A0
s_cmp_eq_u32 s69, 3
s_cbranch_scc1 L_ep3A0
v_mul_f32 v180, s88, v180
v_mul_f32 v181, s88, v181
v_mul_f32 v182, s88, v182
v_mul_f32 v183, s88, v183
v_cvt_pk_bf16_f32 v180, v180, v181
v_cvt_pk_bf16_f32 v181, v182, v183
s_add_u32 s81, s20, 0
s_add_u32 s83, s20, 8
s_sub_u32 s83, s83, s81
v_mul_lo_u32 v172, v3, s83
v_add3_u32 v172, v172, v10, s81
ds_write_b64 v172, v[180:181]
v_mul_f32 v184, s88, v184
v_mul_f32 v185, s88, v185
v_mul_f32 v186, s88, v186
v_mul_f32 v187, s88, v187
v_cvt_pk_bf16_f32 v184, v184, v185
v_cvt_pk_bf16_f32 v185, v186, v187
s_add_u32 s81, s20, 512
s_add_u32 s83, s20, 520
s_sub_u32 s83, s83, s81
v_mul_lo_u32 v172, v3, s83
v_add3_u32 v172, v172, v10, s81
ds_write_b64 v172, v[184:185]
v_mul_f32 v188, s88, v188
v_mul_f32 v189, s88, v189
v_mul_f32 v190, s88, v190
v_mul_f32 v191, s88, v191
v_cvt_pk_bf16_f32 v188, v188, v189
v_cvt_pk_bf16_f32 v189, v190, v191
s_add_u32 s81, s84, 0
s_add_u32 s83, s20, 1024
s_sub_u32 s83, s83, s81
v_mul_lo_u32 v172, v3, s83
v_add3_u32 v172, v172, v10, s81
ds_write_b64 v172, v[188:189]
v_mul_f32 v192, s88, v192
v_mul_f32 v193, s88, v193
v_mul_f32 v194, s88, v194
v_mul_f32 v195, s88, v195
v_cvt_pk_bf16_f32 v192, v192, v193
v_cvt_pk_bf16_f32 v193, v194, v195
s_add_u32 s81, s20, 1032
s_add_u32 s83, s20, 1536
s_sub_u32 s83, s83, s81
v_mul_lo_u32 v172, v3, s83
v_add3_u32 v172, v172, v10, s81
ds_write_b64 v172, v[192:193]
s_branch L_epmA0
L_ep1A0:
v_mul_f32 v180, s88, v180
v_mul_f32 v181, s88, v181
v_mul_f32 v182, s88, v182
v_mul_f32 v183, s88, v183
v_cvt_pk_bf16_f32 v180, v180, v181
v_cvt_pk_bf16_f32 v181, v182, v183
s_add_u32 s81, s20, 1544
s_add_u32 s83, s20, 2048
s_sub_u32 s83, s83, s81
v_mul_lo_u32 v172, v3, s83
v_add3_u32 v172, v172, v10, s81
ds_write_b64 v172, v[180:181]
v_mul_f32 v184, s88, v184
v_mul_f32 v185, s88, v185
v_mul_f32 v186, s88, v186
v_mul_f32 v187, s88, v187
v_cvt_pk_bf16_f32 v184, v184, v185
v_cvt_pk_bf16_f32 v185, v186, v187
s_add_u32 s81, s20, 2056
s_add_u32 s83, s20, 2560
s_sub_u32 s83, s83, s81
v_mul_lo_u32 v172, v3, s83
v_add3_u32 v172, v172, v10, s81
ds_write_b64 v172, v[184:185]
v_mul_f32 v188, s88, v188
v_mul_f32 v189, s88, v189
v_mul_f32 v190, s88, v190
v_mul_f32 v191, s88, v191
v_cvt_pk_bf16_f32 v188, v188, v189
v_cvt_pk_bf16_f32 v189, v190, v191
s_add_u32 s81, s20, 2568
s_add_u32 s83, s84, 8
s_sub_u32 s83, s83, s81
v_mul_lo_u32 v172, v3, s83
v_add3_u32 v172, v172, v10, s81
ds_write_b64 v172, v[188:189]
v_mul_f32 v192, s88, v192
v_mul_f32 v193, s88, v193
v_mul_f32 v194, s88, v194
v_mul_f32 v195, s88, v195
v_cvt_pk_bf16_f32 v192, v192, v193
v_cvt_pk_bf16_f32 v193, v194, v195
s_add_u32 s81, s20, 3072
s_add_u32 s83, s20, 3080
s_sub_u32 s83, s83, s81
v_mul_lo_u32 v172, v3, s83
v_add3_u32 v172, v172, v10, s81
ds_write_b64 v172, v[192:193]
s_branch L_epmA0
L_ep2A0:
v_mul_f32 v180, s88, v180
v_mul_f32 v181, s88, v181
v_mul_f32 v182, s88, v182
v_mul_f32 v183, s88, v183
v_cvt_pk_bf16_f32 v180, v180, v181
v_cvt_pk_bf16_f32 v181, v182, v183
s_add_u32 s81, s20, 3584
s_add_u32 s83, s20, 3592
s_sub_u32 s83, s83, s81
v_mul_lo_u32 v172, v3, s83
v_add3_u32 v172, v172, v10, s81
ds_write_b64 v172, v[180:181]
v_cvt_pk_bf16_f32 v184, v184, v185
v_cvt_pk_bf16_f32 v185, v186, v187
s_mov_b32 s81, 8
v_mad_u32_u24 v165, v3, s81, v10
v_cvt_pk_bf16_f32 v188, v188, v189
v_cvt_pk_bf16_f32 v189, v190, v191
s_mov_b32 s81, 8
v_mad_u32_u24 v166, v3, s81, v10
v_cvt_pk_bf16_f32 v192, v192, v193
v_cvt_pk_bf16_f32 v193, v194, v195
s_mov_b32 s81, 3072
v_mad_u32_u24 v167, v171, s81, v10
s_branch L_epmA0
L_ep3A0:
v_cvt_pk_bf16_f32 v180, v180, v181
v_cvt_pk_bf16_f32 v181, v182, v183
s_mov_b32 s81, 504
v_mad_u32_u24 v164, v3, s81, v10
v_cvt_pk_bf16_f32 v184, v184, v185
v_cvt_pk_bf16_f32 v185, v186, v187
s_mov_b32 s81, 504
v_mad_u32_u24 v165, v3, s81, v10
v_cvt_pk_bf16_f32 v188, v188, v189
v_cvt_pk_bf16_f32 v189, v190, v191
s_mov_b32 s81, 504
v_mad_u32_u24 v166, v3, s81, v10
v_cvt_pk_bf16_f32 v192, v192, v193
v_cvt_pk_bf16_f32 v193, v194, v195
s_mov_b32 s81, 1536
v_mad_u32_u24 v167, v3, s81, v10
L_epmA0:
buffer_load_dwordx4 v8, s[36:39], s3 offen offset:1024 lds
v_exp_f32 v251, v251
v_add_f32 v248, 1.0, v248
v_add_f32 v249, 1.0, v249
v_add_f32 v250, 1.0, v250
v_add_f32 v251, 1.0, v251
v_rcp_f32 v248, v248
s_add_u32 m0, s13, 40960
s_add_u32 s3, s3, 589824
buffer_load_dwordx4 v7, s[36:39], s3 offen lds
v_rcp_f32 v249, v249
v_rcp_f32 v250, v250
v_rcp_f32 v251, v251
v_mul_f32 v248, v228, v248
v_mul_f32 v249, v229, v249
v_mul_f32 v250, v230, v250
buffer_load_dwordx4 v8, s[36:39], s3 offen offset:1024 lds
v_mul_f32 v251, v231, v251
v_cvt_pk_bf16_f32 v228, v248, v249
v_cvt_pk_bf16_f32 v229, v250, v251
v_mul_f32 v248, v232, v232
v_mul_f32 v249, v233, v233
v_mul_f32 v250, v234, v234
s_barrier
s_add_u32 m0, s13, 49152
s_add_u32 s3, s3, 589824
buffer_load_dwordx4 v7, s[36:39], s3 offen lds
v_mul_f32 v251, v235, v235
v_fmaak_f32 v248, v248, v11, 0xc0135761
v_fmaak_f32 v249, v249, v11, 0xc0135761
v_fmaak_f32 v250, v250, v11, 0xc0135761
v_fmaak_f32 v251, v251, v11, 0xc0135761
v_mul_f32 v248, v232, v248
buffer_load_dwordx4 v8, s[36:39], s3 offen offset:1024 lds
v_mul_f32 v249, v233, v249
v_mul_f32 v250, v234, v250
v_mul_f32 v251, v235, v251
v_exp_f32 v248, v248
v_exp_f32 v249, v249
v_exp_f32 v250, v250
s_add_u32 m0, s13, 57344
s_add_u32 s3, s3, 589824
buffer_load_dwordx4 v7, s[36:39], s3 offen lds
v_exp_f32 v251, v251
v_add_f32 v248, 1.0, v248
v_add_f32 v249, 1.0, v249
v_add_f32 v250, 1.0, v250
v_add_f32 v251, 1.0, v251
v_rcp_f32 v248, v248
s_lshl_b32 s84, s70, 9
s_add_u32 s84, s84, 157952
v_xor_b32 v171, 1, v3
s_cmp_lg_u32 s69, 0
s_cbranch_scc1 L_epvA1
v_cvt_pk_bf16_f32 v196, v196, v197
v_cvt_pk_bf16_f32 v197, v198, v199
s_mov_b32 s81, 8
v_mad_u32_u24 v164, v3, s81, v10
v_cvt_pk_bf16_f32 v200, v200, v201
v_cvt_pk_bf16_f32 v201, v202, v203
s_mov_b32 s81, 8
v_mad_u32_u24 v165, v3, s81, v10
s_branch L_epdA1
L_epvA1:
v_cvt_pk_bf16_f32 v196, v196, v197
v_cvt_pk_bf16_f32 v197, v198, v199
v_cvt_pk_bf16_f32 v198, v200, v201
v_cvt_pk_bf16_f32 v199, v202, v203
v_cvt_pk_bf16_f32 v200, v204, v205
v_cvt_pk_bf16_f32 v201, v206, v207
v_cvt_pk_bf16_f32 v202, v208, v209
v_cvt_pk_bf16_f32 v203, v210, v211
s_sub_u32 s81, s69, 1
s_lshl_b32 s81, s81, 5
v_add_u32 v168, s81, v2
v_mul_u32_u24 v169, 57, v168
v_lshrrev_b32 v169, 10, v169
v_mul_u32_u24 v170, 58, v169
v_add_u32 v170, v168, v170
v_cmp_lt_u32 s[26:27], 3, v169
v_mul_u32_u24 v169, 76, v168
v_subrev_u32 v169, 5454, v169
v_cndmask_b32 v170, v170, v169, s[26:27]
v_mov_b32 v169, 0x3f803f80
v_cndmask_b32 v196, v196, v169, s[26:27]
v_cndmask_b32 v197, v197, v169, s[26:27]
v_cndmask_b32 v198, v198, v169, s[26:27]
v_cndmask_b32 v199, v199, v169, s[26:27]
v_cndmask_b32 v200, v200, v169, s[26:27]
v_cndmask_b32 v201, v201, v169, s[26:27]
v_cndmask_b32 v202, v202, v169, s[26:27]
v_cndmask_b32 v203, v203, v169, s[26:27]
v_mad_u32_u24 v170, v3, 19, v170
v_lshlrev_b32 v170, 4, v170
v_lshrrev_b32 v168, 2, v168
v_cmp_lt_u32 s[26:27], 18, v168
v_mov_b32 v169, 0x7fffff00
s_nop 0
v_cndmask_b32 v170, v170, v169, s[26:27]
L_epdA1:
buffer_load_dwordx4 v8, s[36:39], s3 offen offset:1024 lds
v_rcp_f32 v249, v249
v_rcp_f32 v250, v250
v_rcp_f32 v251, v251
v_mul_f32 v248, v232, v248
v_mul_f32 v249, v233, v249
v_mul_f32 v250, v234, v250
s_waitcnt vmcnt(8)
s_barrier
s_add_u32 m0, s13, 65536
s_add_u32 s3, s3, 589824
buffer_load_dwordx4 v7, s[36:39], s3 offen lds
v_mul_f32 v251, v235, v251
v_cvt_pk_bf16_f32 v230, v248, v249
v_cvt_pk_bf16_f32 v231, v250, v251
v_mul_f32 v248, v236, v236
v_mul_f32 v249, v237, v237
v_mul_f32 v250, v238, v238
buffer_load_dwordx4 v8, s[36:39], s3 offen offset:1024 lds
v_mul_f32 v251, v239, v239
v_fmaak_f32 v248, v248, v11, 0xc0135761
v_fmaak_f32 v249, v249, v11, 0xc0135761
v_fmaak_f32 v250, v250, v11, 0xc0135761
v_fmaak_f32 v251, v251, v11, 0xc0135761
v_mul_f32 v248, v236, v248
s_add_u32 m0, s13, 73728
s_add_u32 s3, s3, 589824
buffer_load_dwordx4 v7, s[36:39], s3 offen lds
v_mul_f32 v249, v237, v249
v_mul_f32 v250, v238, v250
v_mul_f32 v251, v239, v251
v_exp_f32 v248, v248
v_exp_f32 v249, v249
v_exp_f32 v250, v250
buffer_load_dwordx4 v8, s[36:39], s3 offen offset:1024 lds
v_exp_f32 v251, v251
v_add_f32 v248, 1.0, v248
v_add_f32 v249, 1.0, v249
v_add_f32 v250, 1.0, v250
v_add_f32 v251, 1.0, v251
v_rcp_f32 v248, v248
s_waitcnt vmcnt(8)
s_barrier
s_add_u32 m0, s13, 0
s_add_u32 s3, s3, 589824
buffer_load_dwordx4 v7, s[36:39], s3 offen lds
v_rcp_f32 v249, v249
v_rcp_f32 v250, v250
v_rcp_f32 v251, v251
v_mul_f32 v248, v236, v248
v_mul_f32 v249, v237, v249
v_mul_f32 v250, v238, v250
buffer_load_dwordx4 v8, s[36:39], s3 offen offset:1024 lds
v_mul_f32 v251, v239, v251
v_cvt_pk_bf16_f32 v232, v248, v249
v_cvt_pk_bf16_f32 v233, v250, v251
s_add_u32 m0, s13, 8192
s_add_u32 s3, s3, 589824
buffer_load_dwordx4 v7, s[36:39], s3 offen lds
buffer_load_dwordx4 v8, s[36:39], s3 offen offset:1024 lds
s_lshl_b32 s85, s71, 6
s_lshl_b32 s81, s72, 1
s_add_u32 s85, s85, s81
s_add_u32 s85, s85, s70
s_mul_i32 s85, s85, 4608
s_cmp_eq_u32 s69, 1
s_cbranch_scc1 L_ep1A2
s_cmp_eq_u32 s69, 2
s_cbranch_scc1 L_ep2A2
s_cmp_eq_u32 s69, 3
s_cbranch_scc1 L_ep3A2
s_branch L_epmA2
L_ep1A2:
s_branch L_epmA2
L_ep2A2:
s_add_u32 s81, s85, 0
buffer_store_dwordx2 v[184:185], v165, s[56:59], s81 offen sc1
s_add_u32 s81, s85, 512
buffer_store_dwordx2 v[188:189], v166, s[56:59], s81 offen sc1
s_add_u32 s81, s85, 1024
buffer_store_dwordx2 v[192:193], v167, s[56:59], s81 offen sc1
s_branch L_epmA2
L_ep3A2:
s_add_u32 s81, s85, 1032
buffer_store_dwordx2 v[180:181], v164, s[56:59], s81 offen sc1
s_add_u32 s81, s85, 1544
buffer_store_dwordx2 v[184:185], v165, s[56:59], s81 offen sc1
s_add_u32 s81, s85, 2056
buffer_store_dwordx2 v[188:189], v166, s[56:59], s81 offen sc1
s_add_u32 s81, s85, 2568
buffer_store_dwordx2 v[192:193], v167, s[56:59], s81 offen sc1
L_epmA2:
s_cmp_lg_u32 s69, 0
s_cbranch_scc1 L_epvA2
s_add_u32 s81, s85, 3072
buffer_store_dwordx2 v[196:197], v164, s[56:59], s81 offen sc1
s_add_u32 s81, s85, 3584
buffer_store_dwordx2 v[200:201], v165, s[56:59], s81 offen sc1
s_branch L_epdA2
L_epvA2:
s_lshl_b32 s81, s71, 6
s_lshl_b32 s83, s72, 1
s_add_u32 s81, s81, s83
s_add_u32 s81, s81, s70
s_mul_i32 s81, s81, 4864
s_add_u32 s81, s81, 4194304
buffer_store_dwordx4 v[196:199], v170, s[56:59], s81 offen sc1
buffer_store_dwordx4 v[200:203], v170, s[56:59], s81 offen offset:608 sc1
L_epdA2:
s_waitcnt lgkmcnt(0)
buffer_load_dword v246, off, s[44:47], 0 sc1
s_lshl_b32 s82, s6, 1
v_add_u32 v254, s82, v13
ds_read_b128 v[196:199], v254 offset:0
ds_read_b128 v[200:203], v254 offset:32
ds_read_b128 v[204:207], v254 offset:64
ds_read_b128 v[208:211], v254 offset:96
ds_read_b64_tr_b16 v[212:213], v5 offset:32768
ds_read_b64_tr_b16 v[214:215], v5 offset:33280
ds_read_b64_tr_b16 v[216:217], v5 offset:34816
ds_read_b64_tr_b16 v[218:219], v5 offset:35328
ds_read_b64_tr_b16 v[220:221], v5 offset:36864
ds_read_b64_tr_b16 v[222:223], v5 offset:37376
s_waitcnt vmcnt(11)
s_barrier
s_waitcnt lgkmcnt(6)
s_waitcnt lgkmcnt(4)
v_mfma_f32_32x32x16_bf16 v[196:211], v[212:215], v[16:19], v[196:211]
ds_read_b64_tr_b16 v[224:225], v5 offset:38912
ds_read_b64_tr_b16 v[226:227], v5 offset:39424
s_waitcnt lgkmcnt(4)
v_mfma_f32_32x32x16_bf16 v[196:211], v[216:219], v[20:23], v[196:211]
ds_read_b64_tr_b16 v[212:213], v5 offset:40960
ds_read_b64_tr_b16 v[214:215], v5 offset:41472
s_waitcnt lgkmcnt(4)
v_mfma_f32_32x32x16_bf16 v[196:211], v[220:223], v[24:27], v[196:211]
ds_read_b64_tr_b16 v[216:217], v5 offset:43008
ds_read_b64_tr_b16 v[218:219], v5 offset:43520
s_waitcnt lgkmcnt(4)
v_mfma_f32_32x32x16_bf16 v[196:211], v[224:227], v[28:31], v[196:211]
ds_read_b64_tr_b16 v[220:221], v5 offset:45056
ds_read_b64_tr_b16 v[222:223], v5 offset:45568
s_waitcnt lgkmcnt(4)
v_mfma_f32_32x32x16_bf16 v[196:211], v[212:215], v[32:35], v[196:211]
ds_read_b64_tr_b16 v[224:225], v5 offset:47104
ds_read_b64_tr_b16 v[226:227], v5 offset:47616
s_waitcnt lgkmcnt(4)
v_mfma_f32_32x32x16_bf16 v[196:211], v[216:219], v[36:39], v[196:211]
ds_read_b64_tr_b16 v[212:213], v5 offset:49152
ds_read_b64_tr_b16 v[214:215], v5 offset:49664
s_waitcnt lgkmcnt(4)
v_mfma_f32_32x32x16_bf16 v[196:211], v[220:223], v[40:43], v[196:211]
ds_read_b64_tr_b16 v[216:217], v5 offset:51200
ds_read_b64_tr_b16 v[218:219], v5 offset:51712
s_waitcnt lgkmcnt(4)
v_mfma_f32_32x32x16_bf16 v[196:211], v[224:227], v[44:47], v[196:211]
ds_read_b64_tr_b16 v[220:221], v5 offset:53248
ds_read_b64_tr_b16 v[222:223], v5 offset:53760
s_waitcnt vmcnt(7) lgkmcnt(4)
s_barrier
v_mfma_f32_32x32x16_bf16 v[196:211], v[212:215], v[48:51], v[196:211]
ds_read_b64_tr_b16 v[224:225], v5 offset:55296
ds_read_b64_tr_b16 v[226:227], v5 offset:55808
s_waitcnt lgkmcnt(4)
v_mfma_f32_32x32x16_bf16 v[196:211], v[216:219], v[52:55], v[196:211]
ds_read_b64_tr_b16 v[212:213], v5 offset:57344
ds_read_b64_tr_b16 v[214:215], v5 offset:57856
s_waitcnt lgkmcnt(4)
v_mfma_f32_32x32x16_bf16 v[196:211], v[220:223], v[56:59], v[196:211]
ds_read_b64_tr_b16 v[216:217], v5 offset:59392
ds_read_b64_tr_b16 v[218:219], v5 offset:59904
s_waitcnt lgkmcnt(4)
v_mfma_f32_32x32x16_bf16 v[196:211], v[224:227], v[60:63], v[196:211]
ds_read_b64_tr_b16 v[220:221], v5 offset:61440
ds_read_b64_tr_b16 v[222:223], v5 offset:61952
s_waitcnt lgkmcnt(4)
v_mfma_f32_32x32x16_bf16 v[196:211], v[212:215], v[64:67], v[196:211]
ds_read_b64_tr_b16 v[224:225], v5 offset:63488
ds_read_b64_tr_b16 v[226:227], v5 offset:64000
s_waitcnt lgkmcnt(4)
v_mfma_f32_32x32x16_bf16 v[196:211], v[216:219], v[68:71], v[196:211]
ds_read_b64_tr_b16 v[212:213], v6 offset:0
ds_read_b64_tr_b16 v[214:215], v6 offset:512
s_waitcnt lgkmcnt(4)
v_mfma_f32_32x32x16_bf16 v[196:211], v[220:223], v[72:75], v[196:211]
ds_read_b64_tr_b16 v[216:217], v6 offset:2048
ds_read_b64_tr_b16 v[218:219], v6 offset:2560
s_waitcnt lgkmcnt(4)
v_mfma_f32_32x32x16_bf16 v[196:211], v[224:227], v[76:79], v[196:211]
ds_read_b64_tr_b16 v[220:221], v6 offset:4096
ds_read_b64_tr_b16 v[222:223], v6 offset:4608
s_waitcnt vmcnt(3) lgkmcnt(4)
s_barrier
v_mfma_f32_32x32x16_bf16 v[196:211], v[212:215], v[80:83], v[196:211]
ds_read_b64_tr_b16 v[224:225], v6 offset:6144
ds_read_b64_tr_b16 v[226:227], v6 offset:6656
s_waitcnt lgkmcnt(4)
v_mfma_f32_32x32x16_bf16 v[196:211], v[216:219], v[84:87], v[196:211]
ds_read_b64_tr_b16 v[212:213], v6 offset:8192
ds_read_b64_tr_b16 v[214:215], v6 offset:8704
s_waitcnt lgkmcnt(4)
v_mfma_f32_32x32x16_bf16 v[196:211], v[220:223], v[88:91], v[196:211]
ds_read_b64_tr_b16 v[216:217], v6 offset:10240
ds_read_b64_tr_b16 v[218:219], v6 offset:10752
s_waitcnt lgkmcnt(4)
v_mfma_f32_32x32x16_bf16 v[196:211], v[224:227], v[92:95], v[196:211]
ds_read_b64_tr_b16 v[220:221], v6 offset:12288
ds_read_b64_tr_b16 v[222:223], v6 offset:12800
s_waitcnt lgkmcnt(4)
v_mfma_f32_32x32x16_bf16 v[196:211], v[212:215], v[96:99], v[196:211]
ds_read_b64_tr_b16 v[224:225], v6 offset:14336
ds_read_b64_tr_b16 v[226:227], v6 offset:14848
s_waitcnt lgkmcnt(4)
v_mfma_f32_32x32x16_bf16 v[196:211], v[216:219], v[100:103], v[196:211]
ds_read_b64_tr_b16 v[212:213], v5 offset:0
ds_read_b64_tr_b16 v[214:215], v5 offset:512
s_waitcnt lgkmcnt(4)
v_mfma_f32_32x32x16_bf16 v[196:211], v[220:223], v[104:107], v[196:211]
ds_read_b64_tr_b16 v[216:217], v5 offset:2048
ds_read_b64_tr_b16 v[218:219], v5 offset:2560
s_waitcnt lgkmcnt(4)
v_mfma_f32_32x32x16_bf16 v[196:211], v[224:227], v[108:111], v[196:211]
ds_read_b64_tr_b16 v[220:221], v5 offset:4096
ds_read_b64_tr_b16 v[222:223], v5 offset:4608
s_waitcnt lgkmcnt(4)
s_barrier
v_mfma_f32_32x32x16_bf16 v[196:211], v[212:215], v[112:115], v[196:211]
ds_read_b64_tr_b16 v[224:225], v5 offset:6144
ds_read_b64_tr_b16 v[226:227], v5 offset:6656
s_waitcnt lgkmcnt(4)
v_mfma_f32_32x32x16_bf16 v[196:211], v[216:219], v[116:119], v[196:211]
ds_read_b64_tr_b16 v[212:213], v5 offset:8192
ds_read_b64_tr_b16 v[214:215], v5 offset:8704
s_waitcnt lgkmcnt(4)
v_mfma_f32_32x32x16_bf16 v[196:211], v[220:223], v[120:123], v[196:211]
ds_read_b64_tr_b16 v[216:217], v5 offset:10240
ds_read_b64_tr_b16 v[218:219], v5 offset:10752
s_waitcnt lgkmcnt(4)
v_mfma_f32_32x32x16_bf16 v[196:211], v[224:227], v[124:127], v[196:211]
ds_read_b64_tr_b16 v[220:221], v5 offset:12288
ds_read_b64_tr_b16 v[222:223], v5 offset:12800
s_waitcnt lgkmcnt(4)
v_mfma_f32_32x32x16_bf16 v[196:211], v[212:215], v[128:131], v[196:211]
ds_read_b64_tr_b16 v[224:225], v5 offset:14336
ds_read_b64_tr_b16 v[226:227], v5 offset:14848
s_waitcnt lgkmcnt(4)
v_mfma_f32_32x32x16_bf16 v[196:211], v[216:219], v[132:135], v[196:211]
ds_read_b64_tr_b16 v[212:213], v5 offset:16384
ds_read_b64_tr_b16 v[214:215], v5 offset:16896
s_waitcnt lgkmcnt(4)
v_mfma_f32_32x32x16_bf16 v[196:211], v[220:223], v[136:139], v[196:211]
ds_read_b64_tr_b16 v[216:217], v5 offset:18432
ds_read_b64_tr_b16 v[218:219], v5 offset:18944
s_waitcnt lgkmcnt(4)
v_mfma_f32_32x32x16_bf16 v[196:211], v[224:227], v[140:143], v[196:211]
ds_read_b64_tr_b16 v[220:221], v5 offset:20480
ds_read_b64_tr_b16 v[222:223], v5 offset:20992
s_waitcnt lgkmcnt(4)
s_barrier
v_mfma_f32_32x32x16_bf16 v[196:211], v[212:215], v[144:147], v[196:211]
ds_read_b64_tr_b16 v[224:225], v5 offset:22528
ds_read_b64_tr_b16 v[226:227], v5 offset:23040
s_waitcnt lgkmcnt(4)
v_mfma_f32_32x32x16_bf16 v[196:211], v[216:219], v[148:151], v[196:211]
s_waitcnt lgkmcnt(2)
v_mfma_f32_32x32x16_bf16 v[196:211], v[220:223], v[152:155], v[196:211]
s_waitcnt lgkmcnt(0)
v_mfma_f32_32x32x16_bf16 v[196:211], v[224:227], v[156:159], v[196:211]
s_add_u32 m0, s13, 8192
s_add_u32 s3, s7, s74
s_add_u32 s3, s3, 4718592
buffer_load_dwordx4 v7, s[36:39], s3 offen lds
s_nop 7
s_nop 3
v_mul_f32 v248, v240, v240
v_mul_f32 v249, v241, v241
v_mul_f32 v250, v242, v242
v_mul_f32 v251, v243, v243
buffer_load_dwordx4 v8, s[36:39], s3 offen offset:1024 lds
v_fmaak_f32 v248, v248, v11, 0xc0135761
v_fmaak_f32 v249, v249, v11, 0xc0135761
v_fmaak_f32 v250, v250, v11, 0xc0135761
v_fmaak_f32 v251, v251, v11, 0xc0135761
v_mul_f32 v248, v240, v248
v_mul_f32 v249, v241, v249
v_mul_f32 v250, v242, v250
v_mul_f32 v251, v243, v251
s_waitcnt vmcnt(2)
s_mov_b32 s85, 0
L_p1:
v_readfirstlane_b32 s96, v246
s_cmp_lg_u32 s96, 0
s_cbranch_scc1 L_pd1
s_sleep 1
buffer_load_dword v246, off, s[44:47], 0 sc1
s_waitcnt vmcnt(0)
s_add_u32 s85, s85, 1
s_cmp_lt_u32 s85, 0x100000
s_cbranch_scc1 L_p1
L_pd1:
s_barrier
s_add_u32 m0, s13, 16384
s_add_u32 s3, s8, s74
buffer_load_dwordx4 v7, s[36:39], s3 offen lds
v_exp_f32 v248, v248
v_exp_f32 v249, v249
v_exp_f32 v250, v250
v_exp_f32 v251, v251
v_add_f32 v248, 1.0, v248
v_add_f32 v249, 1.0, v249
v_add_f32 v250, 1.0, v250
v_add_f32 v251, 1.0, v251
buffer_load_dwordx4 v8, s[36:39], s3 offen offset:1024 lds
v_rcp_f32 v248, v248
v_rcp_f32 v249, v249
v_rcp_f32 v250, v250
v_rcp_f32 v251, v251
v_mul_f32 v248, v240, v248
v_mul_f32 v249, v241, v249
v_mul_f32 v250, v242, v250
v_mul_f32 v251, v243, v251
s_add_u32 m0, s13, 24576
s_add_u32 s3, s3, 589824
buffer_load_dwordx4 v7, s[36:39], s3 offen lds
v_cvt_pk_bf16_f32 v234, v248, v249
v_cvt_pk_bf16_f32 v235, v250, v251
s_lshl_b32 s82, s4, 5
v_add_u32 v255, s82, v12
ds_write_b128 v255, v[228:231] offset:0
ds_write_b128 v255, v[232:235] offset:1024
v_mul_f32 v248, v196, v196
v_mul_f32 v249, v197, v197
buffer_load_dwordx4 v8, s[36:39], s3 offen offset:1024 lds
v_mul_f32 v250, v198, v198
v_mul_f32 v251, v199, v199
v_fmaak_f32 v248, v248, v11, 0xc0135761
v_fmaak_f32 v249, v249, v11, 0xc0135761
v_fmaak_f32 v250, v250, v11, 0xc0135761
v_fmaak_f32 v251, v251, v11, 0xc0135761
v_mul_f32 v248, v196, v248
v_mul_f32 v249, v197, v249
s_barrier
s_add_u32 m0, s13, 32768
s_add_u32 s3, s3, 589824
buffer_load_dwordx4 v7, s[36:39], s3 offen lds
v_mul_f32 v250, v198, v250
v_mul_f32 v251, v199, v251
v_exp_f32 v248, v248
v_exp_f32 v249, v249
v_exp_f32 v250, v250
v_exp_f32 v251, v251
v_add_f32 v248, 1.0, v248
v_add_f32 v249, 1.0, v249
buffer_load_dwordx4 v8, s[36:39], s3 offen offset:1024 lds
v_add_f32 v250, 1.0, v250
v_add_f32 v251, 1.0, v251
v_rcp_f32 v248, v248
v_rcp_f32 v249, v249
v_rcp_f32 v250, v250
v_rcp_f32 v251, v251
v_mul_f32 v248, v196, v248
v_mul_f32 v249, v197, v249
s_add_u32 m0, s13, 40960
s_add_u32 s3, s3, 589824
buffer_load_dwordx4 v7, s[36:39], s3 offen lds
v_mul_f32 v250, v198, v250
v_mul_f32 v251, v199, v251
v_cvt_pk_bf16_f32 v196, v248, v249
v_cvt_pk_bf16_f32 v197, v250, v251
v_mul_f32 v248, v200, v200
v_mul_f32 v249, v201, v201
v_mul_f32 v250, v202, v202
v_mul_f32 v251, v203, v203
buffer_load_dwordx4 v8, s[36:39], s3 offen offset:1024 lds
v_fmaak_f32 v248, v248, v11, 0xc0135761
v_fmaak_f32 v249, v249, v11, 0xc0135761
v_fmaak_f32 v250, v250, v11, 0xc0135761
v_fmaak_f32 v251, v251, v11, 0xc0135761
v_mul_f32 v248, v200, v248
v_mul_f32 v249, v201, v249
v_mul_f32 v250, v202, v250
v_mul_f32 v251, v203, v251
s_waitcnt vmcnt(8)
s_barrier
s_add_u32 m0, s13, 49152
s_add_u32 s3, s3, 589824
buffer_load_dwordx4 v7, s[36:39], s3 offen lds
v_exp_f32 v248, v248
v_exp_f32 v249, v249
v_exp_f32 v250, v250
v_exp_f32 v251, v251
v_add_f32 v248, 1.0, v248
v_add_f32 v249, 1.0, v249
v_add_f32 v250, 1.0, v250
v_add_f32 v251, 1.0, v251
buffer_load_dwordx4 v8, s[36:39], s3 offen offset:1024 lds
v_rcp_f32 v248, v248
v_rcp_f32 v249, v249
v_rcp_f32 v250, v250
v_rcp_f32 v251, v251
v_mul_f32 v248, v200, v248
v_mul_f32 v249, v201, v249
v_mul_f32 v250, v202, v250
v_mul_f32 v251, v203, v251
s_add_u32 m0, s13, 57344
s_add_u32 s3, s3, 589824
buffer_load_dwordx4 v7, s[36:39], s3 offen lds
v_cvt_pk_bf16_f32 v198, v248, v249
v_cvt_pk_bf16_f32 v199, v250, v251
v_mul_f32 v248, v204, v204
v_mul_f32 v249, v205, v205
v_mul_f32 v250, v206, v206
v_mul_f32 v251, v207, v207
v_fmaak_f32 v248, v248, v11, 0xc0135761
v_fmaak_f32 v249, v249, v11, 0xc0135761
buffer_load_dwordx4 v8, s[36:39], s3 offen offset:1024 lds
v_fmaak_f32 v250, v250, v11, 0xc0135761
v_fmaak_f32 v251, v251, v11, 0xc0135761
v_mul_f32 v248, v204, v248
v_mul_f32 v249, v205, v249
v_mul_f32 v250, v206, v250
v_mul_f32 v251, v207, v251
v_exp_f32 v248, v248
v_exp_f32 v249, v249
s_lshl_b32 s82, s69, 10
s_add_u32 s82, s82, s20
v_add_u32 v254, s82, v9
s_lshl_b32 s82, s70, 9
s_add_u32 s82, s82, 157952
v_add_u32 v253, s82, v10
ds_read_b128 v[180:183], v254
ds_read_b128 v[184:187], v253
s_waitcnt vmcnt(8)
s_barrier
s_add_u32 m0, s13, 65536
s_add_u32 s3, s3, 589824
buffer_load_dwordx4 v7, s[36:39], s3 offen lds
v_exp_f32 v250, v250
v_exp_f32 v251, v251
v_add_f32 v248, 1.0, v248
v_add_f32 v249, 1.0, v249
v_add_f32 v250, 1.0, v250
v_add_f32 v251, 1.0, v251
v_rcp_f32 v248, v248
v_rcp_f32 v249, v249
buffer_load_dwordx4 v8, s[36:39], s3 offen offset:1024 lds
v_rcp_f32 v250, v250
v_rcp_f32 v251, v251
v_mul_f32 v248, v204, v248
v_mul_f32 v249, v205, v249
s_lshl_b32 s82, s8, 1
v_add_u32 v254, s82, v13
ds_read_b128 v[228:231], v254 offset:0
ds_read_b128 v[232:235], v254 offset:32
ds_read_b128 v[236:239], v254 offset:64
ds_read_b128 v[240:243], v254 offset:96
ds_read_b64_tr_b16 v[212:213], v5 offset:16384
ds_read_b64_tr_b16 v[214:215], v5 offset:16896
ds_read_b64_tr_b16 v[216:217], v5 offset:18432
ds_read_b64_tr_b16 v[218:219], v5 offset:18944
ds_read_b64_tr_b16 v[220:221], v5 offset:20480
ds_read_b64_tr_b16 v[222:223], v5 offset:20992
v_mul_f32 v250, v206, v250
v_mul_f32 v251, v207, v251
v_cvt_pk_bf16_f32 v200, v248, v249
v_cvt_pk_bf16_f32 v201, v250, v251
s_add_u32 m0, s13, 73728
s_add_u32 s3, s3, 589824
buffer_load_dwordx4 v7, s[36:39], s3 offen lds
v_mul_f32 v248, v208, v208
v_mul_f32 v249, v209, v209
v_mul_f32 v250, v210, v210
v_mul_f32 v251, v211, v211
v_fmaak_f32 v248, v248, v11, 0xc0135761
v_fmaak_f32 v249, v249, v11, 0xc0135761
v_fmaak_f32 v250, v250, v11, 0xc0135761
v_fmaak_f32 v251, v251, v11, 0xc0135761
buffer_load_dwordx4 v8, s[36:39], s3 offen offset:1024 lds
v_mul_f32 v248, v208, v248
v_mul_f32 v249, v209, v249
v_mul_f32 v250, v210, v250
v_mul_f32 v251, v211, v251
v_mov_b32 v246, s96
s_lshl_b32 s82, s71, 5
s_add_u32 s82, s82, s72
s_lshl_b32 s82, s82, 2
s_add_u32 s82, s82, 9437184
s_cmp_eq_u32 s68, 0
s_cselect_b32 s82, s82, 0x7ff00000
v_mov_b32 v247, s82
s_mov_b64 exec, 1
buffer_store_dword v246, v247, s[56:59], 0 offen sc1
s_mov_b64 exec, -1
s_waitcnt vmcnt(9)
s_barrier
s_waitcnt lgkmcnt(6)
s_waitcnt lgkmcnt(4)
v_mfma_f32_32x32x16_bf16 v[228:243], v[212:215], v[16:19], v[228:243]
ds_read_b64_tr_b16 v[224:225], v5 offset:22528
ds_read_b64_tr_b16 v[226:227], v5 offset:23040
s_waitcnt lgkmcnt(4)
v_mfma_f32_32x32x16_bf16 v[228:243], v[216:219], v[20:23], v[228:243]
ds_read_b64_tr_b16 v[212:213], v5 offset:24576
ds_read_b64_tr_b16 v[214:215], v5 offset:25088
s_waitcnt lgkmcnt(4)
v_mfma_f32_32x32x16_bf16 v[228:243], v[220:223], v[24:27], v[228:243]
ds_read_b64_tr_b16 v[216:217], v5 offset:26624
ds_read_b64_tr_b16 v[218:219], v5 offset:27136
s_waitcnt lgkmcnt(4)
v_mfma_f32_32x32x16_bf16 v[228:243], v[224:227], v[28:31], v[228:243]
ds_read_b64_tr_b16 v[220:221], v5 offset:28672
ds_read_b64_tr_b16 v[222:223], v5 offset:29184
s_waitcnt lgkmcnt(4)
v_mfma_f32_32x32x16_bf16 v[228:243], v[212:215], v[32:35], v[228:243]
ds_read_b64_tr_b16 v[224:225], v5 offset:30720
ds_read_b64_tr_b16 v[226:227], v5 offset:31232
s_waitcnt lgkmcnt(4)
v_mfma_f32_32x32x16_bf16 v[228:243], v[216:219], v[36:39], v[228:243]
ds_read_b64_tr_b16 v[212:213], v5 offset:32768
ds_read_b64_tr_b16 v[214:215], v5 offset:33280
s_waitcnt lgkmcnt(4)
v_mfma_f32_32x32x16_bf16 v[228:243], v[220:223], v[40:43], v[228:243]
ds_read_b64_tr_b16 v[216:217], v5 offset:34816
ds_read_b64_tr_b16 v[218:219], v5 offset:35328
s_waitcnt lgkmcnt(4)
v_mfma_f32_32x32x16_bf16 v[228:243], v[224:227], v[44:47], v[228:243]
ds_read_b64_tr_b16 v[220:221], v5 offset:36864
ds_read_b64_tr_b16 v[222:223], v5 offset:37376
s_waitcnt vmcnt(5) lgkmcnt(4)
s_barrier
v_mfma_f32_32x32x16_bf16 v[228:243], v[212:215], v[48:51], v[228:243]
ds_read_b64_tr_b16 v[224:225], v5 offset:38912
ds_read_b64_tr_b16 v[226:227], v5 offset:39424
s_waitcnt lgkmcnt(4)
v_mfma_f32_32x32x16_bf16 v[228:243], v[216:219], v[52:55], v[228:243]
ds_read_b64_tr_b16 v[212:213], v5 offset:40960
ds_read_b64_tr_b16 v[214:215], v5 offset:41472
s_waitcnt lgkmcnt(4)
v_mfma_f32_32x32x16_bf16 v[228:243], v[220:223], v[56:59], v[228:243]
ds_read_b64_tr_b16 v[216:217], v5 offset:43008
ds_read_b64_tr_b16 v[218:219], v5 offset:43520
s_waitcnt lgkmcnt(4)
v_mfma_f32_32x32x16_bf16 v[228:243], v[224:227], v[60:63], v[228:243]
ds_read_b64_tr_b16 v[220:221], v5 offset:45056
ds_read_b64_tr_b16 v[222:223], v5 offset:45568
s_waitcnt lgkmcnt(4)
v_mfma_f32_32x32x16_bf16 v[228:243], v[212:215], v[64:67], v[228:243]
ds_read_b64_tr_b16 v[224:225], v5 offset:47104
ds_read_b64_tr_b16 v[226:227], v5 offset:47616
s_waitcnt lgkmcnt(4)
v_mfma_f32_32x32x16_bf16 v[228:243], v[216:219], v[68:71], v[228:243]
ds_read_b64_tr_b16 v[212:213], v5 offset:49152
ds_read_b64_tr_b16 v[214:215], v5 offset:49664
s_waitcnt lgkmcnt(4)
v_mfma_f32_32x32x16_bf16 v[228:243], v[220:223], v[72:75], v[228:243]
ds_read_b64_tr_b16 v[216:217], v5 offset:51200
ds_read_b64_tr_b16 v[218:219], v5 offset:51712
s_waitcnt lgkmcnt(4)
v_mfma_f32_32x32x16_bf16 v[228:243], v[224:227], v[76:79], v[228:243]
ds_read_b64_tr_b16 v[220:221], v5 offset:53248
ds_read_b64_tr_b16 v[222:223], v5 offset:53760
s_waitcnt vmcnt(1) lgkmcnt(4)
s_barrier
v_mfma_f32_32x32x16_bf16 v[228:243], v[212:215], v[80:83], v[228:243]
ds_read_b64_tr_b16 v[224:225], v5 offset:55296
ds_read_b64_tr_b16 v[226:227], v5 offset:55808
s_waitcnt lgkmcnt(4)
v_mfma_f32_32x32x16_bf16 v[228:243], v[216:219], v[84:87], v[228:243]
ds_read_b64_tr_b16 v[212:213], v5 offset:57344
ds_read_b64_tr_b16 v[214:215], v5 offset:57856
s_waitcnt lgkmcnt(4)
v_mfma_f32_32x32x16_bf16 v[228:243], v[220:223], v[88:91], v[228:243]
ds_read_b64_tr_b16 v[216:217], v5 offset:59392
ds_read_b64_tr_b16 v[218:219], v5 offset:59904
s_waitcnt lgkmcnt(4)
v_mfma_f32_32x32x16_bf16 v[228:243], v[224:227], v[92:95], v[228:243]
ds_read_b64_tr_b16 v[220:221], v5 offset:61440
ds_read_b64_tr_b16 v[222:223], v5 offset:61952
s_waitcnt lgkmcnt(4)
v_mfma_f32_32x32x16_bf16 v[228:243], v[212:215], v[96:99], v[228:243]
ds_read_b64_tr_b16 v[224:225], v5 offset:63488
ds_read_b64_tr_b16 v[226:227], v5 offset:64000
s_waitcnt lgkmcnt(4)
v_mfma_f32_32x32x16_bf16 v[228:243], v[216:219], v[100:103], v[228:243]
ds_read_b64_tr_b16 v[212:213], v6 offset:0
ds_read_b64_tr_b16 v[214:215], v6 offset:512
s_waitcnt lgkmcnt(4)
v_mfma_f32_32x32x16_bf16 v[228:243], v[220:223], v[104:107], v[228:243]
ds_read_b64_tr_b16 v[216:217], v6 offset:2048
ds_read_b64_tr_b16 v[218:219], v6 offset:2560
s_waitcnt lgkmcnt(4)
v_mfma_f32_32x32x16_bf16 v[228:243], v[224:227], v[108:111], v[228:243]
ds_read_b64_tr_b16 v[220:221], v6 offset:4096
ds_read_b64_tr_b16 v[222:223], v6 offset:4608
s_waitcnt lgkmcnt(4)
s_barrier
v_mfma_f32_32x32x16_bf16 v[228:243], v[212:215], v[112:115], v[228:243]
ds_read_b64_tr_b16 v[224:225], v6 offset:6144
ds_read_b64_tr_b16 v[226:227], v6 offset:6656
s_waitcnt lgkmcnt(4)
v_mfma_f32_32x32x16_bf16 v[228:243], v[216:219], v[116:119], v[228:243]
ds_read_b64_tr_b16 v[212:213], v6 offset:8192
ds_read_b64_tr_b16 v[214:215], v6 offset:8704
s_waitcnt lgkmcnt(4)
v_mfma_f32_32x32x16_bf16 v[228:243], v[220:223], v[120:123], v[228:243]
ds_read_b64_tr_b16 v[216:217], v6 offset:10240
ds_read_b64_tr_b16 v[218:219], v6 offset:10752
s_waitcnt lgkmcnt(4)
v_mfma_f32_32x32x16_bf16 v[228:243], v[224:227], v[124:127], v[228:243]
ds_read_b64_tr_b16 v[220:221], v6 offset:12288
ds_read_b64_tr_b16 v[222:223], v6 offset:12800
s_waitcnt lgkmcnt(4)
v_mfma_f32_32x32x16_bf16 v[228:243], v[212:215], v[128:131], v[228:243]
ds_read_b64_tr_b16 v[224:225], v6 offset:14336
ds_read_b64_tr_b16 v[226:227], v6 offset:14848
s_waitcnt lgkmcnt(4)
v_mfma_f32_32x32x16_bf16 v[228:243], v[216:219], v[132:135], v[228:243]
ds_read_b64_tr_b16 v[212:213], v5 offset:0
ds_read_b64_tr_b16 v[214:215], v5 offset:512
s_waitcnt lgkmcnt(4)
v_mfma_f32_32x32x16_bf16 v[228:243], v[220:223], v[136:139], v[228:243]
ds_read_b64_tr_b16 v[216:217], v5 offset:2048
ds_read_b64_tr_b16 v[218:219], v5 offset:2560
s_waitcnt lgkmcnt(4)
v_mfma_f32_32x32x16_bf16 v[228:243], v[224:227], v[140:143], v[228:243]
ds_read_b64_tr_b16 v[220:221], v5 offset:4096
ds_read_b64_tr_b16 v[222:223], v5 offset:4608
s_waitcnt lgkmcnt(4)
s_barrier
v_mfma_f32_32x32x16_bf16 v[228:243], v[212:215], v[144:147], v[228:243]
ds_read_b64_tr_b16 v[224:225], v5 offset:6144
ds_read_b64_tr_b16 v[226:227], v5 offset:6656
s_waitcnt lgkmcnt(4)
v_mfma_f32_32x32x16_bf16 v[228:243], v[216:219], v[148:151], v[228:243]
s_waitcnt lgkmcnt(2)
v_mfma_f32_32x32x16_bf16 v[228:243], v[220:223], v[152:155], v[228:243]
s_waitcnt lgkmcnt(0)
v_mfma_f32_32x32x16_bf16 v[228:243], v[224:227], v[156:159], v[228:243]
s_add_u32 m0, s13, 73728
s_add_u32 s3, s9, s74
s_add_u32 s3, s3, 4718592
buffer_load_dwordx4 v7, s[36:39], s3 offen lds
s_nop 7
s_nop 3
v_exp_f32 v248, v248
v_exp_f32 v249, v249
v_exp_f32 v250, v250
v_exp_f32 v251, v251
buffer_load_dwordx4 v8, s[36:39], s3 offen offset:1024 lds
v_add_f32 v248, 1.0, v248
v_add_f32 v249, 1.0, v249
v_add_f32 v250, 1.0, v250
v_add_f32 v251, 1.0, v251
v_rcp_f32 v248, v248
v_rcp_f32 v249, v249
v_rcp_f32 v250, v250
v_rcp_f32 v251, v251
s_barrier
s_add_u32 m0, s13, 0
s_add_u32 s3, s10, s74
buffer_load_dwordx4 v7, s[36:39], s3 offen lds
v_mul_f32 v248, v208, v248
v_mul_f32 v249, v209, v249
v_mul_f32 v250, v210, v250
v_mul_f32 v251, v211, v251
v_cvt_pk_bf16_f32 v202, v248, v249
v_cvt_pk_bf16_f32 v203, v250, v251
s_lshl_b32 s82, s6, 5
v_add_u32 v255, s82, v12
buffer_load_dwordx4 v8, s[36:39], s3 offen offset:1024 lds
ds_write_b128 v255, v[196:199] offset:0
ds_write_b128 v255, v[200:203] offset:1024
v_mul_f32 v248, v228, v228
v_mul_f32 v249, v229, v229
v_mul_f32 v250, v230, v230
v_mul_f32 v251, v231, v231
v_fmaak_f32 v248, v248, v11, 0xc0135761
v_fmaak_f32 v249, v249, v11, 0xc0135761
s_add_u32 m0, s13, 8192
s_add_u32 s3, s3, 589824
buffer_load_dwordx4 v7, s[36:39], s3 offen lds
v_fmaak_f32 v250, v250, v11, 0xc0135761
v_fmaak_f32 v251, v251, v11, 0xc0135761
v_mul_f32 v248, v228, v248
v_mul_f32 v249, v229, v249
v_mul_f32 v250, v230, v250
v_mul_f32 v251, v231, v251
v_exp_f32 v248, v248
v_exp_f32 v249, v249
buffer_load_dwordx4 v8, s[36:39], s3 offen offset:1024 lds
v_exp_f32 v250, v250
v_exp_f32 v251, v251
v_add_f32 v248, 1.0, v248
v_add_f32 v249, 1.0, v249
v_add_f32 v250, 1.0, v250
v_add_f32 v251, 1.0, v251
v_rcp_f32 v248, v248
v_rcp_f32 v249, v249
s_barrier
s_add_u32 m0, s13, 16384
s_add_u32 s3, s3, 589824
buffer_load_dwordx4 v7, s[36:39], s3 offen lds
v_rcp_f32 v250, v250
v_rcp_f32 v251, v251
v_mul_f32 v248, v228, v248
v_mul_f32 v249, v229, v249
v_mul_f32 v250, v230, v250
v_mul_f32 v251, v231, v251
v_cvt_pk_bf16_f32 v228, v248, v249
v_cvt_pk_bf16_f32 v229, v250, v251
buffer_load_dwordx4 v8, s[36:39], s3 offen offset:1024 lds
v_mul_f32 v248, v232, v232
v_mul_f32 v249, v233, v233
v_mul_f32 v250, v234, v234
v_mul_f32 v251, v235, v235
v_fmaak_f32 v248, v248, v11, 0xc0135761
v_fmaak_f32 v249, v249, v11, 0xc0135761
v_fmaak_f32 v250, v250, v11, 0xc0135761
v_fmaak_f32 v251, v251, v11, 0xc0135761
s_add_u32 m0, s13, 24576
s_add_u32 s3, s3, 589824
buffer_load_dwordx4 v7, s[36:39], s3 offen lds
v_mul_f32 v248, v232, v248
v_mul_f32 v249, v233, v249
v_mul_f32 v250, v234, v250
v_mul_f32 v251, v235, v251
v_exp_f32 v248, v248
v_exp_f32 v249, v249
v_exp_f32 v250, v250
v_exp_f32 v251, v251
buffer_load_dwordx4 v8, s[36:39], s3 offen offset:1024 lds
v_add_f32 v248, 1.0, v248
v_add_f32 v249, 1.0, v249
v_add_f32 v250, 1.0, v250
v_add_f32 v251, 1.0, v251
v_rcp_f32 v248, v248
v_rcp_f32 v249, v249
v_rcp_f32 v250, v250
v_rcp_f32 v251, v251
s_waitcnt vmcnt(8)
s_barrier
s_add_u32 m0, s13, 32768
s_add_u32 s3, s3, 589824
buffer_load_dwordx4 v7, s[36:39], s3 offen lds
v_mul_f32 v248, v232, v248
v_mul_f32 v249, v233, v249
v_mul_f32 v250, v234, v250
v_mul_f32 v251, v235, v251
v_cvt_pk_bf16_f32 v230, v248, v249
v_cvt_pk_bf16_f32 v231, v250, v251
v_mul_f32 v248, v236, v236
v_mul_f32 v249, v237, v237
buffer_load_dwordx4 v8, s[36:39], s3 offen offset:1024 lds
v_mul_f32 v250, v238, v238
v_mul_f32 v251, v239, v239
v_fmaak_f32 v248, v248, v11, 0xc0135761
v_fmaak_f32 v249, v249, v11, 0xc0135761
v_fmaak_f32 v250, v250, v11, 0xc0135761
v_fmaak_f32 v251, v251, v11, 0xc0135761
v_mul_f32 v248, v236, v248
v_mul_f32 v249, v237, v249
s_add_u32 m0, s13, 40960
s_add_u32 s3, s3, 589824
buffer_load_dwordx4 v7, s[36:39], s3 offen lds
v_mul_f32 v250, v238, v250
v_mul_f32 v251, v239, v251
v_exp_f32 v248, v248
v_exp_f32 v249, v249
v_exp_f32 v250, v250
v_exp_f32 v251, v251
v_add_f32 v248, 1.0, v248
v_add_f32 v249, 1.0, v249
buffer_load_dwordx4 v8, s[36:39], s3 offen offset:1024 lds
v_add_f32 v250, 1.0, v250
v_add_f32 v251, 1.0, v251
v_rcp_f32 v248, v248
v_rcp_f32 v249, v249
v_rcp_f32 v250, v250
v_rcp_f32 v251, v251
v_mul_f32 v248, v236, v248
v_mul_f32 v249, v237, v249
s_waitcnt vmcnt(8)
s_barrier
s_add_u32 m0, s13, 49152
s_add_u32 s3, s3, 589824
buffer_load_dwordx4 v7, s[36:39], s3 offen lds
v_mul_f32 v250, v238, v250
v_mul_f32 v251, v239, v251
v_cvt_pk_bf16_f32 v232, v248, v249
v_cvt_pk_bf16_f32 v233, v250, v251
v_mul_f32 v248, v240, v240
v_mul_f32 v249, v241, v241
v_mul_f32 v250, v242, v242
v_mul_f32 v251, v243, v243
buffer_load_dwordx4 v8, s[36:39], s3 offen offset:1024 lds
v_fmaak_f32 v248, v248, v11, 0xc0135761
v_fmaak_f32 v249, v249, v11, 0xc0135761
v_fmaak_f32 v250, v250, v11, 0xc0135761
v_fmaak_f32 v251, v251, v11, 0xc0135761
s_lshl_b32 s82, s10, 1
v_add_u32 v254, s82, v13
ds_read_b128 v[196:199], v254 offset:0
ds_read_b128 v[200:203], v254 offset:32
ds_read_b128 v[204:207], v254 offset:64
ds_read_b128 v[208:211], v254 offset:96
ds_read_b64_tr_b16 v[212:213], v5 offset:0
ds_read_b64_tr_b16 v[214:215], v5 offset:512
ds_read_b64_tr_b16 v[216:217], v5 offset:2048
ds_read_b64_tr_b16 v[218:219], v5 offset:2560
ds_read_b64_tr_b16 v[220:221], v5 offset:4096
ds_read_b64_tr_b16 v[222:223], v5 offset:4608
v_mul_f32 v248, v240, v248
v_mul_f32 v249, v241, v249
v_mul_f32 v250, v242, v250
v_mul_f32 v251, v243, v251
s_add_u32 m0, s13, 57344
s_add_u32 s3, s3, 589824
buffer_load_dwordx4 v7, s[36:39], s3 offen lds
v_exp_f32 v248, v248
v_exp_f32 v249, v249
v_exp_f32 v250, v250
v_exp_f32 v251, v251
v_add_f32 v248, 1.0, v248
v_add_f32 v249, 1.0, v249
v_add_f32 v250, 1.0, v250
v_add_f32 v251, 1.0, v251
buffer_load_dwordx4 v8, s[36:39], s3 offen offset:1024 lds
v_rcp_f32 v248, v248
v_rcp_f32 v249, v249
v_rcp_f32 v250, v250
v_rcp_f32 v251, v251
s_waitcnt vmcnt(8)
s_barrier
s_waitcnt lgkmcnt(6)
s_waitcnt lgkmcnt(4)
v_mfma_f32_32x32x16_bf16 v[196:211], v[212:215], v[16:19], v[196:211]
ds_read_b64_tr_b16 v[224:225], v5 offset:6144
ds_read_b64_tr_b16 v[226:227], v5 offset:6656
s_waitcnt lgkmcnt(4)
v_mfma_f32_32x32x16_bf16 v[196:211], v[216:219], v[20:23], v[196:211]
ds_read_b64_tr_b16 v[212:213], v5 offset:8192
ds_read_b64_tr_b16 v[214:215], v5 offset:8704
s_waitcnt lgkmcnt(4)
v_mfma_f32_32x32x16_bf16 v[196:211], v[220:223], v[24:27], v[196:211]
ds_read_b64_tr_b16 v[216:217], v5 offset:10240
ds_read_b64_tr_b16 v[218:219], v5 offset:10752
s_waitcnt lgkmcnt(4)
v_mfma_f32_32x32x16_bf16 v[196:211], v[224:227], v[28:31], v[196:211]
ds_read_b64_tr_b16 v[220:221], v5 offset:12288
ds_read_b64_tr_b16 v[222:223], v5 offset:12800
s_waitcnt lgkmcnt(4)
v_mfma_f32_32x32x16_bf16 v[196:211], v[212:215], v[32:35], v[196:211]
ds_read_b64_tr_b16 v[224:225], v5 offset:14336
ds_read_b64_tr_b16 v[226:227], v5 offset:14848
s_waitcnt lgkmcnt(4)
v_mfma_f32_32x32x16_bf16 v[196:211], v[216:219], v[36:39], v[196:211]
ds_read_b64_tr_b16 v[212:213], v5 offset:16384
ds_read_b64_tr_b16 v[214:215], v5 offset:16896
s_waitcnt lgkmcnt(4)
v_mfma_f32_32x32x16_bf16 v[196:211], v[220:223], v[40:43], v[196:211]
ds_read_b64_tr_b16 v[216:217], v5 offset:18432
ds_read_b64_tr_b16 v[218:219], v5 offset:18944
s_waitcnt lgkmcnt(4)
v_mfma_f32_32x32x16_bf16 v[196:211], v[224:227], v[44:47], v[196:211]
ds_read_b64_tr_b16 v[220:221], v5 offset:20480
ds_read_b64_tr_b16 v[222:223], v5 offset:20992
s_waitcnt vmcnt(4) lgkmcnt(4)
s_barrier
v_mfma_f32_32x32x16_bf16 v[196:211], v[212:215], v[48:51], v[196:211]
ds_read_b64_tr_b16 v[224:225], v5 offset:22528
ds_read_b64_tr_b16 v[226:227], v5 offset:23040
s_waitcnt lgkmcnt(4)
v_mfma_f32_32x32x16_bf16 v[196:211], v[216:219], v[52:55], v[196:211]
ds_read_b64_tr_b16 v[212:213], v5 offset:24576
ds_read_b64_tr_b16 v[214:215], v5 offset:25088
s_waitcnt lgkmcnt(4)
v_mfma_f32_32x32x16_bf16 v[196:211], v[220:223], v[56:59], v[196:211]
ds_read_b64_tr_b16 v[216:217], v5 offset:26624
ds_read_b64_tr_b16 v[218:219], v5 offset:27136
s_waitcnt lgkmcnt(4)
v_mfma_f32_32x32x16_bf16 v[196:211], v[224:227], v[60:63], v[196:211]
ds_read_b64_tr_b16 v[220:221], v5 offset:28672
ds_read_b64_tr_b16 v[222:223], v5 offset:29184
s_waitcnt lgkmcnt(4)
v_mfma_f32_32x32x16_bf16 v[196:211], v[212:215], v[64:67], v[196:211]
ds_read_b64_tr_b16 v[224:225], v5 offset:30720
ds_read_b64_tr_b16 v[226:227], v5 offset:31232
s_waitcnt lgkmcnt(4)
v_mfma_f32_32x32x16_bf16 v[196:211], v[216:219], v[68:71], v[196:211]
ds_read_b64_tr_b16 v[212:213], v5 offset:32768
ds_read_b64_tr_b16 v[214:215], v5 offset:33280
s_waitcnt lgkmcnt(4)
v_mfma_f32_32x32x16_bf16 v[196:211], v[220:223], v[72:75], v[196:211]
ds_read_b64_tr_b16 v[216:217], v5 offset:34816
ds_read_b64_tr_b16 v[218:219], v5 offset:35328
s_waitcnt lgkmcnt(4)
v_mfma_f32_32x32x16_bf16 v[196:211], v[224:227], v[76:79], v[196:211]
ds_read_b64_tr_b16 v[220:221], v5 offset:36864
ds_read_b64_tr_b16 v[222:223], v5 offset:37376
s_waitcnt vmcnt(0) lgkmcnt(4)
s_barrier
v_mfma_f32_32x32x16_bf16 v[196:211], v[212:215], v[80:83], v[196:211]
ds_read_b64_tr_b16 v[224:225], v5 offset:38912
ds_read_b64_tr_b16 v[226:227], v5 offset:39424
s_waitcnt lgkmcnt(4)
v_mfma_f32_32x32x16_bf16 v[196:211], v[216:219], v[84:87], v[196:211]
ds_read_b64_tr_b16 v[212:213], v5 offset:40960
ds_read_b64_tr_b16 v[214:215], v5 offset:41472
s_waitcnt lgkmcnt(4)
v_mfma_f32_32x32x16_bf16 v[196:211], v[220:223], v[88:91], v[196:211]
ds_read_b64_tr_b16 v[216:217], v5 offset:43008
ds_read_b64_tr_b16 v[218:219], v5 offset:43520
s_waitcnt lgkmcnt(4)
v_mfma_f32_32x32x16_bf16 v[196:211], v[224:227], v[92:95], v[196:211]
ds_read_b64_tr_b16 v[220:221], v5 offset:45056
ds_read_b64_tr_b16 v[222:223], v5 offset:45568
s_waitcnt lgkmcnt(4)
v_mfma_f32_32x32x16_bf16 v[196:211], v[212:215], v[96:99], v[196:211]
ds_read_b64_tr_b16 v[224:225], v5 offset:47104
ds_read_b64_tr_b16 v[226:227], v5 offset:47616
s_waitcnt lgkmcnt(4)
v_mfma_f32_32x32x16_bf16 v[196:211], v[216:219], v[100:103], v[196:211]
ds_read_b64_tr_b16 v[212:213], v5 offset:49152
ds_read_b64_tr_b16 v[214:215], v5 offset:49664
s_waitcnt lgkmcnt(4)
v_mfma_f32_32x32x16_bf16 v[196:211], v[220:223], v[104:107], v[196:211]
ds_read_b64_tr_b16 v[216:217], v5 offset:51200
ds_read_b64_tr_b16 v[218:219], v5 offset:51712
s_waitcnt lgkmcnt(4)
v_mfma_f32_32x32x16_bf16 v[196:211], v[224:227], v[108:111], v[196:211]
ds_read_b64_tr_b16 v[220:221], v5 offset:53248
ds_read_b64_tr_b16 v[222:223], v5 offset:53760
s_waitcnt lgkmcnt(4)
s_barrier
v_mfma_f32_32x32x16_bf16 v[196:211], v[212:215], v[112:115], v[196:211]
ds_read_b64_tr_b16 v[224:225], v5 offset:55296
ds_read_b64_tr_b16 v[226:227], v5 offset:55808
s_waitcnt lgkmcnt(4)
v_mfma_f32_32x32x16_bf16 v[196:211], v[216:219], v[116:119], v[196:211]
ds_read_b64_tr_b16 v[212:213], v5 offset:57344
ds_read_b64_tr_b16 v[214:215], v5 offset:57856
s_waitcnt lgkmcnt(4)
v_mfma_f32_32x32x16_bf16 v[196:211], v[220:223], v[120:123], v[196:211]
ds_read_b64_tr_b16 v[216:217], v5 offset:59392
ds_read_b64_tr_b16 v[218:219], v5 offset:59904
s_waitcnt lgkmcnt(4)
v_mfma_f32_32x32x16_bf16 v[196:211], v[224:227], v[124:127], v[196:211]
ds_read_b64_tr_b16 v[220:221], v5 offset:61440
ds_read_b64_tr_b16 v[222:223], v5 offset:61952
s_waitcnt lgkmcnt(4)
v_mfma_f32_32x32x16_bf16 v[196:211], v[212:215], v[128:131], v[196:211]
ds_read_b64_tr_b16 v[224:225], v5 offset:63488
ds_read_b64_tr_b16 v[226:227], v5 offset:64000
s_waitcnt lgkmcnt(4)
v_mfma_f32_32x32x16_bf16 v[196:211], v[216:219], v[132:135], v[196:211]
ds_read_b64_tr_b16 v[212:213], v6 offset:0
ds_read_b64_tr_b16 v[214:215], v6 offset:512
s_waitcnt lgkmcnt(4)
v_mfma_f32_32x32x16_bf16 v[196:211], v[220:223], v[136:139], v[196:211]
ds_read_b64_tr_b16 v[216:217], v6 offset:2048
ds_read_b64_tr_b16 v[218:219], v6 offset:2560
s_waitcnt lgkmcnt(4)
v_mfma_f32_32x32x16_bf16 v[196:211], v[224:227], v[140:143], v[196:211]
ds_read_b64_tr_b16 v[220:221], v6 offset:4096
ds_read_b64_tr_b16 v[222:223], v6 offset:4608
s_waitcnt lgkmcnt(4)
s_barrier
v_mfma_f32_32x32x16_bf16 v[196:211], v[212:215], v[144:147], v[196:211]
ds_read_b64_tr_b16 v[224:225], v6 offset:6144
ds_read_b64_tr_b16 v[226:227], v6 offset:6656
s_waitcnt lgkmcnt(4)
v_mfma_f32_32x32x16_bf16 v[196:211], v[216:219], v[148:151], v[196:211]
s_waitcnt lgkmcnt(2)
v_mfma_f32_32x32x16_bf16 v[196:211], v[220:223], v[152:155], v[196:211]
s_waitcnt lgkmcnt(0)
v_mfma_f32_32x32x16_bf16 v[196:211], v[224:227], v[156:159], v[196:211]
s_add_u32 m0, s13, 57344
s_add_u32 s3, s11, s74
s_add_u32 s3, s3, 4718592
buffer_load_dwordx4 v7, s[36:39], s3 offen lds
s_nop 7
s_nop 3
v_mul_f32 v248, v240, v248
v_mul_f32 v249, v241, v249
v_mul_f32 v250, v242, v250
buffer_load_dwordx4 v8, s[36:39], s3 offen offset:1024 lds
v_mul_f32 v251, v243, v251
v_cvt_pk_bf16_f32 v234, v248, v249
v_cvt_pk_bf16_f32 v235, v250, v251
s_lshl_b32 s82, s8, 5
v_add_u32 v255, s82, v12
ds_write_b128 v255, v[228:231] offset:0
ds_write_b128 v255, v[232:235] offset:1024
v_mul_f32 v248, v196, v196
s_barrier
s_add_u32 m0, s13, 65536
s_add_u32 s3, s12, s74
buffer_load_dwordx4 v7, s[36:39], s3 offen lds
v_mul_f32 v249, v197, v197
v_mul_f32 v250, v198, v198
v_mul_f32 v251, v199, v199
v_fmaak_f32 v248, v248, v11, 0xc0135761
v_fmaak_f32 v249, v249, v11, 0xc0135761
v_fmaak_f32 v250, v250, v11, 0xc0135761
v_fmaak_f32 v251, v251, v11, 0xc0135761
v_mul_f32 v248, v196, v248
buffer_load_dwordx4 v8, s[36:39], s3 offen offset:1024 lds
v_mul_f32 v249, v197, v249
v_mul_f32 v250, v198, v250
v_mul_f32 v251, v199, v251
v_exp_f32 v248, v248
v_exp_f32 v249, v249
v_exp_f32 v250, v250
v_exp_f32 v251, v251
v_add_f32 v248, 1.0, v248
s_add_u32 m0, s13, 73728
s_add_u32 s3, s3, 589824
buffer_load_dwordx4 v7, s[36:39], s3 offen lds
v_add_f32 v249, 1.0, v249
v_add_f32 v250, 1.0, v250
v_add_f32 v251, 1.0, v251
v_rcp_f32 v248, v248
v_rcp_f32 v249, v249
v_rcp_f32 v250, v250
v_rcp_f32 v251, v251
v_mul_f32 v248, v196, v248
buffer_load_dwordx4 v8, s[36:39], s3 offen offset:1024 lds
v_mul_f32 v249, v197, v249
v_mul_f32 v250, v198, v250
v_mul_f32 v251, v199, v251
v_cvt_pk_bf16_f32 v196, v248, v249
v_cvt_pk_bf16_f32 v197, v250, v251
v_mul_f32 v248, v200, v200
v_mul_f32 v249, v201, v201
v_mul_f32 v250, v202, v202
s_barrier
s_add_u32 m0, s13, 0
s_add_u32 s3, s3, 589824
buffer_load_dwordx4 v7, s[36:39], s3 offen lds
v_mul_f32 v251, v203, v203
v_fmaak_f32 v248, v248, v11, 0xc0135761
v_fmaak_f32 v249, v249, v11, 0xc0135761
v_fmaak_f32 v250, v250, v11, 0xc0135761
v_fmaak_f32 v251, v251, v11, 0xc0135761
v_mul_f32 v248, v200, v248
v_mul_f32 v249, v201, v249
v_mul_f32 v250, v202, v250
buffer_load_dwordx4 v8, s[36:39], s3 offen offset:1024 lds
v_mul_f32 v251, v203, v251
v_exp_f32 v248, v248
v_exp_f32 v249, v249
v_exp_f32 v250, v250
v_exp_f32 v251, v251
v_add_f32 v248, 1.0, v248
v_add_f32 v249, 1.0, v249
v_add_f32 v250, 1.0, v250
s_add_u32 m0, s13, 8192
s_add_u32 s3, s3, 589824
buffer_load_dwordx4 v7, s[36:39], s3 offen lds
v_add_f32 v251, 1.0, v251
v_rcp_f32 v248, v248
v_rcp_f32 v249, v249
v_rcp_f32 v250, v250
v_rcp_f32 v251, v251
v_mul_f32 v248, v200, v248
v_mul_f32 v249, v201, v249
v_mul_f32 v250, v202, v250
buffer_load_dwordx4 v8, s[36:39], s3 offen offset:1024 lds
v_mul_f32 v251, v203, v251
v_cvt_pk_bf16_f32 v198, v248, v249
v_cvt_pk_bf16_f32 v199, v250, v251
v_mul_f32 v248, v204, v204
v_mul_f32 v249, v205, v205
v_mul_f32 v250, v206, v206
v_mul_f32 v251, v207, v207
s_waitcnt vmcnt(8)
s_barrier
s_add_u32 m0, s13, 16384
s_add_u32 s3, s3, 589824
buffer_load_dwordx4 v7, s[36:39], s3 offen lds
v_fmaak_f32 v248, v248, v11, 0xc0135761
v_fmaak_f32 v249, v249, v11, 0xc0135761
v_fmaak_f32 v250, v250, v11, 0xc0135761
v_fmaak_f32 v251, v251, v11, 0xc0135761
v_mul_f32 v248, v204, v248
v_mul_f32 v249, v205, v249
v_mul_f32 v250, v206, v250
v_mul_f32 v251, v207, v251
buffer_load_dwordx4 v8, s[36:39], s3 offen offset:1024 lds
v_exp_f32 v248, v248
v_exp_f32 v249, v249
v_exp_f32 v250, v250
v_exp_f32 v251, v251
v_add_f32 v248, 1.0, v248
v_add_f32 v249, 1.0, v249
v_add_f32 v250, 1.0, v250
v_add_f32 v251, 1.0, v251
s_add_u32 m0, s13, 24576
s_add_u32 s3, s3, 589824
buffer_load_dwordx4 v7, s[36:39], s3 offen lds
v_rcp_f32 v248, v248
v_rcp_f32 v249, v249
v_rcp_f32 v250, v250
v_rcp_f32 v251, v251
v_mul_f32 v248, v204, v248
v_mul_f32 v249, v205, v249
v_mul_f32 v250, v206, v250
v_mul_f32 v251, v207, v251
buffer_load_dwordx4 v8, s[36:39], s3 offen offset:1024 lds
v_cvt_pk_bf16_f32 v200, v248, v249
v_cvt_pk_bf16_f32 v201, v250, v251
v_mul_f32 v248, v208, v208
v_mul_f32 v249, v209, v209
v_mul_f32 v250, v210, v210
v_mul_f32 v251, v211, v211
v_fmaak_f32 v248, v248, v11, 0xc0135761
v_fmaak_f32 v249, v249, v11, 0xc0135761
s_waitcnt vmcnt(8)
s_barrier
s_add_u32 m0, s13, 32768
s_add_u32 s3, s3, 589824
buffer_load_dwordx4 v7, s[36:39], s3 offen lds
v_fmaak_f32 v250, v250, v11, 0xc0135761
v_fmaak_f32 v251, v251, v11, 0xc0135761
v_mul_f32 v248, v208, v248
v_mul_f32 v249, v209, v249
v_mul_f32 v250, v210, v250
v_mul_f32 v251, v211, v251
v_exp_f32 v248, v248
v_exp_f32 v249, v249
buffer_load_dwordx4 v8, s[36:39], s3 offen offset:1024 lds
v_exp_f32 v250, v250
v_exp_f32 v251, v251
v_add_f32 v248, 1.0, v248
v_add_f32 v249, 1.0, v249
s_lshl_b32 s82, s12, 1
v_add_u32 v254, s82, v13
ds_read_b128 v[228:231], v254 offset:0
ds_read_b128 v[232:235], v254 offset:32
ds_read_b128 v[236:239], v254 offset:64
ds_read_b128 v[240:243], v254 offset:96
ds_read_b64_tr_b16 v[212:213], v6 offset:0
ds_read_b64_tr_b16 v[214:215], v6 offset:512
ds_read_b64_tr_b16 v[216:217], v6 offset:2048
ds_read_b64_tr_b16 v[218:219], v6 offset:2560
ds_read_b64_tr_b16 v[220:221], v6 offset:4096
ds_read_b64_tr_b16 v[222:223], v6 offset:4608
v_add_f32 v250, 1.0, v250
v_add_f32 v251, 1.0, v251
v_rcp_f32 v248, v248
v_rcp_f32 v249, v249
s_add_u32 m0, s13, 40960
s_add_u32 s3, s3, 589824
buffer_load_dwordx4 v7, s[36:39], s3 offen lds
v_rcp_f32 v250, v250
v_rcp_f32 v251, v251
v_mul_f32 v248, v208, v248
v_mul_f32 v249, v209, v249
v_mul_f32 v250, v210, v250
v_mul_f32 v251, v211, v251
v_cvt_pk_bf16_f32 v202, v248, v249
v_cvt_pk_bf16_f32 v203, v250, v251
buffer_load_dwordx4 v8, s[36:39], s3 offen offset:1024 lds
s_lshl_b32 s82, s10, 5
v_add_u32 v255, s82, v12
ds_write_b128 v255, v[196:199] offset:0
ds_write_b128 v255, v[200:203] offset:1024
s_waitcnt vmcnt(8)
s_barrier
s_waitcnt lgkmcnt(8)
s_waitcnt lgkmcnt(6)
v_mfma_f32_32x32x16_bf16 v[228:243], v[212:215], v[16:19], v[228:243]
ds_read_b64_tr_b16 v[224:225], v6 offset:6144
ds_read_b64_tr_b16 v[226:227], v6 offset:6656
s_waitcnt lgkmcnt(6)
v_mfma_f32_32x32x16_bf16 v[228:243], v[216:219], v[20:23], v[228:243]
ds_read_b64_tr_b16 v[212:213], v6 offset:8192
ds_read_b64_tr_b16 v[214:215], v6 offset:8704
s_waitcnt lgkmcnt(6)
v_mfma_f32_32x32x16_bf16 v[228:243], v[220:223], v[24:27], v[228:243]
ds_read_b64_tr_b16 v[216:217], v6 offset:10240
ds_read_b64_tr_b16 v[218:219], v6 offset:10752
s_waitcnt lgkmcnt(4)
v_mfma_f32_32x32x16_bf16 v[228:243], v[224:227], v[28:31], v[228:243]
ds_read_b64_tr_b16 v[220:221], v6 offset:12288
ds_read_b64_tr_b16 v[222:223], v6 offset:12800
s_waitcnt lgkmcnt(4)
v_mfma_f32_32x32x16_bf16 v[228:243], v[212:215], v[32:35], v[228:243]
ds_read_b64_tr_b16 v[224:225], v6 offset:14336
ds_read_b64_tr_b16 v[226:227], v6 offset:14848
s_waitcnt lgkmcnt(4)
v_mfma_f32_32x32x16_bf16 v[228:243], v[216:219], v[36:39], v[228:243]
ds_read_b64_tr_b16 v[212:213], v5 offset:0
ds_read_b64_tr_b16 v[214:215], v5 offset:512
s_waitcnt lgkmcnt(4)
v_mfma_f32_32x32x16_bf16 v[228:243], v[220:223], v[40:43], v[228:243]
ds_read_b64_tr_b16 v[216:217], v5 offset:2048
ds_read_b64_tr_b16 v[218:219], v5 offset:2560
s_waitcnt lgkmcnt(4)
v_mfma_f32_32x32x16_bf16 v[228:243], v[224:227], v[44:47], v[228:243]
ds_read_b64_tr_b16 v[220:221], v5 offset:4096
ds_read_b64_tr_b16 v[222:223], v5 offset:4608
s_waitcnt vmcnt(4) lgkmcnt(4)
s_barrier
v_mfma_f32_32x32x16_bf16 v[228:243], v[212:215], v[48:51], v[228:243]
ds_read_b64_tr_b16 v[224:225], v5 offset:6144
ds_read_b64_tr_b16 v[226:227], v5 offset:6656
s_waitcnt lgkmcnt(4)
v_mfma_f32_32x32x16_bf16 v[228:243], v[216:219], v[52:55], v[228:243]
ds_read_b64_tr_b16 v[212:213], v5 offset:8192
ds_read_b64_tr_b16 v[214:215], v5 offset:8704
s_waitcnt lgkmcnt(4)
v_mfma_f32_32x32x16_bf16 v[228:243], v[220:223], v[56:59], v[228:243]
ds_read_b64_tr_b16 v[216:217], v5 offset:10240
ds_read_b64_tr_b16 v[218:219], v5 offset:10752
s_waitcnt lgkmcnt(4)
v_mfma_f32_32x32x16_bf16 v[228:243], v[224:227], v[60:63], v[228:243]
ds_read_b64_tr_b16 v[220:221], v5 offset:12288
ds_read_b64_tr_b16 v[222:223], v5 offset:12800
s_waitcnt lgkmcnt(4)
v_mfma_f32_32x32x16_bf16 v[228:243], v[212:215], v[64:67], v[228:243]
ds_read_b64_tr_b16 v[224:225], v5 offset:14336
ds_read_b64_tr_b16 v[226:227], v5 offset:14848
s_waitcnt lgkmcnt(4)
v_mfma_f32_32x32x16_bf16 v[228:243], v[216:219], v[68:71], v[228:243]
ds_read_b64_tr_b16 v[212:213], v5 offset:16384
ds_read_b64_tr_b16 v[214:215], v5 offset:16896
s_waitcnt lgkmcnt(4)
v_mfma_f32_32x32x16_bf16 v[228:243], v[220:223], v[72:75], v[228:243]
ds_read_b64_tr_b16 v[216:217], v5 offset:18432
ds_read_b64_tr_b16 v[218:219], v5 offset:18944
s_waitcnt lgkmcnt(4)
v_mfma_f32_32x32x16_bf16 v[228:243], v[224:227], v[76:79], v[228:243]
ds_read_b64_tr_b16 v[220:221], v5 offset:20480
ds_read_b64_tr_b16 v[222:223], v5 offset:20992
s_waitcnt vmcnt(0) lgkmcnt(4)
s_barrier
v_mfma_f32_32x32x16_bf16 v[228:243], v[212:215], v[80:83], v[228:243]
ds_read_b64_tr_b16 v[224:225], v5 offset:22528
ds_read_b64_tr_b16 v[226:227], v5 offset:23040
s_waitcnt lgkmcnt(4)
v_mfma_f32_32x32x16_bf16 v[228:243], v[216:219], v[84:87], v[228:243]
ds_read_b64_tr_b16 v[212:213], v5 offset:24576
ds_read_b64_tr_b16 v[214:215], v5 offset:25088
s_waitcnt lgkmcnt(4)
v_mfma_f32_32x32x16_bf16 v[228:243], v[220:223], v[88:91], v[228:243]
ds_read_b64_tr_b16 v[216:217], v5 offset:26624
ds_read_b64_tr_b16 v[218:219], v5 offset:27136
s_waitcnt lgkmcnt(4)
v_mfma_f32_32x32x16_bf16 v[228:243], v[224:227], v[92:95], v[228:243]
ds_read_b64_tr_b16 v[220:221], v5 offset:28672
ds_read_b64_tr_b16 v[222:223], v5 offset:29184
s_waitcnt lgkmcnt(4)
v_mfma_f32_32x32x16_bf16 v[228:243], v[212:215], v[96:99], v[228:243]
ds_read_b64_tr_b16 v[224:225], v5 offset:30720
ds_read_b64_tr_b16 v[226:227], v5 offset:31232
s_waitcnt lgkmcnt(4)
v_mfma_f32_32x32x16_bf16 v[228:243], v[216:219], v[100:103], v[228:243]
ds_read_b64_tr_b16 v[212:213], v5 offset:32768
ds_read_b64_tr_b16 v[214:215], v5 offset:33280
s_waitcnt lgkmcnt(4)
v_mfma_f32_32x32x16_bf16 v[228:243], v[220:223], v[104:107], v[228:243]
ds_read_b64_tr_b16 v[216:217], v5 offset:34816
ds_read_b64_tr_b16 v[218:219], v5 offset:35328
s_waitcnt lgkmcnt(4)
v_mfma_f32_32x32x16_bf16 v[228:243], v[224:227], v[108:111], v[228:243]
ds_read_b64_tr_b16 v[220:221], v5 offset:36864
ds_read_b64_tr_b16 v[222:223], v5 offset:37376
s_waitcnt lgkmcnt(4)
s_barrier
v_mfma_f32_32x32x16_bf16 v[228:243], v[212:215], v[112:115], v[228:243]
ds_read_b64_tr_b16 v[224:225], v5 offset:38912
ds_read_b64_tr_b16 v[226:227], v5 offset:39424
s_waitcnt lgkmcnt(4)
v_mfma_f32_32x32x16_bf16 v[228:243], v[216:219], v[116:119], v[228:243]
ds_read_b64_tr_b16 v[212:213], v5 offset:40960
ds_read_b64_tr_b16 v[214:215], v5 offset:41472
s_waitcnt lgkmcnt(4)
v_mfma_f32_32x32x16_bf16 v[228:243], v[220:223], v[120:123], v[228:243]
ds_read_b64_tr_b16 v[216:217], v5 offset:43008
ds_read_b64_tr_b16 v[218:219], v5 offset:43520
s_waitcnt lgkmcnt(4)
v_mfma_f32_32x32x16_bf16 v[228:243], v[224:227], v[124:127], v[228:243]
ds_read_b64_tr_b16 v[220:221], v5 offset:45056
ds_read_b64_tr_b16 v[222:223], v5 offset:45568
s_waitcnt lgkmcnt(4)
v_mfma_f32_32x32x16_bf16 v[228:243], v[212:215], v[128:131], v[228:243]
ds_read_b64_tr_b16 v[224:225], v5 offset:47104
ds_read_b64_tr_b16 v[226:227], v5 offset:47616
s_waitcnt lgkmcnt(4)
v_mfma_f32_32x32x16_bf16 v[228:243], v[216:219], v[132:135], v[228:243]
ds_read_b64_tr_b16 v[212:213], v5 offset:49152
ds_read_b64_tr_b16 v[214:215], v5 offset:49664
s_waitcnt lgkmcnt(4)
v_mfma_f32_32x32x16_bf16 v[228:243], v[220:223], v[136:139], v[228:243]
ds_read_b64_tr_b16 v[216:217], v5 offset:51200
ds_read_b64_tr_b16 v[218:219], v5 offset:51712
s_waitcnt lgkmcnt(4)
v_mfma_f32_32x32x16_bf16 v[228:243], v[224:227], v[140:143], v[228:243]
ds_read_b64_tr_b16 v[220:221], v5 offset:53248
ds_read_b64_tr_b16 v[222:223], v5 offset:53760
s_waitcnt lgkmcnt(4)
s_barrier
v_mfma_f32_32x32x16_bf16 v[228:243], v[212:215], v[144:147], v[228:243]
ds_read_b64_tr_b16 v[224:225], v5 offset:55296
ds_read_b64_tr_b16 v[226:227], v5 offset:55808
s_waitcnt lgkmcnt(4)
v_mfma_f32_32x32x16_bf16 v[228:243], v[216:219], v[148:151], v[228:243]
s_waitcnt lgkmcnt(2)
v_mfma_f32_32x32x16_bf16 v[228:243], v[220:223], v[152:155], v[228:243]
s_waitcnt lgkmcnt(0)
v_mfma_f32_32x32x16_bf16 v[228:243], v[224:227], v[156:159], v[228:243]
s_nop 7
s_nop 3
v_mul_f32 v248, v228, v228
v_mul_f32 v249, v229, v229
v_mul_f32 v250, v230, v230
v_mul_f32 v251, v231, v231
v_fmaak_f32 v248, v248, v11, 0xc0135761
v_fmaak_f32 v249, v249, v11, 0xc0135761
v_fmaak_f32 v250, v250, v11, 0xc0135761
v_fmaak_f32 v251, v251, v11, 0xc0135761
v_mul_f32 v248, v228, v248
v_mul_f32 v249, v229, v249
v_mul_f32 v250, v230, v250
v_mul_f32 v251, v231, v251
v_exp_f32 v248, v248
v_exp_f32 v249, v249
v_exp_f32 v250, v250
v_exp_f32 v251, v251
v_add_f32 v248, 1.0, v248
v_add_f32 v249, 1.0, v249
v_add_f32 v250, 1.0, v250
v_add_f32 v251, 1.0, v251
v_rcp_f32 v248, v248
v_rcp_f32 v249, v249
v_rcp_f32 v250, v250
v_rcp_f32 v251, v251
v_mul_f32 v248, v228, v248
v_mul_f32 v249, v229, v249
v_mul_f32 v250, v230, v250
v_mul_f32 v251, v231, v251
v_cvt_pk_bf16_f32 v228, v248, v249
v_cvt_pk_bf16_f32 v229, v250, v251
v_mul_f32 v248, v232, v232
v_mul_f32 v249, v233, v233
v_mul_f32 v250, v234, v234
v_mul_f32 v251, v235, v235
v_fmaak_f32 v248, v248, v11, 0xc0135761
v_fmaak_f32 v249, v249, v11, 0xc0135761
v_fmaak_f32 v250, v250, v11, 0xc0135761
v_fmaak_f32 v251, v251, v11, 0xc0135761
v_mul_f32 v248, v232, v248
v_mul_f32 v249, v233, v249
v_mul_f32 v250, v234, v250
v_mul_f32 v251, v235, v251
v_exp_f32 v248, v248
v_exp_f32 v249, v249
v_exp_f32 v250, v250
v_exp_f32 v251, v251
v_add_f32 v248, 1.0, v248
v_add_f32 v249, 1.0, v249
v_add_f32 v250, 1.0, v250
v_add_f32 v251, 1.0, v251
v_rcp_f32 v248, v248
v_rcp_f32 v249, v249
v_rcp_f32 v250, v250
v_rcp_f32 v251, v251
v_mul_f32 v248, v232, v248
v_mul_f32 v249, v233, v249
v_mul_f32 v250, v234, v250
v_mul_f32 v251, v235, v251
v_cvt_pk_bf16_f32 v230, v248, v249
v_cvt_pk_bf16_f32 v231, v250, v251
v_mul_f32 v248, v236, v236
v_mul_f32 v249, v237, v237
v_mul_f32 v250, v238, v238
v_mul_f32 v251, v239, v239
v_fmaak_f32 v248, v248, v11, 0xc0135761
v_fmaak_f32 v249, v249, v11, 0xc0135761
v_fmaak_f32 v250, v250, v11, 0xc0135761
v_fmaak_f32 v251, v251, v11, 0xc0135761
v_mul_f32 v248, v236, v248
v_mul_f32 v249, v237, v249
v_mul_f32 v250, v238, v250
v_mul_f32 v251, v239, v251
v_exp_f32 v248, v248
v_exp_f32 v249, v249
v_exp_f32 v250, v250
v_exp_f32 v251, v251
v_add_f32 v248, 1.0, v248
v_add_f32 v249, 1.0, v249
v_add_f32 v250, 1.0, v250
v_add_f32 v251, 1.0, v251
v_rcp_f32 v248, v248
v_rcp_f32 v249, v249
v_rcp_f32 v250, v250
v_rcp_f32 v251, v251
v_mul_f32 v248, v236, v248
v_mul_f32 v249, v237, v249
v_mul_f32 v250, v238, v250
v_mul_f32 v251, v239, v251
v_cvt_pk_bf16_f32 v232, v248, v249
v_cvt_pk_bf16_f32 v233, v250, v251
v_mul_f32 v248, v240, v240
v_mul_f32 v249, v241, v241
v_mul_f32 v250, v242, v242
v_mul_f32 v251, v243, v243
v_fmaak_f32 v248, v248, v11, 0xc0135761
v_fmaak_f32 v249, v249, v11, 0xc0135761
v_fmaak_f32 v250, v250, v11, 0xc0135761
v_fmaak_f32 v251, v251, v11, 0xc0135761
v_mul_f32 v248, v240, v248
v_mul_f32 v249, v241, v249
v_mul_f32 v250, v242, v250
v_mul_f32 v251, v243, v251
v_exp_f32 v248, v248
v_exp_f32 v249, v249
v_exp_f32 v250, v250
v_exp_f32 v251, v251
v_add_f32 v248, 1.0, v248
v_add_f32 v249, 1.0, v249
v_add_f32 v250, 1.0, v250
v_add_f32 v251, 1.0, v251
v_rcp_f32 v248, v248
v_rcp_f32 v249, v249
v_rcp_f32 v250, v250
v_rcp_f32 v251, v251
v_mul_f32 v248, v240, v248
v_mul_f32 v249, v241, v249
v_mul_f32 v250, v242, v250
v_mul_f32 v251, v243, v251
v_cvt_pk_bf16_f32 v234, v248, v249
v_cvt_pk_bf16_f32 v235, v250, v251
s_lshl_b32 s82, s12, 5
v_add_u32 v255, s82, v12
ds_write_b128 v255, v[228:231] offset:0
ds_write_b128 v255, v[232:235] offset:1024
s_mul_i32 s82, s70, 4608
s_lshl_b32 s83, s69, 10
s_add_u32 s83, s83, s82
v_add_u32 v6, s83, v9
v_add_u32 v5, 65536, v6
s_add_u32 s83, s82, 4096
v_add_u32 v11, s83, v10
v_add_u32 v13, 65536, v11
s_mul_i32 s83, s70, 79360
s_sub_u32 s83, 74752, s83
v_add_u32 v12, s83, v6
v_add_u32 v188, s83, v11
v_lshl_add_u32 v252, v3, 2, s69
v_lshlrev_b32 v253, 2, v3
v_sub_u32 v253, v2, v253
v_cvt_f32_i32 v253, v253
v_mov_b32 v254, 0x7149f2ca
v_cmp_eq_u32 s[26:27], 0, v252
s_nop 1
v_cndmask_b32 v184, 0, v184, s[26:27]
v_cmp_eq_u32 s[26:27], 1, v252
s_nop 1
v_cndmask_b32 v185, 0, v185, s[26:27]
v_cmp_eq_u32 s[26:27], 2, v252
s_nop 1
v_cndmask_b32 v186, 0, v186, s[26:27]
v_cmp_eq_u32 s[26:27], 3, v252
s_nop 1
v_cndmask_b32 v187, 0, v187, s[26:27]
v_fmaak_f32 v16, v253, v254, 0x70c9f2ca
v_min_f32 v144, 0, v16
v_min_f32_e64 v16, -v16, 0
v_fmaak_f32 v17, v253, v254, 0xf0c9f2ca
v_min_f32 v145, 0, v17
v_min_f32_e64 v17, -v17, 0
v_fmaak_f32 v18, v253, v254, 0xf1977617
v_min_f32 v146, 0, v18
v_min_f32_e64 v18, -v18, 0
v_fmaak_f32 v19, v253, v254, 0xf1fc6f7c
v_min_f32 v147, 0, v19
v_min_f32_e64 v19, -v19, 0
v_fmaak_f32 v20, v253, v254, 0xf2bd539d
v_min_f32 v148, 0, v20
v_min_f32_e64 v20, -v20, 0
v_fmaak_f32 v21, v253, v254, 0xf2d691f6
v_min_f32 v149, 0, v21
v_min_f32_e64 v21, -v21, 0
v_fmaak_f32 v22, v253, v254, 0xf2efd050
v_min_f32 v150, 0, v22
v_min_f32_e64 v22, -v22, 0
v_fmaak_f32 v23, v253, v254, 0xf3048754
v_min_f32 v151, 0, v23
v_min_f32_e64 v23, -v23, 0
v_fmaak_f32 v24, v253, v254, 0xf343a333
v_min_f32 v152, 0, v24
v_min_f32_e64 v24, -v24, 0
v_fmaak_f32 v25, v253, v254, 0xf3504260
v_min_f32 v153, 0, v25
v_min_f32_e64 v25, -v25, 0
v_fmaak_f32 v26, v253, v254, 0xf35ce18d
v_min_f32 v154, 0, v26
v_min_f32_e64 v26, -v26, 0
v_fmaak_f32 v27, v253, v254, 0xf36980b9
v_min_f32 v155, 0, v27
v_min_f32_e64 v27, -v27, 0
v_fmaak_f32 v28, v253, v254, 0xf3944e4c
v_min_f32 v156, 0, v28
v_min_f32_e64 v28, -v28, 0
v_fmaak_f32 v29, v253, v254, 0xf39a9de3
v_min_f32 v157, 0, v29
v_min_f32_e64 v29, -v29, 0
v_fmaak_f32 v30, v253, v254, 0xf3a0ed79
v_min_f32 v158, 0, v30
v_min_f32_e64 v30, -v30, 0
v_fmaak_f32 v31, v253, v254, 0xf3a73d0f
v_min_f32 v159, 0, v31
v_min_f32_e64 v31, -v31, 0
s_lshl_b32 s91, s72, 1
s_sub_u32 s91, s91, 8
s_mul_i32 s91, s91, 256
v_add_u32 v14, s91, v14
s_waitcnt lgkmcnt(0)
s_branch L_f1_done
L_f1_B:
s_waitcnt vmcnt(4)
s_barrier
s_add_u32 m0, s13, 32768
s_add_u32 s3, s4, s74
s_add_u32 s3, s3, 4718592
buffer_load_dwordx4 v7, s[36:39], s3 offen lds
buffer_load_dwordx4 v8, s[36:39], s3 offen offset:1024 lds
s_add_u32 m0, s13, 40960
s_add_u32 s3, s5, s74
buffer_load_dwordx4 v7, s[36:39], s3 offen lds
s_lshl_b32 s84, s70, 9
s_add_u32 s84, s84, 157952
v_xor_b32 v171, 1, v3
s_cmp_eq_u32 s69, 1
s_cbranch_scc1 L_ep1B0
s_cmp_eq_u32 s69, 2
s_cbranch_scc1 L_ep2B0
s_cmp_eq_u32 s69, 3
s_cbranch_scc1 L_ep3B0
v_mul_f32 v180, s88, v180
v_mul_f32 v181, s88, v181
v_mul_f32 v182, s88, v182
v_mul_f32 v183, s88, v183
v_cvt_pk_bf16_f32 v180, v180, v181
v_cvt_pk_bf16_f32 v181, v182, v183
s_add_u32 s81, s20, 0
s_add_u32 s83, s20, 8
s_sub_u32 s83, s83, s81
v_mul_lo_u32 v172, v3, s83
v_add3_u32 v172, v172, v10, s81
ds_write_b64 v172, v[180:181]
v_mul_f32 v184, s88, v184
v_mul_f32 v185, s88, v185
v_mul_f32 v186, s88, v186
v_mul_f32 v187, s88, v187
v_cvt_pk_bf16_f32 v184, v184, v185
v_cvt_pk_bf16_f32 v185, v186, v187
s_add_u32 s81, s20, 512
s_add_u32 s83, s20, 520
s_sub_u32 s83, s83, s81
v_mul_lo_u32 v172, v3, s83
v_add3_u32 v172, v172, v10, s81
ds_write_b64 v172, v[184:185]
v_mul_f32 v188, s88, v188
v_mul_f32 v189, s88, v189
v_mul_f32 v190, s88, v190
v_mul_f32 v191, s88, v191
v_cvt_pk_bf16_f32 v188, v188, v189
v_cvt_pk_bf16_f32 v189, v190, v191
s_add_u32 s81, s84, 0
s_add_u32 s83, s20, 1024
s_sub_u32 s83, s83, s81
v_mul_lo_u32 v172, v3, s83
v_add3_u32 v172, v172, v10, s81
ds_write_b64 v172, v[188:189]
v_mul_f32 v192, s88, v192
v_mul_f32 v193, s88, v193
v_mul_f32 v194, s88, v194
v_mul_f32 v195, s88, v195
v_cvt_pk_bf16_f32 v192, v192, v193
v_cvt_pk_bf16_f32 v193, v194, v195
s_add_u32 s81, s20, 1032
s_add_u32 s83, s20, 1536
s_sub_u32 s83, s83, s81
v_mul_lo_u32 v172, v3, s83
v_add3_u32 v172, v172, v10, s81
ds_write_b64 v172, v[192:193]
s_branch L_epmB0
L_ep1B0:
v_mul_f32 v180, s88, v180
v_mul_f32 v181, s88, v181
v_mul_f32 v182, s88, v182
v_mul_f32 v183, s88, v183
v_cvt_pk_bf16_f32 v180, v180, v181
v_cvt_pk_bf16_f32 v181, v182, v183
s_add_u32 s81, s20, 1544
s_add_u32 s83, s20, 2048
s_sub_u32 s83, s83, s81
v_mul_lo_u32 v172, v3, s83
v_add3_u32 v172, v172, v10, s81
ds_write_b64 v172, v[180:181]
v_mul_f32 v184, s88, v184
v_mul_f32 v185, s88, v185
v_mul_f32 v186, s88, v186
v_mul_f32 v187, s88, v187
v_cvt_pk_bf16_f32 v184, v184, v185
v_cvt_pk_bf16_f32 v185, v186, v187
s_add_u32 s81, s20, 2056
s_add_u32 s83, s20, 2560
s_sub_u32 s83, s83, s81
v_mul_lo_u32 v172, v3, s83
v_add3_u32 v172, v172, v10, s81
ds_write_b64 v172, v[184:185]
v_mul_f32 v188, s88, v188
v_mul_f32 v189, s88, v189
v_mul_f32 v190, s88, v190
v_mul_f32 v191, s88, v191
v_cvt_pk_bf16_f32 v188, v188, v189
v_cvt_pk_bf16_f32 v189, v190, v191
s_add_u32 s81, s20, 2568
s_add_u32 s83, s84, 8
s_sub_u32 s83, s83, s81
v_mul_lo_u32 v172, v3, s83
v_add3_u32 v172, v172, v10, s81
ds_write_b64 v172, v[188:189]
v_mul_f32 v192, s88, v192
v_mul_f32 v193, s88, v193
v_mul_f32 v194, s88, v194
v_mul_f32 v195, s88, v195
v_cvt_pk_bf16_f32 v192, v192, v193
v_cvt_pk_bf16_f32 v193, v194, v195
s_add_u32 s81, s20, 3072
s_add_u32 s83, s20, 3080
s_sub_u32 s83, s83, s81
v_mul_lo_u32 v172, v3, s83
v_add3_u32 v172, v172, v10, s81
ds_write_b64 v172, v[192:193]
s_branch L_epmB0
L_ep2B0:
v_mul_f32 v180, s88, v180
v_mul_f32 v181, s88, v181
v_mul_f32 v182, s88, v182
v_mul_f32 v183, s88, v183
v_cvt_pk_bf16_f32 v180, v180, v181
v_cvt_pk_bf16_f32 v181, v182, v183
s_add_u32 s81, s20, 3584
s_add_u32 s83, s20, 3592
s_sub_u32 s83, s83, s81
v_mul_lo_u32 v172, v3, s83
v_add3_u32 v172, v172, v10, s81
ds_write_b64 v172, v[180:181]
v_cvt_pk_bf16_f32 v184, v184, v185
v_cvt_pk_bf16_f32 v185, v186, v187
s_mov_b32 s81, 8
v_mad_u32_u24 v165, v3, s81, v10
v_cvt_pk_bf16_f32 v188, v188, v189
v_cvt_pk_bf16_f32 v189, v190, v191
s_mov_b32 s81, 8
v_mad_u32_u24 v166, v3, s81, v10
v_cvt_pk_bf16_f32 v192, v192, v193
v_cvt_pk_bf16_f32 v193, v194, v195
s_mov_b32 s81, 3072
v_mad_u32_u24 v167, v171, s81, v10
s_branch L_epmB0
L_ep3B0:
v_cvt_pk_bf16_f32 v180, v180, v181
v_cvt_pk_bf16_f32 v181, v182, v183
s_mov_b32 s81, 504
v_mad_u32_u24 v164, v3, s81, v10
v_cvt_pk_bf16_f32 v184, v184, v185
v_cvt_pk_bf16_f32 v185, v186, v187
s_mov_b32 s81, 504
v_mad_u32_u24 v165, v3, s81, v10
v_cvt_pk_bf16_f32 v188, v188, v189
v_cvt_pk_bf16_f32 v189, v190, v191
s_mov_b32 s81, 504
v_mad_u32_u24 v166, v3, s81, v10
v_cvt_pk_bf16_f32 v192, v192, v193
v_cvt_pk_bf16_f32 v193, v194, v195
s_mov_b32 s81, 1536
v_mad_u32_u24 v167, v3, s81, v10
L_epmB0:
buffer_load_dwordx4 v8, s[36:39], s3 offen offset:1024 lds
s_waitcnt vmcnt(6)
s_barrier
s_add_u32 m0, s13, 49152
s_add_u32 s3, s3, 589824
buffer_load_dwordx4 v7, s[36:39], s3 offen lds
buffer_load_dwordx4 v8, s[36:39], s3 offen offset:1024 lds
s_add_u32 m0, s13, 57344
s_add_u32 s3, s3, 589824
buffer_load_dwordx4 v7, s[36:39], s3 offen lds
buffer_load_dwordx4 v8, s[36:39], s3 offen offset:1024 lds
s_waitcnt vmcnt(8)
s_barrier
s_add_u32 m0, s13, 65536
s_add_u32 s3, s3, 589824
buffer_load_dwordx4 v7, s[36:39], s3 offen lds
s_lshl_b32 s84, s70, 9
s_add_u32 s84, s84, 157952
v_xor_b32 v171, 1, v3
s_cmp_lg_u32 s69, 0
s_cbranch_scc1 L_epvB1
v_cvt_pk_bf16_f32 v196, v196, v197
v_cvt_pk_bf16_f32 v197, v198, v199
s_mov_b32 s81, 8
v_mad_u32_u24 v164, v3, s81, v10
v_cvt_pk_bf16_f32 v200, v200, v201
v_cvt_pk_bf16_f32 v201, v202, v203
s_mov_b32 s81, 8
v_mad_u32_u24 v165, v3, s81, v10
s_branch L_epdB1
L_epvB1:
v_cvt_pk_bf16_f32 v196, v196, v197
v_cvt_pk_bf16_f32 v197, v198, v199
v_cvt_pk_bf16_f32 v198, v200, v201
v_cvt_pk_bf16_f32 v199, v202, v203
v_cvt_pk_bf16_f32 v200, v204, v205
v_cvt_pk_bf16_f32 v201, v206, v207
v_cvt_pk_bf16_f32 v202, v208, v209
v_cvt_pk_bf16_f32 v203, v210, v211
s_sub_u32 s81, s69, 1
s_lshl_b32 s81, s81, 5
v_add_u32 v168, s81, v2
v_mul_u32_u24 v169, 57, v168
v_lshrrev_b32 v169, 10, v169
v_mul_u32_u24 v170, 58, v169
v_add_u32 v170, v168, v170
v_cmp_lt_u32 s[26:27], 3, v169
v_mul_u32_u24 v169, 76, v168
v_subrev_u32 v169, 5454, v169
v_cndmask_b32 v170, v170, v169, s[26:27]
v_mov_b32 v169, 0x3f803f80
v_cndmask_b32 v196, v196, v169, s[26:27]
v_cndmask_b32 v197, v197, v169, s[26:27]
v_cndmask_b32 v198, v198, v169, s[26:27]
v_cndmask_b32 v199, v199, v169, s[26:27]
v_cndmask_b32 v200, v200, v169, s[26:27]
v_cndmask_b32 v201, v201, v169, s[26:27]
v_cndmask_b32 v202, v202, v169, s[26:27]
v_cndmask_b32 v203, v203, v169, s[26:27]
v_mad_u32_u24 v170, v3, 19, v170
v_lshlrev_b32 v170, 4, v170
v_lshrrev_b32 v168, 2, v168
v_cmp_lt_u32 s[26:27], 18, v168
v_mov_b32 v169, 0x7fffff00
s_nop 0
v_cndmask_b32 v170, v170, v169, s[26:27]
L_epdB1:
buffer_load_dwordx4 v8, s[36:39], s3 offen offset:1024 lds
s_add_u32 m0, s13, 73728
s_add_u32 s3, s3, 589824
buffer_load_dwordx4 v7, s[36:39], s3 offen lds
buffer_load_dwordx4 v8, s[36:39], s3 offen offset:1024 lds
s_waitcnt vmcnt(8)
s_barrier
s_add_u32 m0, s13, 0
s_add_u32 s3, s3, 589824
buffer_load_dwordx4 v7, s[36:39], s3 offen lds
buffer_load_dwordx4 v8, s[36:39], s3 offen offset:1024 lds
s_add_u32 m0, s13, 8192
s_add_u32 s3, s3, 589824
buffer_load_dwordx4 v7, s[36:39], s3 offen lds
buffer_load_dwordx4 v8, s[36:39], s3 offen offset:1024 lds
s_waitcnt vmcnt(8)
s_barrier
s_add_u32 m0, s13, 16384
s_add_u32 s3, s3, 589824
buffer_load_dwordx4 v7, s[36:39], s3 offen lds
buffer_load_dwordx4 v8, s[36:39], s3 offen offset:1024 lds
s_lshl_b32 s85, s71, 6
s_lshl_b32 s81, s72, 1
s_add_u32 s85, s85, s81
s_add_u32 s85, s85, s70
s_mul_i32 s85, s85, 4608
s_cmp_eq_u32 s69, 1
s_cbranch_scc1 L_ep1B2
s_cmp_eq_u32 s69, 2
s_cbranch_scc1 L_ep2B2
s_cmp_eq_u32 s69, 3
s_cbranch_scc1 L_ep3B2
s_branch L_epmB2
L_ep1B2:
s_branch L_epmB2
L_ep2B2:
s_add_u32 s81, s85, 0
buffer_store_dwordx2 v[184:185], v165, s[56:59], s81 offen sc1
s_add_u32 s81, s85, 512
buffer_store_dwordx2 v[188:189], v166, s[56:59], s81 offen sc1
s_add_u32 s81, s85, 1024
buffer_store_dwordx2 v[192:193], v167, s[56:59], s81 offen sc1
s_branch L_epmB2
L_ep3B2:
s_add_u32 s81, s85, 1032
buffer_store_dwordx2 v[180:181], v164, s[56:59], s81 offen sc1
s_add_u32 s81, s85, 1544
buffer_store_dwordx2 v[184:185], v165, s[56:59], s81 offen sc1
s_add_u32 s81, s85, 2056
buffer_store_dwordx2 v[188:189], v166, s[56:59], s81 offen sc1
s_add_u32 s81, s85, 2568
buffer_store_dwordx2 v[192:193], v167, s[56:59], s81 offen sc1
L_epmB2:
s_cmp_lg_u32 s69, 0
s_cbranch_scc1 L_epvB2
s_add_u32 s81, s85, 3072
buffer_store_dwordx2 v[196:197], v164, s[56:59], s81 offen sc1
s_add_u32 s81, s85, 3584
buffer_store_dwordx2 v[200:201], v165, s[56:59], s81 offen sc1
s_branch L_epdB2
L_epvB2:
s_lshl_b32 s81, s71, 6
s_lshl_b32 s83, s72, 1
s_add_u32 s81, s81, s83
s_add_u32 s81, s81, s70
s_mul_i32 s81, s81, 4864
s_add_u32 s81, s81, 4194304
buffer_store_dwordx4 v[196:199], v170, s[56:59], s81 offen sc1
buffer_store_dwordx4 v[200:203], v170, s[56:59], s81 offen offset:608 sc1
L_epdB2:
s_waitcnt lgkmcnt(0)
buffer_load_dword v246, off, s[44:47], 0 sc1
s_lshl_b32 s82, s5, 1
v_add_u32 v254, s82, v13
ds_read_b128 v[228:231], v254 offset:0
ds_read_b128 v[232:235], v254 offset:32
ds_read_b128 v[236:239], v254 offset:64
ds_read_b128 v[240:243], v254 offset:96
ds_read_b64_tr_b16 v[212:213], v5 offset:40960
ds_read_b64_tr_b16 v[214:215], v5 offset:41472
ds_read_b64_tr_b16 v[216:217], v5 offset:43008
ds_read_b64_tr_b16 v[218:219], v5 offset:43520
ds_read_b64_tr_b16 v[220:221], v5 offset:45056
ds_read_b64_tr_b16 v[222:223], v5 offset:45568
s_waitcnt lgkmcnt(6)
s_waitcnt lgkmcnt(4)
v_mfma_f32_32x32x16_bf16 v[228:243], v[212:215], v[16:19], v[228:243]
ds_read_b64_tr_b16 v[224:225], v5 offset:47104
ds_read_b64_tr_b16 v[226:227], v5 offset:47616
s_waitcnt lgkmcnt(4)
v_mfma_f32_32x32x16_bf16 v[228:243], v[216:219], v[20:23], v[228:243]
ds_read_b64_tr_b16 v[212:213], v5 offset:49152
ds_read_b64_tr_b16 v[214:215], v5 offset:49664
s_waitcnt lgkmcnt(4)
v_mfma_f32_32x32x16_bf16 v[228:243], v[220:223], v[24:27], v[228:243]
ds_read_b64_tr_b16 v[216:217], v5 offset:51200
ds_read_b64_tr_b16 v[218:219], v5 offset:51712
s_waitcnt lgkmcnt(4)
v_mfma_f32_32x32x16_bf16 v[228:243], v[224:227], v[28:31], v[228:243]
ds_read_b64_tr_b16 v[220:221], v5 offset:53248
ds_read_b64_tr_b16 v[222:223], v5 offset:53760
s_waitcnt vmcnt(9) lgkmcnt(4)
s_barrier
v_mfma_f32_32x32x16_bf16 v[228:243], v[212:215], v[32:35], v[228:243]
ds_read_b64_tr_b16 v[224:225], v5 offset:55296
ds_read_b64_tr_b16 v[226:227], v5 offset:55808
s_waitcnt lgkmcnt(4)
v_mfma_f32_32x32x16_bf16 v[228:243], v[216:219], v[36:39], v[228:243]
ds_read_b64_tr_b16 v[212:213], v5 offset:57344
ds_read_b64_tr_b16 v[214:215], v5 offset:57856
s_waitcnt lgkmcnt(4)
v_mfma_f32_32x32x16_bf16 v[228:243], v[220:223], v[40:43], v[228:243]
ds_read_b64_tr_b16 v[216:217], v5 offset:59392
ds_read_b64_tr_b16 v[218:219], v5 offset:59904
s_waitcnt lgkmcnt(4)
v_mfma_f32_32x32x16_bf16 v[228:243], v[224:227], v[44:47], v[228:243]
ds_read_b64_tr_b16 v[220:221], v5 offset:61440
ds_read_b64_tr_b16 v[222:223], v5 offset:61952
s_waitcnt lgkmcnt(4)
v_mfma_f32_32x32x16_bf16 v[228:243], v[212:215], v[48:51], v[228:243]
ds_read_b64_tr_b16 v[224:225], v5 offset:63488
ds_read_b64_tr_b16 v[226:227], v5 offset:64000
s_waitcnt lgkmcnt(4)
v_mfma_f32_32x32x16_bf16 v[228:243], v[216:219], v[52:55], v[228:243]
ds_read_b64_tr_b16 v[212:213], v6 offset:0
ds_read_b64_tr_b16 v[214:215], v6 offset:512
s_waitcnt lgkmcnt(4)
v_mfma_f32_32x32x16_bf16 v[228:243], v[220:223], v[56:59], v[228:243]
ds_read_b64_tr_b16 v[216:217], v6 offset:2048
ds_read_b64_tr_b16 v[218:219], v6 offset:2560
s_waitcnt lgkmcnt(4)
v_mfma_f32_32x32x16_bf16 v[228:243], v[224:227], v[60:63], v[228:243]
ds_read_b64_tr_b16 v[220:221], v6 offset:4096
ds_read_b64_tr_b16 v[222:223], v6 offset:4608
s_waitcnt vmcnt(5) lgkmcnt(4)
s_barrier
v_mfma_f32_32x32x16_bf16 v[228:243], v[212:215], v[64:67], v[228:243]
ds_read_b64_tr_b16 v[224:225], v6 offset:6144
ds_read_b64_tr_b16 v[226:227], v6 offset:6656
s_waitcnt lgkmcnt(4)
v_mfma_f32_32x32x16_bf16 v[228:243], v[216:219], v[68:71], v[228:243]
ds_read_b64_tr_b16 v[212:213], v6 offset:8192
ds_read_b64_tr_b16 v[214:215], v6 offset:8704
s_waitcnt lgkmcnt(4)
v_mfma_f32_32x32x16_bf16 v[228:243], v[220:223], v[72:75], v[228:243]
ds_read_b64_tr_b16 v[216:217], v6 offset:10240
ds_read_b64_tr_b16 v[218:219], v6 offset:10752
s_waitcnt lgkmcnt(4)
v_mfma_f32_32x32x16_bf16 v[228:243], v[224:227], v[76:79], v[228:243]
ds_read_b64_tr_b16 v[220:221], v6 offset:12288
ds_read_b64_tr_b16 v[222:223], v6 offset:12800
s_waitcnt lgkmcnt(4)
v_mfma_f32_32x32x16_bf16 v[228:243], v[212:215], v[80:83], v[228:243]
ds_read_b64_tr_b16 v[224:225], v6 offset:14336
ds_read_b64_tr_b16 v[226:227], v6 offset:14848
s_waitcnt lgkmcnt(4)
v_mfma_f32_32x32x16_bf16 v[228:243], v[216:219], v[84:87], v[228:243]
ds_read_b64_tr_b16 v[212:213], v5 offset:0
ds_read_b64_tr_b16 v[214:215], v5 offset:512
s_waitcnt lgkmcnt(4)
v_mfma_f32_32x32x16_bf16 v[228:243], v[220:223], v[88:91], v[228:243]
ds_read_b64_tr_b16 v[216:217], v5 offset:2048
ds_read_b64_tr_b16 v[218:219], v5 offset:2560
s_waitcnt lgkmcnt(4)
v_mfma_f32_32x32x16_bf16 v[228:243], v[224:227], v[92:95], v[228:243]
ds_read_b64_tr_b16 v[220:221], v5 offset:4096
ds_read_b64_tr_b16 v[222:223], v5 offset:4608
s_waitcnt vmcnt(3) lgkmcnt(4)
s_barrier
v_mfma_f32_32x32x16_bf16 v[228:243], v[212:215], v[96:99], v[228:243]
ds_read_b64_tr_b16 v[224:225], v5 offset:6144
ds_read_b64_tr_b16 v[226:227], v5 offset:6656
s_waitcnt lgkmcnt(4)
v_mfma_f32_32x32x16_bf16 v[228:243], v[216:219], v[100:103], v[228:243]
ds_read_b64_tr_b16 v[212:213], v5 offset:8192
ds_read_b64_tr_b16 v[214:215], v5 offset:8704
s_waitcnt lgkmcnt(4)
v_mfma_f32_32x32x16_bf16 v[228:243], v[220:223], v[104:107], v[228:243]
ds_read_b64_tr_b16 v[216:217], v5 offset:10240
ds_read_b64_tr_b16 v[218:219], v5 offset:10752
s_waitcnt lgkmcnt(4)
v_mfma_f32_32x32x16_bf16 v[228:243], v[224:227], v[108:111], v[228:243]
ds_read_b64_tr_b16 v[220:221], v5 offset:12288
ds_read_b64_tr_b16 v[222:223], v5 offset:12800
s_waitcnt lgkmcnt(4)
v_mfma_f32_32x32x16_bf16 v[228:243], v[212:215], v[112:115], v[228:243]
ds_read_b64_tr_b16 v[224:225], v5 offset:14336
ds_read_b64_tr_b16 v[226:227], v5 offset:14848
s_waitcnt lgkmcnt(4)
v_mfma_f32_32x32x16_bf16 v[228:243], v[216:219], v[116:119], v[228:243]
ds_read_b64_tr_b16 v[212:213], v5 offset:16384
ds_read_b64_tr_b16 v[214:215], v5 offset:16896
s_waitcnt lgkmcnt(4)
v_mfma_f32_32x32x16_bf16 v[228:243], v[220:223], v[120:123], v[228:243]
ds_read_b64_tr_b16 v[216:217], v5 offset:18432
ds_read_b64_tr_b16 v[218:219], v5 offset:18944
s_waitcnt lgkmcnt(4)
v_mfma_f32_32x32x16_bf16 v[228:243], v[224:227], v[124:127], v[228:243]
ds_read_b64_tr_b16 v[220:221], v5 offset:20480
ds_read_b64_tr_b16 v[222:223], v5 offset:20992
s_waitcnt lgkmcnt(4)
s_barrier
v_mfma_f32_32x32x16_bf16 v[228:243], v[212:215], v[128:131], v[228:243]
ds_read_b64_tr_b16 v[224:225], v5 offset:22528
ds_read_b64_tr_b16 v[226:227], v5 offset:23040
s_waitcnt lgkmcnt(4)
v_mfma_f32_32x32x16_bf16 v[228:243], v[216:219], v[132:135], v[228:243]
ds_read_b64_tr_b16 v[212:213], v5 offset:24576
ds_read_b64_tr_b16 v[214:215], v5 offset:25088
s_waitcnt lgkmcnt(4)
v_mfma_f32_32x32x16_bf16 v[228:243], v[220:223], v[136:139], v[228:243]
ds_read_b64_tr_b16 v[216:217], v5 offset:26624
ds_read_b64_tr_b16 v[218:219], v5 offset:27136
s_waitcnt lgkmcnt(4)
v_mfma_f32_32x32x16_bf16 v[228:243], v[224:227], v[140:143], v[228:243]
ds_read_b64_tr_b16 v[220:221], v5 offset:28672
ds_read_b64_tr_b16 v[222:223], v5 offset:29184
s_waitcnt lgkmcnt(4)
v_mfma_f32_32x32x16_bf16 v[228:243], v[212:215], v[144:147], v[228:243]
ds_read_b64_tr_b16 v[224:225], v5 offset:30720
ds_read_b64_tr_b16 v[226:227], v5 offset:31232
s_waitcnt lgkmcnt(4)
v_mfma_f32_32x32x16_bf16 v[228:243], v[216:219], v[148:151], v[228:243]
s_waitcnt lgkmcnt(2)
v_mfma_f32_32x32x16_bf16 v[228:243], v[220:223], v[152:155], v[228:243]
s_waitcnt lgkmcnt(0)
v_mfma_f32_32x32x16_bf16 v[228:243], v[224:227], v[156:159], v[228:243]
s_barrier
s_add_u32 m0, s13, 16384
s_add_u32 s3, s6, s74
s_add_u32 s3, s3, 4718592
buffer_load_dwordx4 v7, s[36:39], s3 offen lds
s_nop 7
s_nop 3
v_mul_f32 v248, v228, v228
v_mul_f32 v249, v229, v229
v_mul_f32 v250, v230, v230
buffer_load_dwordx4 v8, s[36:39], s3 offen offset:1024 lds
v_mul_f32 v251, v231, v231
v_fmaak_f32 v248, v248, v11, 0xc0135761
v_fmaak_f32 v249, v249, v11, 0xc0135761
v_fmaak_f32 v250, v250, v11, 0xc0135761
v_fmaak_f32 v251, v251, v11, 0xc0135761
v_mul_f32 v248, v228, v248
v_mul_f32 v249, v229, v249
s_add_u32 m0, s13, 24576
s_add_u32 s3, s7, s74
buffer_load_dwordx4 v7, s[36:39], s3 offen lds
v_mul_f32 v250, v230, v250
v_mul_f32 v251, v231, v251
v_exp_f32 v248, v248
v_exp_f32 v249, v249
v_exp_f32 v250, v250
v_exp_f32 v251, v251
v_add_f32 v248, 1.0, v248
v_add_f32 v249, 1.0, v249
buffer_load_dwordx4 v8, s[36:39], s3 offen offset:1024 lds
v_add_f32 v250, 1.0, v250
v_add_f32 v251, 1.0, v251
v_rcp_f32 v248, v248
v_rcp_f32 v249, v249
v_rcp_f32 v250, v250
v_rcp_f32 v251, v251
v_mul_f32 v248, v228, v248
s_barrier
s_add_u32 m0, s13, 32768
s_add_u32 s3, s3, 589824
buffer_load_dwordx4 v7, s[36:39], s3 offen lds
v_mul_f32 v249, v229, v249
v_mul_f32 v250, v230, v250
v_mul_f32 v251, v231, v251
v_cvt_pk_bf16_f32 v228, v248, v249
v_cvt_pk_bf16_f32 v229, v250, v251
v_mul_f32 v248, v232, v232
v_mul_f32 v249, v233, v233
buffer_load_dwordx4 v8, s[36:39], s3 offen offset:1024 lds
v_mul_f32 v250, v234, v234
v_mul_f32 v251, v235, v235
v_fmaak_f32 v248, v248, v11, 0xc0135761
v_fmaak_f32 v249, v249, v11, 0xc0135761
v_fmaak_f32 v250, v250, v11, 0xc0135761
v_fmaak_f32 v251, v251, v11, 0xc0135761
v_mul_f32 v248, v232, v248
v_mul_f32 v249, v233, v249
s_add_u32 m0, s13, 40960
s_add_u32 s3, s3, 589824
buffer_load_dwordx4 v7, s[36:39], s3 offen lds
v_mul_f32 v250, v234, v250
v_mul_f32 v251, v235, v251
v_exp_f32 v248, v248
v_exp_f32 v249, v249
v_exp_f32 v250, v250
v_exp_f32 v251, v251
v_add_f32 v248, 1.0, v248
buffer_load_dwordx4 v8, s[36:39], s3 offen offset:1024 lds
v_add_f32 v249, 1.0, v249
v_add_f32 v250, 1.0, v250
v_add_f32 v251, 1.0, v251
v_rcp_f32 v248, v248
v_rcp_f32 v249, v249
v_rcp_f32 v250, v250
v_rcp_f32 v251, v251
s_barrier
s_add_u32 m0, s13, 49152
s_add_u32 s3, s3, 589824
buffer_load_dwordx4 v7, s[36:39], s3 offen lds
v_mul_f32 v248, v232, v248
v_mul_f32 v249, v233, v249
v_mul_f32 v250, v234, v250
v_mul_f32 v251, v235, v251
v_cvt_pk_bf16_f32 v230, v248, v249
v_cvt_pk_bf16_f32 v231, v250, v251
v_mul_f32 v248, v236, v236
v_mul_f32 v249, v237, v237
buffer_load_dwordx4 v8, s[36:39], s3 offen offset:1024 lds
v_mul_f32 v250, v238, v238
v_mul_f32 v251, v239, v239
v_fmaak_f32 v248, v248, v11, 0xc0135761
v_fmaak_f32 v249, v249, v11, 0xc0135761
v_fmaak_f32 v250, v250, v11, 0xc0135761
v_fmaak_f32 v251, v251, v11, 0xc0135761
v_mul_f32 v248, v236, v248
s_add_u32 m0, s13, 57344
s_add_u32 s3, s3, 589824
buffer_load_dwordx4 v7, s[36:39], s3 offen lds
v_mul_f32 v249, v237, v249
v_mul_f32 v250, v238, v250
v_mul_f32 v251, v239, v251
v_exp_f32 v248, v248
v_exp_f32 v249, v249
v_exp_f32 v250, v250
v_exp_f32 v251, v251
buffer_load_dwordx4 v8, s[36:39], s3 offen offset:1024 lds
v_add_f32 v248, 1.0, v248
v_add_f32 v249, 1.0, v249
v_add_f32 v250, 1.0, v250
v_add_f32 v251, 1.0, v251
v_rcp_f32 v248, v248
v_rcp_f32 v249, v249
v_rcp_f32 v250, v250
s_waitcnt vmcnt(8)
s_barrier
s_add_u32 m0, s13, 65536
s_add_u32 s3, s3, 589824
buffer_load_dwordx4 v7, s[36:39], s3 offen lds
v_rcp_f32 v251, v251
v_mul_f32 v248, v236, v248
v_mul_f32 v249, v237, v249
v_mul_f32 v250, v238, v250
v_mul_f32 v251, v239, v251
v_cvt_pk_bf16_f32 v232, v248, v249
v_cvt_pk_bf16_f32 v233, v250, v251
v_mul_f32 v248, v240, v240
buffer_load_dwordx4 v8, s[36:39], s3 offen offset:1024 lds
v_mul_f32 v249, v241, v241
v_mul_f32 v250, v242, v242
v_mul_f32 v251, v243, v243
v_fmaak_f32 v248, v248, v11, 0xc0135761
v_fmaak_f32 v249, v249, v11, 0xc0135761
v_fmaak_f32 v250, v250, v11, 0xc0135761
v_fmaak_f32 v251, v251, v11, 0xc0135761
s_add_u32 m0, s13, 73728
s_add_u32 s3, s3, 589824
buffer_load_dwordx4 v7, s[36:39], s3 offen lds
v_mul_f32 v248, v240, v248
v_mul_f32 v249, v241, v249
v_mul_f32 v250, v242, v250
v_mul_f32 v251, v243, v251
v_exp_f32 v248, v248
v_exp_f32 v249, v249
v_exp_f32 v250, v250
buffer_load_dwordx4 v8, s[36:39], s3 offen offset:1024 lds
v_exp_f32 v251, v251
v_add_f32 v248, 1.0, v248
v_add_f32 v249, 1.0, v249
v_add_f32 v250, 1.0, v250
s_lshl_b32 s82, s7, 1
v_add_u32 v254, s82, v13
ds_read_b128 v[196:199], v254 offset:0
ds_read_b128 v[200:203], v254 offset:32
ds_read_b128 v[204:207], v254 offset:64
ds_read_b128 v[208:211], v254 offset:96
ds_read_b64_tr_b16 v[212:213], v5 offset:24576
ds_read_b64_tr_b16 v[214:215], v5 offset:25088
ds_read_b64_tr_b16 v[216:217], v5 offset:26624
ds_read_b64_tr_b16 v[218:219], v5 offset:27136
ds_read_b64_tr_b16 v[220:221], v5 offset:28672
ds_read_b64_tr_b16 v[222:223], v5 offset:29184
v_add_f32 v251, 1.0, v251
v_rcp_f32 v248, v248
v_rcp_f32 v249, v249
v_rcp_f32 v250, v250
s_waitcnt vmcnt(8)
s_barrier
s_add_u32 m0, s13, 0
s_add_u32 s3, s3, 589824
buffer_load_dwordx4 v7, s[36:39], s3 offen lds
v_rcp_f32 v251, v251
v_mul_f32 v248, v240, v248
v_mul_f32 v249, v241, v249
v_mul_f32 v250, v242, v250
v_mul_f32 v251, v243, v251
v_cvt_pk_bf16_f32 v234, v248, v249
v_cvt_pk_bf16_f32 v235, v250, v251
buffer_load_dwordx4 v8, s[36:39], s3 offen offset:1024 lds
s_lshl_b32 s82, s5, 5
v_add_u32 v255, s82, v12
ds_write_b128 v255, v[228:231] offset:0
ds_write_b128 v255, v[232:235] offset:1024
s_waitcnt lgkmcnt(8)
s_waitcnt lgkmcnt(6)
v_mfma_f32_32x32x16_bf16 v[196:211], v[212:215], v[16:19], v[196:211]
ds_read_b64_tr_b16 v[224:225], v5 offset:30720
ds_read_b64_tr_b16 v[226:227], v5 offset:31232
s_waitcnt lgkmcnt(6)
v_mfma_f32_32x32x16_bf16 v[196:211], v[216:219], v[20:23], v[196:211]
ds_read_b64_tr_b16 v[212:213], v5 offset:32768
ds_read_b64_tr_b16 v[214:215], v5 offset:33280
s_waitcnt lgkmcnt(6)
v_mfma_f32_32x32x16_bf16 v[196:211], v[220:223], v[24:27], v[196:211]
ds_read_b64_tr_b16 v[216:217], v5 offset:34816
ds_read_b64_tr_b16 v[218:219], v5 offset:35328
s_waitcnt lgkmcnt(4)
v_mfma_f32_32x32x16_bf16 v[196:211], v[224:227], v[28:31], v[196:211]
ds_read_b64_tr_b16 v[220:221], v5 offset:36864
ds_read_b64_tr_b16 v[222:223], v5 offset:37376
s_mov_b32 s85, 0
L_p2:
v_readfirstlane_b32 s96, v246
s_cmp_lg_u32 s96, 0
s_cbranch_scc1 L_pd2
s_sleep 1
buffer_load_dword v246, off, s[44:47], 0 sc1
s_waitcnt vmcnt(0)
s_add_u32 s85, s85, 1
s_cmp_lt_u32 s85, 0x100000
s_cbranch_scc1 L_p2
L_pd2:
s_waitcnt vmcnt(6) lgkmcnt(4)
s_barrier
v_mfma_f32_32x32x16_bf16 v[196:211], v[212:215], v[32:35], v[196:211]
ds_read_b64_tr_b16 v[224:225], v5 offset:38912
ds_read_b64_tr_b16 v[226:227], v5 offset:39424
s_waitcnt lgkmcnt(4)
v_mfma_f32_32x32x16_bf16 v[196:211], v[216:219], v[36:39], v[196:211]
ds_read_b64_tr_b16 v[212:213], v5 offset:40960
ds_read_b64_tr_b16 v[214:215], v5 offset:41472
s_waitcnt lgkmcnt(4)
v_mfma_f32_32x32x16_bf16 v[196:211], v[220:223], v[40:43], v[196:211]
ds_read_b64_tr_b16 v[216:217], v5 offset:43008
ds_read_b64_tr_b16 v[218:219], v5 offset:43520
s_waitcnt lgkmcnt(4)
v_mfma_f32_32x32x16_bf16 v[196:211], v[224:227], v[44:47], v[196:211]
ds_read_b64_tr_b16 v[220:221], v5 offset:45056
ds_read_b64_tr_b16 v[222:223], v5 offset:45568
s_waitcnt lgkmcnt(4)
v_mfma_f32_32x32x16_bf16 v[196:211], v[212:215], v[48:51], v[196:211]
ds_read_b64_tr_b16 v[224:225], v5 offset:47104
ds_read_b64_tr_b16 v[226:227], v5 offset:47616
s_waitcnt lgkmcnt(4)
v_mfma_f32_32x32x16_bf16 v[196:211], v[216:219], v[52:55], v[196:211]
ds_read_b64_tr_b16 v[212:213], v5 offset:49152
ds_read_b64_tr_b16 v[214:215], v5 offset:49664
s_waitcnt lgkmcnt(4)
v_mfma_f32_32x32x16_bf16 v[196:211], v[220:223], v[56:59], v[196:211]
ds_read_b64_tr_b16 v[216:217], v5 offset:51200
ds_read_b64_tr_b16 v[218:219], v5 offset:51712
s_waitcnt lgkmcnt(4)
v_mfma_f32_32x32x16_bf16 v[196:211], v[224:227], v[60:63], v[196:211]
ds_read_b64_tr_b16 v[220:221], v5 offset:53248
ds_read_b64_tr_b16 v[222:223], v5 offset:53760
s_waitcnt vmcnt(2) lgkmcnt(4)
s_barrier
v_mfma_f32_32x32x16_bf16 v[196:211], v[212:215], v[64:67], v[196:211]
ds_read_b64_tr_b16 v[224:225], v5 offset:55296
ds_read_b64_tr_b16 v[226:227], v5 offset:55808
s_waitcnt lgkmcnt(4)
v_mfma_f32_32x32x16_bf16 v[196:211], v[216:219], v[68:71], v[196:211]
ds_read_b64_tr_b16 v[212:213], v5 offset:57344
ds_read_b64_tr_b16 v[214:215], v5 offset:57856
s_waitcnt lgkmcnt(4)
v_mfma_f32_32x32x16_bf16 v[196:211], v[220:223], v[72:75], v[196:211]
ds_read_b64_tr_b16 v[216:217], v5 offset:59392
ds_read_b64_tr_b16 v[218:219], v5 offset:59904
s_waitcnt lgkmcnt(4)
v_mfma_f32_32x32x16_bf16 v[196:211], v[224:227], v[76:79], v[196:211]
ds_read_b64_tr_b16 v[220:221], v5 offset:61440
ds_read_b64_tr_b16 v[222:223], v5 offset:61952
s_waitcnt lgkmcnt(4)
v_mfma_f32_32x32x16_bf16 v[196:211], v[212:215], v[80:83], v[196:211]
ds_read_b64_tr_b16 v[224:225], v5 offset:63488
ds_read_b64_tr_b16 v[226:227], v5 offset:64000
s_waitcnt lgkmcnt(4)
v_mfma_f32_32x32x16_bf16 v[196:211], v[216:219], v[84:87], v[196:211]
ds_read_b64_tr_b16 v[212:213], v6 offset:0
ds_read_b64_tr_b16 v[214:215], v6 offset:512
s_waitcnt lgkmcnt(4)
v_mfma_f32_32x32x16_bf16 v[196:211], v[220:223], v[88:91], v[196:211]
ds_read_b64_tr_b16 v[216:217], v6 offset:2048
ds_read_b64_tr_b16 v[218:219], v6 offset:2560
s_waitcnt lgkmcnt(4)
v_mfma_f32_32x32x16_bf16 v[196:211], v[224:227], v[92:95], v[196:211]
ds_read_b64_tr_b16 v[220:221], v6 offset:4096
ds_read_b64_tr_b16 v[222:223], v6 offset:4608
s_waitcnt vmcnt(0) lgkmcnt(4)
s_barrier
v_mfma_f32_32x32x16_bf16 v[196:211], v[212:215], v[96:99], v[196:211]
ds_read_b64_tr_b16 v[224:225], v6 offset:6144
ds_read_b64_tr_b16 v[226:227], v6 offset:6656
s_waitcnt lgkmcnt(4)
v_mfma_f32_32x32x16_bf16 v[196:211], v[216:219], v[100:103], v[196:211]
ds_read_b64_tr_b16 v[212:213], v6 offset:8192
ds_read_b64_tr_b16 v[214:215], v6 offset:8704
s_waitcnt lgkmcnt(4)
v_mfma_f32_32x32x16_bf16 v[196:211], v[220:223], v[104:107], v[196:211]
ds_read_b64_tr_b16 v[216:217], v6 offset:10240
ds_read_b64_tr_b16 v[218:219], v6 offset:10752
s_waitcnt lgkmcnt(4)
v_mfma_f32_32x32x16_bf16 v[196:211], v[224:227], v[108:111], v[196:211]
ds_read_b64_tr_b16 v[220:221], v6 offset:12288
ds_read_b64_tr_b16 v[222:223], v6 offset:12800
s_waitcnt lgkmcnt(4)
v_mfma_f32_32x32x16_bf16 v[196:211], v[212:215], v[112:115], v[196:211]
ds_read_b64_tr_b16 v[224:225], v6 offset:14336
ds_read_b64_tr_b16 v[226:227], v6 offset:14848
s_waitcnt lgkmcnt(4)
v_mfma_f32_32x32x16_bf16 v[196:211], v[216:219], v[116:119], v[196:211]
ds_read_b64_tr_b16 v[212:213], v5 offset:0
ds_read_b64_tr_b16 v[214:215], v5 offset:512
s_waitcnt lgkmcnt(4)
v_mfma_f32_32x32x16_bf16 v[196:211], v[220:223], v[120:123], v[196:211]
ds_read_b64_tr_b16 v[216:217], v5 offset:2048
ds_read_b64_tr_b16 v[218:219], v5 offset:2560
s_waitcnt lgkmcnt(4)
v_mfma_f32_32x32x16_bf16 v[196:211], v[224:227], v[124:127], v[196:211]
ds_read_b64_tr_b16 v[220:221], v5 offset:4096
ds_read_b64_tr_b16 v[222:223], v5 offset:4608
s_waitcnt lgkmcnt(4)
s_barrier
v_mfma_f32_32x32x16_bf16 v[196:211], v[212:215], v[128:131], v[196:211]
ds_read_b64_tr_b16 v[224:225], v5 offset:6144
ds_read_b64_tr_b16 v[226:227], v5 offset:6656
s_waitcnt lgkmcnt(4)
v_mfma_f32_32x32x16_bf16 v[196:211], v[216:219], v[132:135], v[196:211]
ds_read_b64_tr_b16 v[212:213], v5 offset:8192
ds_read_b64_tr_b16 v[214:215], v5 offset:8704
s_waitcnt lgkmcnt(4)
v_mfma_f32_32x32x16_bf16 v[196:211], v[220:223], v[136:139], v[196:211]
ds_read_b64_tr_b16 v[216:217], v5 offset:10240
ds_read_b64_tr_b16 v[218:219], v5 offset:10752
s_waitcnt lgkmcnt(4)
v_mfma_f32_32x32x16_bf16 v[196:211], v[224:227], v[140:143], v[196:211]
ds_read_b64_tr_b16 v[220:221], v5 offset:12288
ds_read_b64_tr_b16 v[222:223], v5 offset:12800
s_waitcnt lgkmcnt(4)
v_mfma_f32_32x32x16_bf16 v[196:211], v[212:215], v[144:147], v[196:211]
ds_read_b64_tr_b16 v[224:225], v5 offset:14336
ds_read_b64_tr_b16 v[226:227], v5 offset:14848
s_waitcnt lgkmcnt(4)
v_mfma_f32_32x32x16_bf16 v[196:211], v[216:219], v[148:151], v[196:211]
s_waitcnt lgkmcnt(2)
v_mfma_f32_32x32x16_bf16 v[196:211], v[220:223], v[152:155], v[196:211]
s_waitcnt lgkmcnt(0)
v_mfma_f32_32x32x16_bf16 v[196:211], v[224:227], v[156:159], v[196:211]
s_barrier
s_add_u32 m0, s13, 0
s_add_u32 s3, s8, s74
s_add_u32 s3, s3, 4718592
buffer_load_dwordx4 v7, s[36:39], s3 offen lds
s_nop 7
s_nop 3
v_mul_f32 v248, v196, v196
v_mul_f32 v249, v197, v197
v_mul_f32 v250, v198, v198
buffer_load_dwordx4 v8, s[36:39], s3 offen offset:1024 lds
v_mul_f32 v251, v199, v199
v_fmaak_f32 v248, v248, v11, 0xc0135761
v_fmaak_f32 v249, v249, v11, 0xc0135761
v_fmaak_f32 v250, v250, v11, 0xc0135761
v_fmaak_f32 v251, v251, v11, 0xc0135761
v_mul_f32 v248, v196, v248
v_mul_f32 v249, v197, v249
s_add_u32 m0, s13, 8192
s_add_u32 s3, s9, s74
buffer_load_dwordx4 v7, s[36:39], s3 offen lds
v_mul_f32 v250, v198, v250
v_mul_f32 v251, v199, v251
v_exp_f32 v248, v248
v_exp_f32 v249, v249
v_exp_f32 v250, v250
v_exp_f32 v251, v251
v_add_f32 v248, 1.0, v248
v_add_f32 v249, 1.0, v249
buffer_load_dwordx4 v8, s[36:39], s3 offen offset:1024 lds
v_add_f32 v250, 1.0, v250
v_add_f32 v251, 1.0, v251
v_rcp_f32 v248, v248
v_rcp_f32 v249, v249
v_rcp_f32 v250, v250
v_rcp_f32 v251, v251
v_mul_f32 v248, v196, v248
s_barrier
s_add_u32 m0, s13, 16384
s_add_u32 s3, s3, 589824
buffer_load_dwordx4 v7, s[36:39], s3 offen lds
v_mul_f32 v249, v197, v249
v_mul_f32 v250, v198, v250
v_mul_f32 v251, v199, v251
v_cvt_pk_bf16_f32 v196, v248, v249
v_cvt_pk_bf16_f32 v197, v250, v251
v_mul_f32 v248, v200, v200
v_mul_f32 v249, v201, v201
buffer_load_dwordx4 v8, s[36:39], s3 offen offset:1024 lds
v_mul_f32 v250, v202, v202
v_mul_f32 v251, v203, v203
v_fmaak_f32 v248, v248, v11, 0xc0135761
v_fmaak_f32 v249, v249, v11, 0xc0135761
v_fmaak_f32 v250, v250, v11, 0xc0135761
v_fmaak_f32 v251, v251, v11, 0xc0135761
v_mul_f32 v248, v200, v248
v_mul_f32 v249, v201, v249
s_add_u32 m0, s13, 24576
s_add_u32 s3, s3, 589824
buffer_load_dwordx4 v7, s[36:39], s3 offen lds
v_mul_f32 v250, v202, v250
v_mul_f32 v251, v203, v251
v_exp_f32 v248, v248
v_exp_f32 v249, v249
v_exp_f32 v250, v250
v_exp_f32 v251, v251
v_add_f32 v248, 1.0, v248
buffer_load_dwordx4 v8, s[36:39], s3 offen offset:1024 lds
v_add_f32 v249, 1.0, v249
v_add_f32 v250, 1.0, v250
v_add_f32 v251, 1.0, v251
v_rcp_f32 v248, v248
v_rcp_f32 v249, v249
v_rcp_f32 v250, v250
v_rcp_f32 v251, v251
s_barrier
s_add_u32 m0, s13, 32768
s_add_u32 s3, s3, 589824
buffer_load_dwordx4 v7, s[36:39], s3 offen lds
v_mul_f32 v248, v200, v248
v_mul_f32 v249, v201, v249
v_mul_f32 v250, v202, v250
v_mul_f32 v251, v203, v251
v_cvt_pk_bf16_f32 v198, v248, v249
v_cvt_pk_bf16_f32 v199, v250, v251
v_mul_f32 v248, v204, v204
v_mul_f32 v249, v205, v205
buffer_load_dwordx4 v8, s[36:39], s3 offen offset:1024 lds
v_mul_f32 v250, v206, v206
v_mul_f32 v251, v207, v207
v_fmaak_f32 v248, v248, v11, 0xc0135761
v_fmaak_f32 v249, v249, v11, 0xc0135761
v_fmaak_f32 v250, v250, v11, 0xc0135761
v_fmaak_f32 v251, v251, v11, 0xc0135761
v_mul_f32 v248, v204, v248
s_add_u32 m0, s13, 40960
s_add_u32 s3, s3, 589824
buffer_load_dwordx4 v7, s[36:39], s3 offen lds
v_mul_f32 v249, v205, v249
v_mul_f32 v250, v206, v250
v_mul_f32 v251, v207, v251
v_exp_f32 v248, v248
v_exp_f32 v249, v249
v_exp_f32 v250, v250
v_exp_f32 v251, v251
buffer_load_dwordx4 v8, s[36:39], s3 offen offset:1024 lds
v_add_f32 v248, 1.0, v248
v_add_f32 v249, 1.0, v249
v_add_f32 v250, 1.0, v250
v_add_f32 v251, 1.0, v251
v_rcp_f32 v248, v248
v_rcp_f32 v249, v249
v_rcp_f32 v250, v250
s_waitcnt vmcnt(8)
s_barrier
s_add_u32 m0, s13, 49152
s_add_u32 s3, s3, 589824
buffer_load_dwordx4 v7, s[36:39], s3 offen lds
v_rcp_f32 v251, v251
v_mul_f32 v248, v204, v248
v_mul_f32 v249, v205, v249
v_mul_f32 v250, v206, v250
v_mul_f32 v251, v207, v251
v_cvt_pk_bf16_f32 v200, v248, v249
v_cvt_pk_bf16_f32 v201, v250, v251
v_mul_f32 v248, v208, v208
buffer_load_dwordx4 v8, s[36:39], s3 offen offset:1024 lds
v_mul_f32 v249, v209, v209
v_mul_f32 v250, v210, v210
v_mul_f32 v251, v211, v211
v_fmaak_f32 v248, v248, v11, 0xc0135761
v_fmaak_f32 v249, v249, v11, 0xc0135761
v_fmaak_f32 v250, v250, v11, 0xc0135761
v_fmaak_f32 v251, v251, v11, 0xc0135761
s_lshl_b32 s82, s69, 10
s_add_u32 s82, s82, s20
v_add_u32 v254, s82, v9
s_lshl_b32 s82, s70, 9
s_add_u32 s82, s82, 157952
v_add_u32 v253, s82, v10
ds_read_b128 v[180:183], v254
ds_read_b128 v[184:187], v253
s_add_u32 m0, s13, 57344
s_add_u32 s3, s3, 589824
buffer_load_dwordx4 v7, s[36:39], s3 offen lds
v_mul_f32 v248, v208, v248
v_mul_f32 v249, v209, v249
v_mul_f32 v250, v210, v250
v_mul_f32 v251, v211, v251
v_exp_f32 v248, v248
v_exp_f32 v249, v249
v_exp_f32 v250, v250
buffer_load_dwordx4 v8, s[36:39], s3 offen offset:1024 lds
v_exp_f32 v251, v251
v_add_f32 v248, 1.0, v248
v_add_f32 v249, 1.0, v249
v_add_f32 v250, 1.0, v250
s_lshl_b32 s82, s9, 1
v_add_u32 v254, s82, v13
ds_read_b128 v[228:231], v254 offset:0
ds_read_b128 v[232:235], v254 offset:32
ds_read_b128 v[236:239], v254 offset:64
ds_read_b128 v[240:243], v254 offset:96
ds_read_b64_tr_b16 v[212:213], v5 offset:8192
ds_read_b64_tr_b16 v[214:215], v5 offset:8704
ds_read_b64_tr_b16 v[216:217], v5 offset:10240
ds_read_b64_tr_b16 v[218:219], v5 offset:10752
ds_read_b64_tr_b16 v[220:221], v5 offset:12288
ds_read_b64_tr_b16 v[222:223], v5 offset:12800
v_add_f32 v251, 1.0, v251
v_rcp_f32 v248, v248
v_rcp_f32 v249, v249
v_rcp_f32 v250, v250
s_waitcnt vmcnt(8)
s_barrier
s_add_u32 m0, s13, 65536
s_add_u32 s3, s3, 589824
buffer_load_dwordx4 v7, s[36:39], s3 offen lds
v_rcp_f32 v251, v251
v_mul_f32 v248, v208, v248
v_mul_f32 v249, v209, v249
v_mul_f32 v250, v210, v250
v_mul_f32 v251, v211, v251
v_cvt_pk_bf16_f32 v202, v248, v249
v_cvt_pk_bf16_f32 v203, v250, v251
buffer_load_dwordx4 v8, s[36:39], s3 offen offset:1024 lds
s_lshl_b32 s82, s7, 5
v_add_u32 v255, s82, v12
ds_write_b128 v255, v[196:199] offset:0
ds_write_b128 v255, v[200:203] offset:1024
s_waitcnt lgkmcnt(8)
s_waitcnt lgkmcnt(6)
v_mfma_f32_32x32x16_bf16 v[228:243], v[212:215], v[16:19], v[228:243]
ds_read_b64_tr_b16 v[224:225], v5 offset:14336
ds_read_b64_tr_b16 v[226:227], v5 offset:14848
s_waitcnt lgkmcnt(6)
v_mfma_f32_32x32x16_bf16 v[228:243], v[216:219], v[20:23], v[228:243]
ds_read_b64_tr_b16 v[212:213], v5 offset:16384
ds_read_b64_tr_b16 v[214:215], v5 offset:16896
s_waitcnt lgkmcnt(6)
v_mfma_f32_32x32x16_bf16 v[228:243], v[220:223], v[24:27], v[228:243]
ds_read_b64_tr_b16 v[216:217], v5 offset:18432
ds_read_b64_tr_b16 v[218:219], v5 offset:18944
s_waitcnt lgkmcnt(4)
v_mfma_f32_32x32x16_bf16 v[228:243], v[224:227], v[28:31], v[228:243]
ds_read_b64_tr_b16 v[220:221], v5 offset:20480
ds_read_b64_tr_b16 v[222:223], v5 offset:20992
s_waitcnt vmcnt(6) lgkmcnt(4)
s_barrier
v_mfma_f32_32x32x16_bf16 v[228:243], v[212:215], v[32:35], v[228:243]
ds_read_b64_tr_b16 v[224:225], v5 offset:22528
ds_read_b64_tr_b16 v[226:227], v5 offset:23040
s_waitcnt lgkmcnt(4)
v_mfma_f32_32x32x16_bf16 v[228:243], v[216:219], v[36:39], v[228:243]
ds_read_b64_tr_b16 v[212:213], v5 offset:24576
ds_read_b64_tr_b16 v[214:215], v5 offset:25088
s_waitcnt lgkmcnt(4)
v_mfma_f32_32x32x16_bf16 v[228:243], v[220:223], v[40:43], v[228:243]
ds_read_b64_tr_b16 v[216:217], v5 offset:26624
ds_read_b64_tr_b16 v[218:219], v5 offset:27136
s_waitcnt lgkmcnt(4)
v_mfma_f32_32x32x16_bf16 v[228:243], v[224:227], v[44:47], v[228:243]
ds_read_b64_tr_b16 v[220:221], v5 offset:28672
ds_read_b64_tr_b16 v[222:223], v5 offset:29184
s_waitcnt lgkmcnt(4)
v_mfma_f32_32x32x16_bf16 v[228:243], v[212:215], v[48:51], v[228:243]
ds_read_b64_tr_b16 v[224:225], v5 offset:30720
ds_read_b64_tr_b16 v[226:227], v5 offset:31232
s_waitcnt lgkmcnt(4)
v_mfma_f32_32x32x16_bf16 v[228:243], v[216:219], v[52:55], v[228:243]
ds_read_b64_tr_b16 v[212:213], v5 offset:32768
ds_read_b64_tr_b16 v[214:215], v5 offset:33280
s_waitcnt lgkmcnt(4)
v_mfma_f32_32x32x16_bf16 v[228:243], v[220:223], v[56:59], v[228:243]
ds_read_b64_tr_b16 v[216:217], v5 offset:34816
ds_read_b64_tr_b16 v[218:219], v5 offset:35328
s_waitcnt lgkmcnt(4)
v_mfma_f32_32x32x16_bf16 v[228:243], v[224:227], v[60:63], v[228:243]
ds_read_b64_tr_b16 v[220:221], v5 offset:36864
ds_read_b64_tr_b16 v[222:223], v5 offset:37376
s_waitcnt vmcnt(2) lgkmcnt(4)
s_barrier
v_mfma_f32_32x32x16_bf16 v[228:243], v[212:215], v[64:67], v[228:243]
ds_read_b64_tr_b16 v[224:225], v5 offset:38912
ds_read_b64_tr_b16 v[226:227], v5 offset:39424
s_waitcnt lgkmcnt(4)
v_mfma_f32_32x32x16_bf16 v[228:243], v[216:219], v[68:71], v[228:243]
ds_read_b64_tr_b16 v[212:213], v5 offset:40960
ds_read_b64_tr_b16 v[214:215], v5 offset:41472
s_waitcnt lgkmcnt(4)
v_mfma_f32_32x32x16_bf16 v[228:243], v[220:223], v[72:75], v[228:243]
ds_read_b64_tr_b16 v[216:217], v5 offset:43008
ds_read_b64_tr_b16 v[218:219], v5 offset:43520
s_waitcnt lgkmcnt(4)
v_mfma_f32_32x32x16_bf16 v[228:243], v[224:227], v[76:79], v[228:243]
ds_read_b64_tr_b16 v[220:221], v5 offset:45056
ds_read_b64_tr_b16 v[222:223], v5 offset:45568
s_waitcnt lgkmcnt(4)
v_mfma_f32_32x32x16_bf16 v[228:243], v[212:215], v[80:83], v[228:243]
ds_read_b64_tr_b16 v[224:225], v5 offset:47104
ds_read_b64_tr_b16 v[226:227], v5 offset:47616
s_waitcnt lgkmcnt(4)
v_mfma_f32_32x32x16_bf16 v[228:243], v[216:219], v[84:87], v[228:243]
ds_read_b64_tr_b16 v[212:213], v5 offset:49152
ds_read_b64_tr_b16 v[214:215], v5 offset:49664
s_waitcnt lgkmcnt(4)
v_mfma_f32_32x32x16_bf16 v[228:243], v[220:223], v[88:91], v[228:243]
ds_read_b64_tr_b16 v[216:217], v5 offset:51200
ds_read_b64_tr_b16 v[218:219], v5 offset:51712
s_waitcnt lgkmcnt(4)
v_mfma_f32_32x32x16_bf16 v[228:243], v[224:227], v[92:95], v[228:243]
ds_read_b64_tr_b16 v[220:221], v5 offset:53248
ds_read_b64_tr_b16 v[222:223], v5 offset:53760
s_waitcnt vmcnt(0) lgkmcnt(4)
s_barrier
v_mfma_f32_32x32x16_bf16 v[228:243], v[212:215], v[96:99], v[228:243]
ds_read_b64_tr_b16 v[224:225], v5 offset:55296
ds_read_b64_tr_b16 v[226:227], v5 offset:55808
s_waitcnt lgkmcnt(4)
v_mfma_f32_32x32x16_bf16 v[228:243], v[216:219], v[100:103], v[228:243]
ds_read_b64_tr_b16 v[212:213], v5 offset:57344
ds_read_b64_tr_b16 v[214:215], v5 offset:57856
s_waitcnt lgkmcnt(4)
v_mfma_f32_32x32x16_bf16 v[228:243], v[220:223], v[104:107], v[228:243]
ds_read_b64_tr_b16 v[216:217], v5 offset:59392
ds_read_b64_tr_b16 v[218:219], v5 offset:59904
s_waitcnt lgkmcnt(4)
v_mfma_f32_32x32x16_bf16 v[228:243], v[224:227], v[108:111], v[228:243]
ds_read_b64_tr_b16 v[220:221], v5 offset:61440
ds_read_b64_tr_b16 v[222:223], v5 offset:61952
s_waitcnt lgkmcnt(4)
v_mfma_f32_32x32x16_bf16 v[228:243], v[212:215], v[112:115], v[228:243]
ds_read_b64_tr_b16 v[224:225], v5 offset:63488
ds_read_b64_tr_b16 v[226:227], v5 offset:64000
s_waitcnt lgkmcnt(4)
v_mfma_f32_32x32x16_bf16 v[228:243], v[216:219], v[116:119], v[228:243]
ds_read_b64_tr_b16 v[212:213], v6 offset:0
ds_read_b64_tr_b16 v[214:215], v6 offset:512
s_waitcnt lgkmcnt(4)
v_mfma_f32_32x32x16_bf16 v[228:243], v[220:223], v[120:123], v[228:243]
ds_read_b64_tr_b16 v[216:217], v6 offset:2048
ds_read_b64_tr_b16 v[218:219], v6 offset:2560
s_waitcnt lgkmcnt(4)
v_mfma_f32_32x32x16_bf16 v[228:243], v[224:227], v[124:127], v[228:243]
ds_read_b64_tr_b16 v[220:221], v6 offset:4096
ds_read_b64_tr_b16 v[222:223], v6 offset:4608
s_waitcnt lgkmcnt(4)
s_barrier
v_mfma_f32_32x32x16_bf16 v[228:243], v[212:215], v[128:131], v[228:243]
ds_read_b64_tr_b16 v[224:225], v6 offset:6144
ds_read_b64_tr_b16 v[226:227], v6 offset:6656
s_waitcnt lgkmcnt(4)
v_mfma_f32_32x32x16_bf16 v[228:243], v[216:219], v[132:135], v[228:243]
ds_read_b64_tr_b16 v[212:213], v6 offset:8192
ds_read_b64_tr_b16 v[214:215], v6 offset:8704
s_waitcnt lgkmcnt(4)
v_mfma_f32_32x32x16_bf16 v[228:243], v[220:223], v[136:139], v[228:243]
ds_read_b64_tr_b16 v[216:217], v6 offset:10240
ds_read_b64_tr_b16 v[218:219], v6 offset:10752
s_waitcnt lgkmcnt(4)
v_mfma_f32_32x32x16_bf16 v[228:243], v[224:227], v[140:143], v[228:243]
ds_read_b64_tr_b16 v[220:221], v6 offset:12288
ds_read_b64_tr_b16 v[222:223], v6 offset:12800
s_waitcnt lgkmcnt(4)
v_mfma_f32_32x32x16_bf16 v[228:243], v[212:215], v[144:147], v[228:243]
ds_read_b64_tr_b16 v[224:225], v6 offset:14336
ds_read_b64_tr_b16 v[226:227], v6 offset:14848
s_waitcnt lgkmcnt(4)
v_mfma_f32_32x32x16_bf16 v[228:243], v[216:219], v[148:151], v[228:243]
s_waitcnt lgkmcnt(2)
v_mfma_f32_32x32x16_bf16 v[228:243], v[220:223], v[152:155], v[228:243]
s_waitcnt lgkmcnt(0)
v_mfma_f32_32x32x16_bf16 v[228:243], v[224:227], v[156:159], v[228:243]
s_barrier
s_add_u32 m0, s13, 65536
s_add_u32 s3, s10, s74
s_add_u32 s3, s3, 4718592
buffer_load_dwordx4 v7, s[36:39], s3 offen lds
s_nop 7
s_nop 3
v_mul_f32 v248, v228, v228
v_mul_f32 v249, v229, v229
v_mul_f32 v250, v230, v230
buffer_load_dwordx4 v8, s[36:39], s3 offen offset:1024 lds
v_mul_f32 v251, v231, v231
v_fmaak_f32 v248, v248, v11, 0xc0135761
v_fmaak_f32 v249, v249, v11, 0xc0135761
v_fmaak_f32 v250, v250, v11, 0xc0135761
v_fmaak_f32 v251, v251, v11, 0xc0135761
v_mul_f32 v248, v228, v248
v_mul_f32 v249, v229, v249
s_add_u32 m0, s13, 73728
s_add_u32 s3, s11, s74
buffer_load_dwordx4 v7, s[36:39], s3 offen lds
v_mul_f32 v250, v230, v250
v_mul_f32 v251, v231, v251
v_exp_f32 v248, v248
v_exp_f32 v249, v249
v_exp_f32 v250, v250
v_exp_f32 v251, v251
v_add_f32 v248, 1.0, v248
v_add_f32 v249, 1.0, v249
buffer_load_dwordx4 v8, s[36:39], s3 offen offset:1024 lds
v_add_f32 v250, 1.0, v250
v_add_f32 v251, 1.0, v251
v_rcp_f32 v248, v248
v_rcp_f32 v249, v249
v_rcp_f32 v250, v250
v_rcp_f32 v251, v251
v_mul_f32 v248, v228, v248
s_barrier
s_add_u32 m0, s13, 0
s_add_u32 s3, s3, 589824
buffer_load_dwordx4 v7, s[36:39], s3 offen lds
v_mul_f32 v249, v229, v249
v_mul_f32 v250, v230, v250
v_mul_f32 v251, v231, v251
v_cvt_pk_bf16_f32 v228, v248, v249
v_cvt_pk_bf16_f32 v229, v250, v251
v_mul_f32 v248, v232, v232
v_mul_f32 v249, v233, v233
buffer_load_dwordx4 v8, s[36:39], s3 offen offset:1024 lds
v_mul_f32 v250, v234, v234
v_mul_f32 v251, v235, v235
v_fmaak_f32 v248, v248, v11, 0xc0135761
v_fmaak_f32 v249, v249, v11, 0xc0135761
v_fmaak_f32 v250, v250, v11, 0xc0135761
v_fmaak_f32 v251, v251, v11, 0xc0135761
v_mul_f32 v248, v232, v248
v_mul_f32 v249, v233, v249
s_add_u32 m0, s13, 8192
s_add_u32 s3, s3, 589824
buffer_load_dwordx4 v7, s[36:39], s3 offen lds
v_mul_f32 v250, v234, v250
v_mul_f32 v251, v235, v251
v_exp_f32 v248, v248
v_exp_f32 v249, v249
v_exp_f32 v250, v250
v_exp_f32 v251, v251
v_add_f32 v248, 1.0, v248
buffer_load_dwordx4 v8, s[36:39], s3 offen offset:1024 lds
v_add_f32 v249, 1.0, v249
v_add_f32 v250, 1.0, v250
v_add_f32 v251, 1.0, v251
v_rcp_f32 v248, v248
v_rcp_f32 v249, v249
v_rcp_f32 v250, v250
v_rcp_f32 v251, v251
s_barrier
s_add_u32 m0, s13, 16384
s_add_u32 s3, s3, 589824
buffer_load_dwordx4 v7, s[36:39], s3 offen lds
v_mul_f32 v248, v232, v248
v_mul_f32 v249, v233, v249
v_mul_f32 v250, v234, v250
v_mul_f32 v251, v235, v251
v_cvt_pk_bf16_f32 v230, v248, v249
v_cvt_pk_bf16_f32 v231, v250, v251
v_mul_f32 v248, v236, v236
v_mul_f32 v249, v237, v237
buffer_load_dwordx4 v8, s[36:39], s3 offen offset:1024 lds
v_mul_f32 v250, v238, v238
v_mul_f32 v251, v239, v239
v_fmaak_f32 v248, v248, v11, 0xc0135761
v_fmaak_f32 v249, v249, v11, 0xc0135761
v_fmaak_f32 v250, v250, v11, 0xc0135761
v_fmaak_f32 v251, v251, v11, 0xc0135761
v_mul_f32 v248, v236, v248
s_add_u32 m0, s13, 24576
s_add_u32 s3, s3, 589824
buffer_load_dwordx4 v7, s[36:39], s3 offen lds
v_mul_f32 v249, v237, v249
v_mul_f32 v250, v238, v250
v_mul_f32 v251, v239, v251
v_exp_f32 v248, v248
v_exp_f32 v249, v249
v_exp_f32 v250, v250
v_exp_f32 v251, v251
buffer_load_dwordx4 v8, s[36:39], s3 offen offset:1024 lds
v_add_f32 v248, 1.0, v248
v_add_f32 v249, 1.0, v249
v_add_f32 v250, 1.0, v250
v_add_f32 v251, 1.0, v251
v_rcp_f32 v248, v248
v_rcp_f32 v249, v249
v_rcp_f32 v250, v250
s_waitcnt vmcnt(8)
s_barrier
s_add_u32 m0, s13, 32768
s_add_u32 s3, s3, 589824
buffer_load_dwordx4 v7, s[36:39], s3 offen lds
v_rcp_f32 v251, v251
v_mul_f32 v248, v236, v248
v_mul_f32 v249, v237, v249
v_mul_f32 v250, v238, v250
v_mul_f32 v251, v239, v251
v_cvt_pk_bf16_f32 v232, v248, v249
v_cvt_pk_bf16_f32 v233, v250, v251
v_mul_f32 v248, v240, v240
buffer_load_dwordx4 v8, s[36:39], s3 offen offset:1024 lds
v_mul_f32 v249, v241, v241
v_mul_f32 v250, v242, v242
v_mul_f32 v251, v243, v243
v_fmaak_f32 v248, v248, v11, 0xc0135761
v_fmaak_f32 v249, v249, v11, 0xc0135761
v_fmaak_f32 v250, v250, v11, 0xc0135761
v_fmaak_f32 v251, v251, v11, 0xc0135761
s_add_u32 m0, s13, 40960
s_add_u32 s3, s3, 589824
buffer_load_dwordx4 v7, s[36:39], s3 offen lds
v_mul_f32 v248, v240, v248
v_mul_f32 v249, v241, v249
v_mul_f32 v250, v242, v250
v_mul_f32 v251, v243, v251
v_exp_f32 v248, v248
v_exp_f32 v249, v249
v_exp_f32 v250, v250
buffer_load_dwordx4 v8, s[36:39], s3 offen offset:1024 lds
v_exp_f32 v251, v251
v_add_f32 v248, 1.0, v248
v_add_f32 v249, 1.0, v249
v_add_f32 v250, 1.0, v250
s_lshl_b32 s82, s11, 1
v_add_u32 v254, s82, v13
ds_read_b128 v[196:199], v254 offset:0
ds_read_b128 v[200:203], v254 offset:32
ds_read_b128 v[204:207], v254 offset:64
ds_read_b128 v[208:211], v254 offset:96
ds_read_b64_tr_b16 v[212:213], v6 offset:8192
ds_read_b64_tr_b16 v[214:215], v6 offset:8704
ds_read_b64_tr_b16 v[216:217], v6 offset:10240
ds_read_b64_tr_b16 v[218:219], v6 offset:10752
ds_read_b64_tr_b16 v[220:221], v6 offset:12288
ds_read_b64_tr_b16 v[222:223], v6 offset:12800
v_add_f32 v251, 1.0, v251
v_rcp_f32 v248, v248
v_rcp_f32 v249, v249
v_rcp_f32 v250, v250
s_waitcnt vmcnt(8)
s_barrier
s_add_u32 m0, s13, 49152
s_add_u32 s3, s3, 589824
buffer_load_dwordx4 v7, s[36:39], s3 offen lds
v_rcp_f32 v251, v251
v_mul_f32 v248, v240, v248
v_mul_f32 v249, v241, v249
v_mul_f32 v250, v242, v250
v_mul_f32 v251, v243, v251
v_cvt_pk_bf16_f32 v234, v248, v249
v_cvt_pk_bf16_f32 v235, v250, v251
buffer_load_dwordx4 v8, s[36:39], s3 offen offset:1024 lds
s_lshl_b32 s82, s9, 5
v_add_u32 v255, s82, v12
ds_write_b128 v255, v[228:231] offset:0
ds_write_b128 v255, v[232:235] offset:1024
s_lshl_b32 s82, s71, 5
s_add_u32 s82, s82, s72
s_lshl_b32 s82, s82, 2
s_add_u32 s82, s82, 9437168
v_and_b32 v247, 3, v1
v_lshl_add_u32 v247, v247, 2, s82
buffer_load_dword v246, v247, s[56:59], 0 offen sc1
s_waitcnt lgkmcnt(8)
s_waitcnt lgkmcnt(6)
v_mfma_f32_32x32x16_bf16 v[196:211], v[212:215], v[16:19], v[196:211]
ds_read_b64_tr_b16 v[224:225], v6 offset:14336
ds_read_b64_tr_b16 v[226:227], v6 offset:14848
s_waitcnt lgkmcnt(6)
v_mfma_f32_32x32x16_bf16 v[196:211], v[216:219], v[20:23], v[196:211]
ds_read_b64_tr_b16 v[212:213], v5 offset:0
ds_read_b64_tr_b16 v[214:215], v5 offset:512
s_waitcnt lgkmcnt(6)
v_mfma_f32_32x32x16_bf16 v[196:211], v[220:223], v[24:27], v[196:211]
ds_read_b64_tr_b16 v[216:217], v5 offset:2048
ds_read_b64_tr_b16 v[218:219], v5 offset:2560
s_waitcnt lgkmcnt(4)
v_mfma_f32_32x32x16_bf16 v[196:211], v[224:227], v[28:31], v[196:211]
ds_read_b64_tr_b16 v[220:221], v5 offset:4096
ds_read_b64_tr_b16 v[222:223], v5 offset:4608
s_waitcnt vmcnt(7) lgkmcnt(4)
s_barrier
v_mfma_f32_32x32x16_bf16 v[196:211], v[212:215], v[32:35], v[196:211]
ds_read_b64_tr_b16 v[224:225], v5 offset:6144
ds_read_b64_tr_b16 v[226:227], v5 offset:6656
s_waitcnt lgkmcnt(4)
v_mfma_f32_32x32x16_bf16 v[196:211], v[216:219], v[36:39], v[196:211]
ds_read_b64_tr_b16 v[212:213], v5 offset:8192
ds_read_b64_tr_b16 v[214:215], v5 offset:8704
s_waitcnt lgkmcnt(4)
v_mfma_f32_32x32x16_bf16 v[196:211], v[220:223], v[40:43], v[196:211]
ds_read_b64_tr_b16 v[216:217], v5 offset:10240
ds_read_b64_tr_b16 v[218:219], v5 offset:10752
s_waitcnt lgkmcnt(4)
v_mfma_f32_32x32x16_bf16 v[196:211], v[224:227], v[44:47], v[196:211]
ds_read_b64_tr_b16 v[220:221], v5 offset:12288
ds_read_b64_tr_b16 v[222:223], v5 offset:12800
s_waitcnt lgkmcnt(4)
v_mfma_f32_32x32x16_bf16 v[196:211], v[212:215], v[48:51], v[196:211]
ds_read_b64_tr_b16 v[224:225], v5 offset:14336
ds_read_b64_tr_b16 v[226:227], v5 offset:14848
s_waitcnt lgkmcnt(4)
v_mfma_f32_32x32x16_bf16 v[196:211], v[216:219], v[52:55], v[196:211]
ds_read_b64_tr_b16 v[212:213], v5 offset:16384
ds_read_b64_tr_b16 v[214:215], v5 offset:16896
s_waitcnt lgkmcnt(4)
v_mfma_f32_32x32x16_bf16 v[196:211], v[220:223], v[56:59], v[196:211]
ds_read_b64_tr_b16 v[216:217], v5 offset:18432
ds_read_b64_tr_b16 v[218:219], v5 offset:18944
s_waitcnt lgkmcnt(4)
v_mfma_f32_32x32x16_bf16 v[196:211], v[224:227], v[60:63], v[196:211]
ds_read_b64_tr_b16 v[220:221], v5 offset:20480
ds_read_b64_tr_b16 v[222:223], v5 offset:20992
s_waitcnt vmcnt(3) lgkmcnt(4)
s_barrier
v_mfma_f32_32x32x16_bf16 v[196:211], v[212:215], v[64:67], v[196:211]
ds_read_b64_tr_b16 v[224:225], v5 offset:22528
ds_read_b64_tr_b16 v[226:227], v5 offset:23040
s_waitcnt lgkmcnt(4)
v_mfma_f32_32x32x16_bf16 v[196:211], v[216:219], v[68:71], v[196:211]
ds_read_b64_tr_b16 v[212:213], v5 offset:24576
ds_read_b64_tr_b16 v[214:215], v5 offset:25088
s_waitcnt lgkmcnt(4)
v_mfma_f32_32x32x16_bf16 v[196:211], v[220:223], v[72:75], v[196:211]
ds_read_b64_tr_b16 v[216:217], v5 offset:26624
ds_read_b64_tr_b16 v[218:219], v5 offset:27136
s_waitcnt lgkmcnt(4)
v_mfma_f32_32x32x16_bf16 v[196:211], v[224:227], v[76:79], v[196:211]
ds_read_b64_tr_b16 v[220:221], v5 offset:28672
ds_read_b64_tr_b16 v[222:223], v5 offset:29184
s_waitcnt lgkmcnt(4)
v_mfma_f32_32x32x16_bf16 v[196:211], v[212:215], v[80:83], v[196:211]
ds_read_b64_tr_b16 v[224:225], v5 offset:30720
ds_read_b64_tr_b16 v[226:227], v5 offset:31232
s_waitcnt lgkmcnt(4)
v_mfma_f32_32x32x16_bf16 v[196:211], v[216:219], v[84:87], v[196:211]
ds_read_b64_tr_b16 v[212:213], v5 offset:32768
ds_read_b64_tr_b16 v[214:215], v5 offset:33280
s_waitcnt lgkmcnt(4)
v_mfma_f32_32x32x16_bf16 v[196:211], v[220:223], v[88:91], v[196:211]
ds_read_b64_tr_b16 v[216:217], v5 offset:34816
ds_read_b64_tr_b16 v[218:219], v5 offset:35328
s_waitcnt lgkmcnt(4)
v_mfma_f32_32x32x16_bf16 v[196:211], v[224:227], v[92:95], v[196:211]
ds_read_b64_tr_b16 v[220:221], v5 offset:36864
ds_read_b64_tr_b16 v[222:223], v5 offset:37376
s_waitcnt vmcnt(1) lgkmcnt(4)
s_barrier
v_mfma_f32_32x32x16_bf16 v[196:211], v[212:215], v[96:99], v[196:211]
ds_read_b64_tr_b16 v[224:225], v5 offset:38912
ds_read_b64_tr_b16 v[226:227], v5 offset:39424
s_waitcnt lgkmcnt(4)
v_mfma_f32_32x32x16_bf16 v[196:211], v[216:219], v[100:103], v[196:211]
ds_read_b64_tr_b16 v[212:213], v5 offset:40960
ds_read_b64_tr_b16 v[214:215], v5 offset:41472
s_waitcnt lgkmcnt(4)
v_mfma_f32_32x32x16_bf16 v[196:211], v[220:223], v[104:107], v[196:211]
ds_read_b64_tr_b16 v[216:217], v5 offset:43008
ds_read_b64_tr_b16 v[218:219], v5 offset:43520
s_waitcnt lgkmcnt(4)
v_mfma_f32_32x32x16_bf16 v[196:211], v[224:227], v[108:111], v[196:211]
ds_read_b64_tr_b16 v[220:221], v5 offset:45056
ds_read_b64_tr_b16 v[222:223], v5 offset:45568
s_waitcnt lgkmcnt(4)
v_mfma_f32_32x32x16_bf16 v[196:211], v[212:215], v[112:115], v[196:211]
ds_read_b64_tr_b16 v[224:225], v5 offset:47104
ds_read_b64_tr_b16 v[226:227], v5 offset:47616
s_waitcnt lgkmcnt(4)
v_mfma_f32_32x32x16_bf16 v[196:211], v[216:219], v[116:119], v[196:211]
ds_read_b64_tr_b16 v[212:213], v5 offset:49152
ds_read_b64_tr_b16 v[214:215], v5 offset:49664
s_waitcnt lgkmcnt(4)
v_mfma_f32_32x32x16_bf16 v[196:211], v[220:223], v[120:123], v[196:211]
ds_read_b64_tr_b16 v[216:217], v5 offset:51200
ds_read_b64_tr_b16 v[218:219], v5 offset:51712
s_waitcnt lgkmcnt(4)
v_mfma_f32_32x32x16_bf16 v[196:211], v[224:227], v[124:127], v[196:211]
ds_read_b64_tr_b16 v[220:221], v5 offset:53248
ds_read_b64_tr_b16 v[222:223], v5 offset:53760
s_waitcnt lgkmcnt(4)
s_barrier
v_mfma_f32_32x32x16_bf16 v[196:211], v[212:215], v[128:131], v[196:211]
ds_read_b64_tr_b16 v[224:225], v5 offset:55296
ds_read_b64_tr_b16 v[226:227], v5 offset:55808
s_waitcnt lgkmcnt(4)
v_mfma_f32_32x32x16_bf16 v[196:211], v[216:219], v[132:135], v[196:211]
ds_read_b64_tr_b16 v[212:213], v5 offset:57344
ds_read_b64_tr_b16 v[214:215], v5 offset:57856
s_waitcnt lgkmcnt(4)
v_mfma_f32_32x32x16_bf16 v[196:211], v[220:223], v[136:139], v[196:211]
ds_read_b64_tr_b16 v[216:217], v5 offset:59392
ds_read_b64_tr_b16 v[218:219], v5 offset:59904
s_waitcnt lgkmcnt(4)
v_mfma_f32_32x32x16_bf16 v[196:211], v[224:227], v[140:143], v[196:211]
ds_read_b64_tr_b16 v[220:221], v5 offset:61440
ds_read_b64_tr_b16 v[222:223], v5 offset:61952
s_waitcnt lgkmcnt(4)
v_mfma_f32_32x32x16_bf16 v[196:211], v[212:215], v[144:147], v[196:211]
ds_read_b64_tr_b16 v[224:225], v5 offset:63488
ds_read_b64_tr_b16 v[226:227], v5 offset:64000
s_waitcnt lgkmcnt(4)
v_mfma_f32_32x32x16_bf16 v[196:211], v[216:219], v[148:151], v[196:211]
s_waitcnt lgkmcnt(2)
v_mfma_f32_32x32x16_bf16 v[196:211], v[220:223], v[152:155], v[196:211]
s_waitcnt lgkmcnt(0)
v_mfma_f32_32x32x16_bf16 v[196:211], v[224:227], v[156:159], v[196:211]
s_barrier
s_add_u32 m0, s13, 49152
s_add_u32 s3, s12, s74
s_add_u32 s3, s3, 4718592
buffer_load_dwordx4 v7, s[36:39], s3 offen lds
s_nop 7
s_nop 3
v_mul_f32 v248, v196, v196
v_mul_f32 v249, v197, v197
v_mul_f32 v250, v198, v198
v_mul_f32 v251, v199, v199
v_fmaak_f32 v248, v248, v11, 0xc0135761
buffer_load_dwordx4 v8, s[36:39], s3 offen offset:1024 lds
v_fmaak_f32 v249, v249, v11, 0xc0135761
v_fmaak_f32 v250, v250, v11, 0xc0135761
v_fmaak_f32 v251, v251, v11, 0xc0135761
v_mul_f32 v248, v196, v248
v_mul_f32 v249, v197, v249
v_mul_f32 v250, v198, v250
v_mul_f32 v251, v199, v251
v_exp_f32 v248, v248
v_exp_f32 v249, v249
v_exp_f32 v250, v250
v_exp_f32 v251, v251
v_add_f32 v248, 1.0, v248
v_add_f32 v249, 1.0, v249
v_add_f32 v250, 1.0, v250
v_add_f32 v251, 1.0, v251
v_rcp_f32 v248, v248
v_rcp_f32 v249, v249
v_rcp_f32 v250, v250
v_rcp_f32 v251, v251
v_mul_f32 v248, v196, v248
v_mul_f32 v249, v197, v249
v_mul_f32 v250, v198, v250
v_mul_f32 v251, v199, v251
v_cvt_pk_bf16_f32 v196, v248, v249
v_cvt_pk_bf16_f32 v197, v250, v251
v_mul_f32 v248, v200, v200
v_mul_f32 v249, v201, v201
v_mul_f32 v250, v202, v202
v_mul_f32 v251, v203, v203
v_fmaak_f32 v248, v248, v11, 0xc0135761
v_fmaak_f32 v249, v249, v11, 0xc0135761
v_fmaak_f32 v250, v250, v11, 0xc0135761
v_fmaak_f32 v251, v251, v11, 0xc0135761
v_mul_f32 v248, v200, v248
v_mul_f32 v249, v201, v249
v_mul_f32 v250, v202, v250
s_barrier
s_sub_u32 s82, 4, s72
s_max_i32 s82, s82, 0
s_lshl_b32 s83, 15, s82
s_and_b32 s83, s83, 15
s_waitcnt vmcnt(2)
s_mov_b32 s85, 0
L_p3:
v_cmp_eq_u32 s[26:27], s96, v246
s_nop 1
s_andn2_b32 s80, s83, s26
s_cmp_eq_u32 s80, 0
s_cbranch_scc1 L_pd3
s_sleep 1
buffer_load_dword v246, v247, s[56:59], 0 offen sc1
s_waitcnt vmcnt(0)
s_add_u32 s85, s85, 1
s_cmp_lt_u32 s85, 0x100000
s_cbranch_scc1 L_p3
L_pd3:
s_add_u32 m0, s13, 65536
v_add_u32 v15, 0, v14
buffer_load_dwordx4 v15, s[40:43], 0 offen sc1 lds
v_mul_f32 v251, v203, v251
v_exp_f32 v248, v248
v_exp_f32 v249, v249
v_exp_f32 v250, v250
v_exp_f32 v251, v251
v_add_f32 v248, 1.0, v248
v_add_f32 v249, 1.0, v249
v_add_f32 v250, 1.0, v250
v_add_f32 v251, 1.0, v251
v_rcp_f32 v248, v248
v_rcp_f32 v249, v249
v_rcp_f32 v250, v250
buffer_load_dwordx4 v15, s[40:43], 0 offen offset:1024 sc1 lds
v_rcp_f32 v251, v251
v_mul_f32 v248, v200, v248
v_mul_f32 v249, v201, v249
v_mul_f32 v250, v202, v250
v_mul_f32 v251, v203, v251
v_cvt_pk_bf16_f32 v198, v248, v249
v_cvt_pk_bf16_f32 v199, v250, v251
v_mul_f32 v248, v204, v204
v_mul_f32 v249, v205, v205
v_mul_f32 v250, v206, v206
v_mul_f32 v251, v207, v207
v_fmaak_f32 v248, v248, v11, 0xc0135761
s_add_u32 m0, s13, 73728
v_add_u32 v15, 8192, v14
buffer_load_dwordx4 v15, s[40:43], 0 offen sc1 lds
v_fmaak_f32 v249, v249, v11, 0xc0135761
v_fmaak_f32 v250, v250, v11, 0xc0135761
v_fmaak_f32 v251, v251, v11, 0xc0135761
v_mul_f32 v248, v204, v248
v_mul_f32 v249, v205, v249
v_mul_f32 v250, v206, v250
v_mul_f32 v251, v207, v251
v_exp_f32 v248, v248
v_exp_f32 v249, v249
v_exp_f32 v250, v250
v_exp_f32 v251, v251
buffer_load_dwordx4 v15, s[40:43], 0 offen offset:1024 sc1 lds
v_add_f32 v248, 1.0, v248
v_add_f32 v249, 1.0, v249
v_add_f32 v250, 1.0, v250
v_add_f32 v251, 1.0, v251
v_rcp_f32 v248, v248
v_rcp_f32 v249, v249
v_rcp_f32 v250, v250
v_rcp_f32 v251, v251
v_mul_f32 v248, v204, v248
v_mul_f32 v249, v205, v249
v_mul_f32 v250, v206, v250
v_mul_f32 v251, v207, v251
s_barrier
s_add_u32 m0, s13, 0
v_add_u32 v15, 13824, v14
buffer_load_dwordx4 v15, s[40:43], 0 offen sc1 lds
v_cvt_pk_bf16_f32 v200, v248, v249
v_cvt_pk_bf16_f32 v201, v250, v251
v_mul_f32 v248, v208, v208
v_mul_f32 v249, v209, v209
v_mul_f32 v250, v210, v210
v_mul_f32 v251, v211, v211
v_fmaak_f32 v248, v248, v11, 0xc0135761
v_fmaak_f32 v249, v249, v11, 0xc0135761
v_fmaak_f32 v250, v250, v11, 0xc0135761
v_fmaak_f32 v251, v251, v11, 0xc0135761
v_mul_f32 v248, v208, v248
v_mul_f32 v249, v209, v249
buffer_load_dwordx4 v15, s[40:43], 0 offen offset:1024 sc1 lds
v_mul_f32 v250, v210, v250
v_mul_f32 v251, v211, v251
v_exp_f32 v248, v248
v_exp_f32 v249, v249
v_exp_f32 v250, v250
v_exp_f32 v251, v251
v_add_f32 v248, 1.0, v248
v_add_f32 v249, 1.0, v249
v_add_f32 v250, 1.0, v250
v_add_f32 v251, 1.0, v251
v_rcp_f32 v248, v248
v_rcp_f32 v249, v249
s_add_u32 m0, s13, 8192
v_add_u32 v15, 22016, v14
buffer_load_dwordx4 v15, s[40:43], 0 offen sc1 lds
v_rcp_f32 v250, v250
v_rcp_f32 v251, v251
v_mul_f32 v248, v208, v248
v_mul_f32 v249, v209, v249
v_mul_f32 v250, v210, v250
v_mul_f32 v251, v211, v251
v_cvt_pk_bf16_f32 v202, v248, v249
v_cvt_pk_bf16_f32 v203, v250, v251
s_lshl_b32 s82, s11, 5
v_add_u32 v255, s82, v12
ds_write_b128 v255, v[196:199] offset:0
ds_write_b128 v255, v[200:203] offset:1024
buffer_load_dwordx4 v15, s[40:43], 0 offen offset:1024 sc1 lds
s_mul_i32 s82, s70, 4608
s_lshl_b32 s83, s69, 10
s_add_u32 s83, s83, s82
v_add_u32 v6, s83, v9
v_add_u32 v5, 65536, v6
s_add_u32 s83, s82, 4096
v_add_u32 v11, s83, v10
v_add_u32 v13, 65536, v11
s_mul_i32 s83, s70, 79360
s_sub_u32 s83, 74752, s83
v_add_u32 v12, s83, v6
s_waitcnt vmcnt(8)
s_barrier
s_add_u32 m0, s13, 16384
v_add_u32 v15, 30208, v14
buffer_load_dwordx4 v15, s[40:43], 0 offen sc1 lds
v_add_u32 v188, s83, v11
v_lshl_add_u32 v252, v3, 2, s69
v_lshlrev_b32 v253, 2, v3
v_sub_u32 v253, v2, v253
v_cvt_f32_i32 v253, v253
v_mov_b32 v254, 0x7149f2ca
v_cmp_eq_u32 s[26:27], 0, v252
s_nop 1
v_cndmask_b32 v184, 0, v184, s[26:27]
v_cmp_eq_u32 s[26:27], 1, v252
s_nop 1
v_cndmask_b32 v185, 0, v185, s[26:27]
buffer_load_dwordx4 v15, s[40:43], 0 offen offset:1024 sc1 lds
v_cmp_eq_u32 s[26:27], 2, v252
s_nop 1
v_cndmask_b32 v186, 0, v186, s[26:27]
v_cmp_eq_u32 s[26:27], 3, v252
s_nop 1
v_cndmask_b32 v187, 0, v187, s[26:27]
v_fmaak_f32 v16, v253, v254, 0x70c9f2ca
v_min_f32 v144, 0, v16
v_min_f32_e64 v16, -v16, 0
v_fmaak_f32 v17, v253, v254, 0xf0c9f2ca
v_min_f32 v145, 0, v17
v_min_f32_e64 v17, -v17, 0
s_add_u32 m0, s13, 24576
v_add_u32 v15, 38400, v14
buffer_load_dwordx4 v15, s[40:43], 0 offen sc1 lds
v_fmaak_f32 v18, v253, v254, 0xf1977617
v_min_f32 v146, 0, v18
v_min_f32_e64 v18, -v18, 0
v_fmaak_f32 v19, v253, v254, 0xf1fc6f7c
v_min_f32 v147, 0, v19
v_min_f32_e64 v19, -v19, 0
v_fmaak_f32 v20, v253, v254, 0xf2bd539d
v_min_f32 v148, 0, v20
v_min_f32_e64 v20, -v20, 0
v_fmaak_f32 v21, v253, v254, 0xf2d691f6
v_min_f32 v149, 0, v21
v_min_f32_e64 v21, -v21, 0
buffer_load_dwordx4 v15, s[40:43], 0 offen offset:1024 sc1 lds
v_fmaak_f32 v22, v253, v254, 0xf2efd050
v_min_f32 v150, 0, v22
v_min_f32_e64 v22, -v22, 0
v_fmaak_f32 v23, v253, v254, 0xf3048754
v_min_f32 v151, 0, v23
v_min_f32_e64 v23, -v23, 0
v_fmaak_f32 v24, v253, v254, 0xf343a333
v_min_f32 v152, 0, v24
v_min_f32_e64 v24, -v24, 0
v_fmaak_f32 v25, v253, v254, 0xf3504260
v_min_f32 v153, 0, v25
v_min_f32_e64 v25, -v25, 0
s_waitcnt vmcnt(8)
s_barrier
s_lshl_b32 s91, s72, 1
s_sub_u32 s91, s91, 8
s_mul_i32 s91, s91, 256
v_add_u32 v14, s91, v14
s_add_u32 m0, s13, 32768
v_add_u32 v15, 0, v14
buffer_load_dwordx4 v15, s[40:43], s93 offen sc1 lds
buffer_load_dwordx4 v15, s[40:43], s93 offen offset:1024 sc1 lds
s_add_u32 m0, s13, 40960
v_add_u32 v15, 8192, v14
buffer_load_dwordx4 v15, s[40:43], s93 offen sc1 lds
v_fmaak_f32 v26, v253, v254, 0xf35ce18d
v_min_f32 v154, 0, v26
v_min_f32_e64 v26, -v26, 0
v_fmaak_f32 v27, v253, v254, 0xf36980b9
v_min_f32 v155, 0, v27
v_min_f32_e64 v27, -v27, 0
v_fmaak_f32 v28, v253, v254, 0xf3944e4c
v_min_f32 v156, 0, v28
v_min_f32_e64 v28, -v28, 0
v_fmaak_f32 v29, v253, v254, 0xf39a9de3
v_min_f32 v157, 0, v29
v_min_f32_e64 v29, -v29, 0
buffer_load_dwordx4 v15, s[40:43], s93 offen offset:1024 sc1 lds
v_fmaak_f32 v30, v253, v254, 0xf3a0ed79
v_min_f32 v158, 0, v30
v_min_f32_e64 v30, -v30, 0
v_fmaak_f32 v31, v253, v254, 0xf3a73d0f
v_min_f32 v159, 0, v31
v_min_f32_e64 v31, -v31, 0
s_waitcnt lgkmcnt(0)
L_f1_done:
s_waitcnt vmcnt(0)
s_barrier
ds_read_b128 v[212:215], v5 offset:0
ds_read_b128 v[228:231], v13 offset:0
ds_read_b128 v[216:219], v5 offset:4608
ds_read_b128 v[232:235], v13 offset:4608
ds_read_b128 v[220:223], v12 offset:0
ds_read_b128 v[236:239], v188 offset:0
s_add_u32 m0, s89, 49152
s_lshl_b32 s91, s87, 13
s_add_u32 s91, s91, 16384
v_add_u32 v15, s91, v14
buffer_load_dwordx4 v15, s[40:43], s93 offen sc1 lds
buffer_load_dwordx4 v15, s[40:43], s93 offen offset:1024 sc1 lds
s_waitcnt lgkmcnt(4)
v_mfma_f32_32x32x16_bf16 v[16:31], v[212:215], v[180:183], v[16:31]
v_mfma_f32_32x32x16_bf16 v[16:31], v[228:231], v[184:187], v[16:31]
ds_read_b128 v[224:227], v6 offset:0
ds_read_b128 v[240:243], v11 offset:0
s_waitcnt lgkmcnt(4)
v_mfma_f32_32x32x16_bf16 v[32:47], v[216:219], v[180:183], 0
v_mfma_f32_32x32x16_bf16 v[32:47], v[232:235], v[184:187], v[32:47]
ds_read_b128 v[212:215], v6 offset:4608
ds_read_b128 v[228:231], v11 offset:4608
s_waitcnt lgkmcnt(4)
v_mfma_f32_32x32x16_bf16 v[48:63], v[220:223], v[180:183], 0
v_mfma_f32_32x32x16_bf16 v[48:63], v[236:239], v[184:187], v[48:63]
ds_read_b128 v[216:219], v6 offset:9216
ds_read_b128 v[232:235], v11 offset:9216
s_waitcnt lgkmcnt(4)
v_mfma_f32_32x32x16_bf16 v[64:79], v[224:227], v[180:183], 0
v_mfma_f32_32x32x16_bf16 v[64:79], v[240:243], v[184:187], v[64:79]
ds_read_b128 v[220:223], v6 offset:13824
ds_read_b128 v[236:239], v11 offset:13824
s_waitcnt lgkmcnt(4)
v_mfma_f32_32x32x16_bf16 v[80:95], v[212:215], v[180:183], 0
v_mfma_f32_32x32x16_bf16 v[80:95], v[228:231], v[184:187], v[80:95]
ds_read_b128 v[224:227], v6 offset:18432
ds_read_b128 v[240:243], v11 offset:18432
s_waitcnt lgkmcnt(4)
v_mfma_f32_32x32x16_bf16 v[96:111], v[216:219], v[180:183], 0
v_mfma_f32_32x32x16_bf16 v[96:111], v[232:235], v[184:187], v[96:111]
ds_read_b128 v[212:215], v6 offset:23040
ds_read_b128 v[228:231], v11 offset:23040
s_waitcnt lgkmcnt(4)
v_mfma_f32_32x32x16_bf16 v[112:127], v[220:223], v[180:183], 0
v_mfma_f32_32x32x16_bf16 v[112:127], v[236:239], v[184:187], v[112:127]
s_waitcnt lgkmcnt(2)
v_mfma_f32_32x32x16_bf16 v[128:143], v[224:227], v[180:183], 0
v_mfma_f32_32x32x16_bf16 v[128:143], v[240:243], v[184:187], v[128:143]
s_waitcnt lgkmcnt(0)
v_mfma_f32_32x32x16_bf16 v[144:159], v[212:215], v[180:183], v[144:159]
v_mfma_f32_32x32x16_bf16 v[144:159], v[228:231], v[184:187], v[144:159]
s_mul_i32 s82, s70, 4864
s_mul_i32 s83, s69, 1216
s_add_u32 s82, s82, s83
s_add_u32 s82, s82, 32768
v_mad_u32_u24 v5, v3, 19, v2
v_lshl_add_u32 v5, v5, 4, s82
v_cmp_gt_u32 s[26:27], 19, v2
s_cmp_ge_u32 s72, 4
s_cbranch_scc1 L_att_valid
s_lshl_b32 s85, s72, 1
s_add_u32 s85, s85, s70
s_nop 7
s_nop 3
s_cmp_ge_u32 s85, 8
s_cbranch_scc1 L_att_valid
v_mov_b32 v16, 0xf149f2ca
v_mov_b32 v17, 0xf149f2ca
v_mov_b32 v18, 0xf149f2ca
v_mov_b32 v19, 0xf149f2ca
v_mov_b32 v20, 0xf149f2ca
v_mov_b32 v21, 0xf149f2ca
v_mov_b32 v22, 0xf149f2ca
v_mov_b32 v23, 0xf149f2ca
v_mov_b32 v24, 0xf149f2ca
v_mov_b32 v25, 0xf149f2ca
v_mov_b32 v26, 0xf149f2ca
v_mov_b32 v27, 0xf149f2ca
v_mov_b32 v28, 0xf149f2ca
v_mov_b32 v29, 0xf149f2ca
v_mov_b32 v30, 0xf149f2ca
v_mov_b32 v31, 0xf149f2ca
s_cmp_ge_u32 s85, 7
s_cbranch_scc1 L_att_valid
v_mov_b32 v32, 0xf149f2ca
v_mov_b32 v33, 0xf149f2ca
v_mov_b32 v34, 0xf149f2ca
v_mov_b32 v35, 0xf149f2ca
v_mov_b32 v36, 0xf149f2ca
v_mov_b32 v37, 0xf149f2ca
v_mov_b32 v38, 0xf149f2ca
v_mov_b32 v39, 0xf149f2ca
v_mov_b32 v40, 0xf149f2ca
v_mov_b32 v41, 0xf149f2ca
v_mov_b32 v42, 0xf149f2ca
v_mov_b32 v43, 0xf149f2ca
v_mov_b32 v44, 0xf149f2ca
v_mov_b32 v45, 0xf149f2ca
v_mov_b32 v46, 0xf149f2ca
v_mov_b32 v47, 0xf149f2ca
s_cmp_ge_u32 s85, 6
s_cbranch_scc1 L_att_valid
v_mov_b32 v48, 0xf149f2ca
v_mov_b32 v49, 0xf149f2ca
v_mov_b32 v50, 0xf149f2ca
v_mov_b32 v51, 0xf149f2ca
v_mov_b32 v52, 0xf149f2ca
v_mov_b32 v53, 0xf149f2ca
v_mov_b32 v54, 0xf149f2ca
v_mov_b32 v55, 0xf149f2ca
v_mov_b32 v56, 0xf149f2ca
v_mov_b32 v57, 0xf149f2ca
v_mov_b32 v58, 0xf149f2ca
v_mov_b32 v59, 0xf149f2ca
v_mov_b32 v60, 0xf149f2ca
v_mov_b32 v61, 0xf149f2ca
v_mov_b32 v62, 0xf149f2ca
v_mov_b32 v63, 0xf149f2ca
s_cmp_ge_u32 s85, 5
s_cbranch_scc1 L_att_valid
v_mov_b32 v64, 0xf149f2ca
v_mov_b32 v65, 0xf149f2ca
v_mov_b32 v66, 0xf149f2ca
v_mov_b32 v67, 0xf149f2ca
v_mov_b32 v68, 0xf149f2ca
v_mov_b32 v69, 0xf149f2ca
v_mov_b32 v70, 0xf149f2ca
v_mov_b32 v71, 0xf149f2ca
v_mov_b32 v72, 0xf149f2ca
v_mov_b32 v73, 0xf149f2ca
v_mov_b32 v74, 0xf149f2ca
v_mov_b32 v75, 0xf149f2ca
v_mov_b32 v76, 0xf149f2ca
v_mov_b32 v77, 0xf149f2ca
v_mov_b32 v78, 0xf149f2ca
v_mov_b32 v79, 0xf149f2ca
s_cmp_ge_u32 s85, 4
s_cbranch_scc1 L_att_valid
v_mov_b32 v80, 0xf149f2ca
v_mov_b32 v81, 0xf149f2ca
v_mov_b32 v82, 0xf149f2ca
v_mov_b32 v83, 0xf149f2ca
v_mov_b32 v84, 0xf149f2ca
v_mov_b32 v85, 0xf149f2ca
v_mov_b32 v86, 0xf149f2ca
v_mov_b32 v87, 0xf149f2ca
v_mov_b32 v88, 0xf149f2ca
v_mov_b32 v89, 0xf149f2ca
v_mov_b32 v90, 0xf149f2ca
v_mov_b32 v91, 0xf149f2ca
v_mov_b32 v92, 0xf149f2ca
v_mov_b32 v93, 0xf149f2ca
v_mov_b32 v94, 0xf149f2ca
v_mov_b32 v95, 0xf149f2ca
s_cmp_ge_u32 s85, 3
s_cbranch_scc1 L_att_valid
v_mov_b32 v96, 0xf149f2ca
v_mov_b32 v97, 0xf149f2ca
v_mov_b32 v98, 0xf149f2ca
v_mov_b32 v99, 0xf149f2ca
v_mov_b32 v100, 0xf149f2ca
v_mov_b32 v101, 0xf149f2ca
v_mov_b32 v102, 0xf149f2ca
v_mov_b32 v103, 0xf149f2ca
v_mov_b32 v104, 0xf149f2ca
v_mov_b32 v105, 0xf149f2ca
v_mov_b32 v106, 0xf149f2ca
v_mov_b32 v107, 0xf149f2ca
v_mov_b32 v108, 0xf149f2ca
v_mov_b32 v109, 0xf149f2ca
v_mov_b32 v110, 0xf149f2ca
v_mov_b32 v111, 0xf149f2ca
s_cmp_ge_u32 s85, 2
s_cbranch_scc1 L_att_valid
v_mov_b32 v112, 0xf149f2ca
v_mov_b32 v113, 0xf149f2ca
v_mov_b32 v114, 0xf149f2ca
v_mov_b32 v115, 0xf149f2ca
v_mov_b32 v116, 0xf149f2ca
v_mov_b32 v117, 0xf149f2ca
v_mov_b32 v118, 0xf149f2ca
v_mov_b32 v119, 0xf149f2ca
v_mov_b32 v120, 0xf149f2ca
v_mov_b32 v121, 0xf149f2ca
v_mov_b32 v122, 0xf149f2ca
v_mov_b32 v123, 0xf149f2ca
v_mov_b32 v124, 0xf149f2ca
v_mov_b32 v125, 0xf149f2ca
v_mov_b32 v126, 0xf149f2ca
v_mov_b32 v127, 0xf149f2ca
s_cmp_ge_u32 s85, 1
s_cbranch_scc1 L_att_valid
v_mov_b32 v128, 0xf149f2ca
v_mov_b32 v129, 0xf149f2ca
v_mov_b32 v130, 0xf149f2ca
v_mov_b32 v131, 0xf149f2ca
v_mov_b32 v132, 0xf149f2ca
v_mov_b32 v133, 0xf149f2ca
v_mov_b32 v134, 0xf149f2ca
v_mov_b32 v135, 0xf149f2ca
v_mov_b32 v136, 0xf149f2ca
v_mov_b32 v137, 0xf149f2ca
v_mov_b32 v138, 0xf149f2ca
v_mov_b32 v139, 0xf149f2ca
v_mov_b32 v140, 0xf149f2ca
v_mov_b32 v141, 0xf149f2ca
v_mov_b32 v142, 0xf149f2ca
v_mov_b32 v143, 0xf149f2ca
L_att_valid:
s_mov_b64 exec, s[26:27]
ds_read_b128 v[160:163], v5 offset:0
ds_read_b128 v[164:167], v5 offset:608
ds_read_b128 v[168:171], v5 offset:4864
ds_read_b128 v[172:175], v5 offset:5472
s_mov_b64 exec, -1
v_max3_f32 v249, v16, v17, v18
v_max3_f32 v250, v19, v20, v21
v_max3_f32 v249, v249, v22, v23
v_max3_f32 v250, v250, v24, v25
v_max3_f32 v249, v249, v26, v27
v_max3_f32 v250, v250, v28, v29
v_max3_f32 v249, v249, v30, v31
v_max3_f32 v250, v250, v32, v33
v_max3_f32 v249, v249, v34, v35
v_max3_f32 v250, v250, v36, v37
v_max3_f32 v249, v249, v38, v39
v_max3_f32 v250, v250, v40, v41
v_max3_f32 v249, v249, v42, v43
v_max3_f32 v250, v250, v44, v45
v_max3_f32 v249, v249, v46, v47
v_max3_f32 v250, v250, v48, v49
v_max3_f32 v249, v249, v50, v51
v_max3_f32 v250, v250, v52, v53
v_max3_f32 v249, v249, v54, v55
v_max3_f32 v250, v250, v56, v57
v_max3_f32 v249, v249, v58, v59
v_max3_f32 v250, v250, v60, v61
v_max3_f32 v249, v249, v62, v63
v_max3_f32 v250, v250, v64, v65
s_waitcnt vmcnt(0)
s_barrier
s_mov_b64 exec, s[26:27]
ds_read_b128 v[176:179], v5 offset:9728
ds_read_b128 v[192:195], v5 offset:10336
ds_read_b128 v[196:199], v5 offset:14592
ds_read_b128 v[200:203], v5 offset:15200
ds_read_b128 v[204:207], v5 offset:19456
ds_read_b128 v[208:211], v5 offset:20064
s_mov_b64 exec, -1
s_add_u32 m0, s89, 65536
s_lshl_b32 s91, s87, 13
s_add_u32 s91, s91, 32768
v_add_u32 v15, s91, v14
buffer_load_dwordx4 v15, s[40:43], s93 offen sc1 lds
buffer_load_dwordx4 v15, s[40:43], s93 offen offset:1024 sc1 lds
v_bfe_u32 v252, v1, 2, 2
v_lshl_add_u32 v252, v3, 2, v252
v_mul_u32_u24 v252, 1152, v252
v_bfe_u32 v253, v1, 4, 1
v_lshl_add_u32 v252, v253, 6, v252
v_and_b32 v253, 3, v1
v_lshl_add_u32 v7, v253, 4, v252
v_add_u32 v8, 8192, v7
s_add_u32 m0, s89, 0
s_add_u32 s91, s4, s77
s_add_u32 s91, s91, 0
buffer_load_dwordx4 v7, s[52:55], s91 offen lds
buffer_load_dwordx4 v8, s[52:55], s91 offen offset:1024 lds
v_max3_f32 v249, v249, v66, v67
v_max3_f32 v250, v250, v68, v69
v_max3_f32 v249, v249, v70, v71
v_max3_f32 v250, v250, v72, v73
v_max3_f32 v249, v249, v74, v75
v_max3_f32 v250, v250, v76, v77
v_max3_f32 v249, v249, v78, v79
v_max3_f32 v250, v250, v80, v81
v_max3_f32 v249, v249, v82, v83
v_max3_f32 v250, v250, v84, v85
v_max3_f32 v249, v249, v86, v87
v_max3_f32 v250, v250, v88, v89
v_max3_f32 v249, v249, v90, v91
v_max3_f32 v250, v250, v92, v93
v_max3_f32 v249, v249, v94, v95
v_max3_f32 v250, v250, v96, v97
v_max3_f32 v249, v249, v98, v99
v_max3_f32 v250, v250, v100, v101
v_max3_f32 v249, v249, v102, v103
v_max3_f32 v250, v250, v104, v105
v_max3_f32 v249, v249, v106, v107
v_max3_f32 v250, v250, v108, v109
v_max3_f32 v249, v249, v110, v111
v_max3_f32 v250, v250, v112, v113
s_add_u32 m0, s89, 16384
s_add_u32 s91, s4, s77
s_add_u32 s91, s91, 147456
buffer_load_dwordx4 v7, s[52:55], s91 offen lds
buffer_load_dwordx4 v8, s[52:55], s91 offen offset:1024 lds
v_max3_f32 v249, v249, v114, v115
v_max3_f32 v250, v250, v116, v117
v_max3_f32 v249, v249, v118, v119
v_max3_f32 v250, v250, v120, v121
v_max3_f32 v249, v249, v122, v123
v_max3_f32 v250, v250, v124, v125
v_max3_f32 v249, v249, v126, v127
v_max3_f32 v250, v250, v128, v129
v_max3_f32 v249, v249, v130, v131
v_max3_f32 v250, v250, v132, v133
v_max3_f32 v249, v249, v134, v135
v_max3_f32 v250, v250, v136, v137
v_max3_f32 v249, v249, v138, v139
v_max3_f32 v250, v250, v140, v141
v_max3_f32 v249, v249, v142, v143
v_max3_f32 v250, v250, v144, v145
v_max3_f32 v249, v249, v146, v147
v_max3_f32 v250, v250, v148, v149
v_max3_f32 v249, v249, v150, v151
v_max3_f32 v250, v250, v152, v153
v_max3_f32 v249, v249, v154, v155
v_max3_f32 v250, v250, v156, v157
v_max3_f32 v249, v249, v158, v159
v_max_f32 v249, v249, v250
v_mov_b32 v250, v249
s_mov_b32 s80, 0x42200000
s_nop 0
v_permlane32_swap_b32 v249, v250
v_max_f32 v249, v249, v250
v_cmp_lt_f32 s[26:27], |v249|, s80
s_nop 1
s_cmp_eq_u64 s[26:27], -1
s_cbranch_scc1 L_att_fast
v_sub_f32 v16, v16, v249
v_sub_f32 v17, v17, v249
v_sub_f32 v18, v18, v249
v_sub_f32 v19, v19, v249
v_sub_f32 v20, v20, v249
v_sub_f32 v21, v21, v249
v_sub_f32 v22, v22, v249
v_sub_f32 v23, v23, v249
v_sub_f32 v24, v24, v249
v_sub_f32 v25, v25, v249
v_sub_f32 v26, v26, v249
v_sub_f32 v27, v27, v249
v_sub_f32 v28, v28, v249
v_sub_f32 v29, v29, v249
v_sub_f32 v30, v30, v249
v_sub_f32 v31, v31, v249
v_sub_f32 v32, v32, v249
v_sub_f32 v33, v33, v249
v_sub_f32 v34, v34, v249
v_sub_f32 v35, v35, v249
v_sub_f32 v36, v36, v249
v_sub_f32 v37, v37, v249
v_sub_f32 v38, v38, v249
v_sub_f32 v39, v39, v249
v_sub_f32 v40, v40, v249
v_sub_f32 v41, v41, v249
v_sub_f32 v42, v42, v249
v_sub_f32 v43, v43, v249
v_sub_f32 v44, v44, v249
v_sub_f32 v45, v45, v249
v_sub_f32 v46, v46, v249
v_sub_f32 v47, v47, v249
v_sub_f32 v48, v48, v249
v_sub_f32 v49, v49, v249
v_sub_f32 v50, v50, v249
v_sub_f32 v51, v51, v249
v_sub_f32 v52, v52, v249
v_sub_f32 v53, v53, v249
v_sub_f32 v54, v54, v249
v_sub_f32 v55, v55, v249
v_sub_f32 v56, v56, v249
v_sub_f32 v57, v57, v249
v_sub_f32 v58, v58, v249
v_sub_f32 v59, v59, v249
v_sub_f32 v60, v60, v249
v_sub_f32 v61, v61, v249
v_sub_f32 v62, v62, v249
v_sub_f32 v63, v63, v249
v_sub_f32 v64, v64, v249
v_sub_f32 v65, v65, v249
v_sub_f32 v66, v66, v249
v_sub_f32 v67, v67, v249
v_sub_f32 v68, v68, v249
v_sub_f32 v69, v69, v249
v_sub_f32 v70, v70, v249
v_sub_f32 v71, v71, v249
v_sub_f32 v72, v72, v249
v_sub_f32 v73, v73, v249
v_sub_f32 v74, v74, v249
v_sub_f32 v75, v75, v249
v_sub_f32 v76, v76, v249
v_sub_f32 v77, v77, v249
v_sub_f32 v78, v78, v249
v_sub_f32 v79, v79, v249
v_sub_f32 v80, v80, v249
v_sub_f32 v81, v81, v249
v_sub_f32 v82, v82, v249
v_sub_f32 v83, v83, v249
v_sub_f32 v84, v84, v249
v_sub_f32 v85, v85, v249
v_sub_f32 v86, v86, v249
v_sub_f32 v87, v87, v249
v_sub_f32 v88, v88, v249
v_sub_f32 v89, v89, v249
v_sub_f32 v90, v90, v249
v_sub_f32 v91, v91, v249
v_sub_f32 v92, v92, v249
v_sub_f32 v93, v93, v249
v_sub_f32 v94, v94, v249
v_sub_f32 v95, v95, v249
v_sub_f32 v96, v96, v249
v_sub_f32 v97, v97, v249
v_sub_f32 v98, v98, v249
v_sub_f32 v99, v99, v249
v_sub_f32 v100, v100, v249
v_sub_f32 v101, v101, v249
v_sub_f32 v102, v102, v249
v_sub_f32 v103, v103, v249
v_sub_f32 v104, v104, v249
v_sub_f32 v105, v105, v249
v_sub_f32 v106, v106, v249
v_sub_f32 v107, v107, v249
v_sub_f32 v108, v108, v249
v_sub_f32 v109, v109, v249
v_sub_f32 v110, v110, v249
v_sub_f32 v111, v111, v249
v_sub_f32 v112, v112, v249
v_sub_f32 v113, v113, v249
v_sub_f32 v114, v114, v249
v_sub_f32 v115, v115, v249
v_sub_f32 v116, v116, v249
v_sub_f32 v117, v117, v249
v_sub_f32 v118, v118, v249
v_sub_f32 v119, v119, v249
v_sub_f32 v120, v120, v249
v_sub_f32 v121, v121, v249
v_sub_f32 v122, v122, v249
v_sub_f32 v123, v123, v249
v_sub_f32 v124, v124, v249
v_sub_f32 v125, v125, v249
v_sub_f32 v126, v126, v249
v_sub_f32 v127, v127, v249
v_sub_f32 v128, v128, v249
v_sub_f32 v129, v129, v249
v_sub_f32 v130, v130, v249
v_sub_f32 v131, v131, v249
v_sub_f32 v132, v132, v249
v_sub_f32 v133, v133, v249
v_sub_f32 v134, v134, v249
v_sub_f32 v135, v135, v249
v_sub_f32 v136, v136, v249
v_sub_f32 v137, v137, v249
v_sub_f32 v138, v138, v249
v_sub_f32 v139, v139, v249
v_sub_f32 v140, v140, v249
v_sub_f32 v141, v141, v249
v_sub_f32 v142, v142, v249
v_sub_f32 v143, v143, v249
v_sub_f32 v144, v144, v249
v_sub_f32 v145, v145, v249
v_sub_f32 v146, v146, v249
v_sub_f32 v147, v147, v249
v_sub_f32 v148, v148, v249
v_sub_f32 v149, v149, v249
v_sub_f32 v150, v150, v249
v_sub_f32 v151, v151, v249
v_sub_f32 v152, v152, v249
v_sub_f32 v153, v153, v249
v_sub_f32 v154, v154, v249
v_sub_f32 v155, v155, v249
v_sub_f32 v156, v156, v249
v_sub_f32 v157, v157, v249
v_sub_f32 v158, v158, v249
v_sub_f32 v159, v159, v249
L_att_fast:
v_exp_f32 v16, v16
v_exp_f32 v17, v17
v_exp_f32 v18, v18
v_exp_f32 v19, v19
v_exp_f32 v20, v20
v_exp_f32 v21, v21
v_exp_f32 v22, v22
v_exp_f32 v23, v23
v_exp_f32 v24, v24
v_exp_f32 v25, v25
v_exp_f32 v26, v26
v_exp_f32 v27, v27
v_exp_f32 v28, v28
v_exp_f32 v29, v29
v_exp_f32 v30, v30
v_exp_f32 v31, v31
v_cvt_pk_bf16_f32 v16, v16, v17
v_cvt_pk_bf16_f32 v17, v18, v19
v_cvt_pk_bf16_f32 v18, v20, v21
v_cvt_pk_bf16_f32 v19, v22, v23
v_cvt_pk_bf16_f32 v20, v24, v25
v_cvt_pk_bf16_f32 v21, v26, v27
v_cvt_pk_bf16_f32 v22, v28, v29
v_cvt_pk_bf16_f32 v23, v30, v31
v_exp_f32 v32, v32
v_exp_f32 v33, v33
v_exp_f32 v34, v34
v_exp_f32 v35, v35
v_exp_f32 v36, v36
v_exp_f32 v37, v37
v_exp_f32 v38, v38
v_exp_f32 v39, v39
v_exp_f32 v40, v40
v_exp_f32 v41, v41
v_exp_f32 v42, v42
v_exp_f32 v43, v43
v_exp_f32 v44, v44
v_exp_f32 v45, v45
v_exp_f32 v46, v46
v_exp_f32 v47, v47
v_cvt_pk_bf16_f32 v24, v32, v33
v_cvt_pk_bf16_f32 v25, v34, v35
v_cvt_pk_bf16_f32 v26, v36, v37
v_cvt_pk_bf16_f32 v27, v38, v39
v_cvt_pk_bf16_f32 v28, v40, v41
v_cvt_pk_bf16_f32 v29, v42, v43
v_cvt_pk_bf16_f32 v30, v44, v45
v_cvt_pk_bf16_f32 v31, v46, v47
s_waitcnt vmcnt(4) lgkmcnt(0)
s_barrier
v_cmp_gt_u32 s[26:27], 19, v2
s_nop 1
s_mov_b64 exec, s[26:27]
ds_read_b128 v[244:247], v5 offset:24320
ds_read_b128 v[212:215], v5 offset:24928
ds_read_b128 v[216:219], v5 offset:29184
ds_read_b128 v[220:223], v5 offset:29792
ds_read_b128 v[224:227], v5 offset:34048
ds_read_b128 v[228:231], v5 offset:34656
ds_read_b128 v[232:235], v5 offset:38912
ds_read_b128 v[236:239], v5 offset:39520
s_mov_b64 exec, -1
s_add_u32 m0, s89, 32768
s_add_u32 s91, s4, s77
s_add_u32 s91, s91, 294912
buffer_load_dwordx4 v7, s[52:55], s91 offen lds
buffer_load_dwordx4 v8, s[52:55], s91 offen offset:1024 lds
v_exp_f32 v48, v48
v_exp_f32 v49, v49
v_exp_f32 v50, v50
v_mfma_f32_32x32x16_bf16 v[32:47], v[160:163], v[16:19], 0
v_exp_f32 v51, v51
v_exp_f32 v52, v52
v_exp_f32 v53, v53
v_exp_f32 v54, v54
v_mfma_f32_32x32x16_bf16 v[32:47], v[164:167], v[20:23], v[32:47]
v_exp_f32 v55, v55
v_exp_f32 v56, v56
v_exp_f32 v57, v57
v_exp_f32 v58, v58
v_mfma_f32_32x32x16_bf16 v[32:47], v[168:171], v[24:27], v[32:47]
v_exp_f32 v59, v59
v_exp_f32 v60, v60
v_exp_f32 v61, v61
v_exp_f32 v62, v62
v_mfma_f32_32x32x16_bf16 v[32:47], v[172:175], v[28:31], v[32:47]
v_exp_f32 v63, v63
v_cvt_pk_bf16_f32 v48, v48, v49
v_cvt_pk_bf16_f32 v49, v50, v51
v_cvt_pk_bf16_f32 v50, v52, v53
v_cvt_pk_bf16_f32 v51, v54, v55
v_cvt_pk_bf16_f32 v52, v56, v57
v_cvt_pk_bf16_f32 v53, v58, v59
v_cvt_pk_bf16_f32 v54, v60, v61
v_cvt_pk_bf16_f32 v55, v62, v63
v_exp_f32 v64, v64
v_exp_f32 v65, v65
v_exp_f32 v66, v66
v_mfma_f32_32x32x16_bf16 v[32:47], v[176:179], v[48:51], v[32:47]
v_exp_f32 v67, v67
v_exp_f32 v68, v68
v_exp_f32 v69, v69
v_exp_f32 v70, v70
v_mfma_f32_32x32x16_bf16 v[32:47], v[192:195], v[52:55], v[32:47]
v_exp_f32 v71, v71
v_exp_f32 v72, v72
v_exp_f32 v73, v73
v_exp_f32 v74, v74
v_exp_f32 v75, v75
v_exp_f32 v76, v76
v_exp_f32 v77, v77
v_exp_f32 v78, v78
v_exp_f32 v79, v79
v_cvt_pk_bf16_f32 v64, v64, v65
v_cvt_pk_bf16_f32 v65, v66, v67
v_cvt_pk_bf16_f32 v66, v68, v69
v_cvt_pk_bf16_f32 v67, v70, v71
v_cvt_pk_bf16_f32 v68, v72, v73
v_cvt_pk_bf16_f32 v69, v74, v75
v_cvt_pk_bf16_f32 v70, v76, v77
v_cvt_pk_bf16_f32 v71, v78, v79
v_exp_f32 v80, v80
v_exp_f32 v81, v81
v_exp_f32 v82, v82
v_mfma_f32_32x32x16_bf16 v[32:47], v[196:199], v[64:67], v[32:47]
v_exp_f32 v83, v83
v_exp_f32 v84, v84
v_exp_f32 v85, v85
v_exp_f32 v86, v86
v_mfma_f32_32x32x16_bf16 v[32:47], v[200:203], v[68:71], v[32:47]
v_exp_f32 v87, v87
v_exp_f32 v88, v88
v_exp_f32 v89, v89
v_exp_f32 v90, v90
v_exp_f32 v91, v91
v_exp_f32 v92, v92
v_exp_f32 v93, v93
v_exp_f32 v94, v94
v_exp_f32 v95, v95
v_cvt_pk_bf16_f32 v80, v80, v81
v_cvt_pk_bf16_f32 v81, v82, v83
v_cvt_pk_bf16_f32 v82, v84, v85
v_cvt_pk_bf16_f32 v83, v86, v87
v_cvt_pk_bf16_f32 v84, v88, v89
v_cvt_pk_bf16_f32 v85, v90, v91
v_cvt_pk_bf16_f32 v86, v92, v93
v_cvt_pk_bf16_f32 v87, v94, v95
s_waitcnt lgkmcnt(0)
s_barrier
s_add_u32 m0, s89, 49152
s_add_u32 s91, s4, s77
s_add_u32 s91, s91, 442368
buffer_load_dwordx4 v7, s[52:55], s91 offen lds
buffer_load_dwordx4 v8, s[52:55], s91 offen offset:1024 lds
s_add_u32 m0, s89, 65536
s_add_u32 s91, s4, s79
buffer_load_dwordx4 v7, s[60:63], s91 offen lds
buffer_load_dwordx4 v8, s[60:63], s91 offen offset:1024 lds
v_exp_f32 v96, v96
v_exp_f32 v97, v97
v_exp_f32 v98, v98
v_mfma_f32_32x32x16_bf16 v[32:47], v[204:207], v[80:83], v[32:47]
v_exp_f32 v99, v99
v_exp_f32 v100, v100
v_exp_f32 v101, v101
v_exp_f32 v102, v102
v_mfma_f32_32x32x16_bf16 v[32:47], v[208:211], v[84:87], v[32:47]
v_exp_f32 v103, v103
v_exp_f32 v104, v104
v_exp_f32 v105, v105
v_exp_f32 v106, v106
v_exp_f32 v107, v107
v_exp_f32 v108, v108
v_exp_f32 v109, v109
v_exp_f32 v110, v110
v_exp_f32 v111, v111
v_cvt_pk_bf16_f32 v96, v96, v97
v_cvt_pk_bf16_f32 v97, v98, v99
v_cvt_pk_bf16_f32 v98, v100, v101
v_cvt_pk_bf16_f32 v99, v102, v103
v_cvt_pk_bf16_f32 v100, v104, v105
v_cvt_pk_bf16_f32 v101, v106, v107
v_cvt_pk_bf16_f32 v102, v108, v109
v_cvt_pk_bf16_f32 v103, v110, v111
v_exp_f32 v112, v112
v_exp_f32 v113, v113
v_exp_f32 v114, v114
v_mfma_f32_32x32x16_bf16 v[32:47], v[244:247], v[96:99], v[32:47]
v_exp_f32 v115, v115
v_exp_f32 v116, v116
v_exp_f32 v117, v117
v_exp_f32 v118, v118
v_mfma_f32_32x32x16_bf16 v[32:47], v[212:215], v[100:103], v[32:47]
v_exp_f32 v119, v119
v_exp_f32 v120, v120
v_exp_f32 v121, v121
v_exp_f32 v122, v122
v_exp_f32 v123, v123
v_exp_f32 v124, v124
v_exp_f32 v125, v125
v_exp_f32 v126, v126
v_exp_f32 v127, v127
v_cvt_pk_bf16_f32 v112, v112, v113
v_cvt_pk_bf16_f32 v113, v114, v115
v_cvt_pk_bf16_f32 v114, v116, v117
v_cvt_pk_bf16_f32 v115, v118, v119
v_cvt_pk_bf16_f32 v116, v120, v121
v_cvt_pk_bf16_f32 v117, v122, v123
v_cvt_pk_bf16_f32 v118, v124, v125
v_cvt_pk_bf16_f32 v119, v126, v127
v_exp_f32 v128, v128
v_exp_f32 v129, v129
v_exp_f32 v130, v130
v_mfma_f32_32x32x16_bf16 v[32:47], v[216:219], v[112:115], v[32:47]
v_exp_f32 v131, v131
v_exp_f32 v132, v132
v_exp_f32 v133, v133
v_exp_f32 v134, v134
v_mfma_f32_32x32x16_bf16 v[32:47], v[220:223], v[116:119], v[32:47]
v_exp_f32 v135, v135
v_exp_f32 v136, v136
v_exp_f32 v137, v137
v_exp_f32 v138, v138
v_exp_f32 v139, v139
v_exp_f32 v140, v140
v_exp_f32 v141, v141
v_exp_f32 v142, v142
v_exp_f32 v143, v143
v_cvt_pk_bf16_f32 v128, v128, v129
v_cvt_pk_bf16_f32 v129, v130, v131
v_cvt_pk_bf16_f32 v130, v132, v133
v_cvt_pk_bf16_f32 v131, v134, v135
v_cvt_pk_bf16_f32 v132, v136, v137
v_cvt_pk_bf16_f32 v133, v138, v139
v_cvt_pk_bf16_f32 v134, v140, v141
v_cvt_pk_bf16_f32 v135, v142, v143
v_exp_f32 v144, v144
v_exp_f32 v145, v145
v_exp_f32 v146, v146
v_mfma_f32_32x32x16_bf16 v[32:47], v[224:227], v[128:131], v[32:47]
v_exp_f32 v147, v147
v_exp_f32 v148, v148
v_exp_f32 v149, v149
v_exp_f32 v150, v150
v_mfma_f32_32x32x16_bf16 v[32:47], v[228:231], v[132:135], v[32:47]
v_exp_f32 v151, v151
v_exp_f32 v152, v152
v_exp_f32 v153, v153
v_exp_f32 v154, v154
v_exp_f32 v155, v155
v_exp_f32 v156, v156
v_exp_f32 v157, v157
v_exp_f32 v158, v158
v_exp_f32 v159, v159
v_cvt_pk_bf16_f32 v144, v144, v145
v_cvt_pk_bf16_f32 v145, v146, v147
v_cvt_pk_bf16_f32 v146, v148, v149
v_cvt_pk_bf16_f32 v147, v150, v151
v_cvt_pk_bf16_f32 v148, v152, v153
v_cvt_pk_bf16_f32 v149, v154, v155
v_cvt_pk_bf16_f32 v150, v156, v157
v_cvt_pk_bf16_f32 v151, v158, v159
s_nop 1
v_mfma_f32_32x32x16_bf16 v[32:47], v[232:235], v[144:147], v[32:47]
v_mfma_f32_32x32x16_bf16 v[32:47], v[236:239], v[148:151], v[32:47]
v_bfe_u32 v13, v1, 2, 3
v_lshrrev_b32 v11, 1, v13
v_mul_u32_u24 v11, 18, v11
v_and_b32 v13, 1, v13
v_add3_u32 v11, v11, v13, 16
v_mul_u32_u24 v11, 1152, v11
v_lshl_add_u32 v11, v3, 6, v11
v_and_b32 v13, 3, v1
v_lshl_add_u32 v11, v13, 4, v11
v_lshl_add_u32 v5, v3, 9, v4
s_lshr_b32 s82, s69, 1
s_lshl_b32 s83, s82, 8
v_add_u32 v5, s83, v5
v_add_u32 v6, 0x10000, v5
s_lshl_b32 s83, s82, 9
s_add_u32 s83, s83, 131072
v_add_u32 v13, s83, v4
v_add_u32 v12, s90, v9
s_lshl_b32 s83, s70, 12
s_add_u32 s83, s83, 155648
v_add_u32 v14, s83, v9
s_lshl_b32 s83, s69, 10
v_add_u32 v15, s83, v14
v_mov_b32 v250, v42
v_mov_b32 v251, v42
v_cmp_eq_u32 s[26:27], 0, v3
s_nop 0
v_permlane32_swap_b32 v250, v251
v_rcp_f32 v249, v250
s_nop 0
v_mul_f32 v32, v32, v249
v_mul_f32 v33, v33, v249
v_mul_f32 v34, v34, v249
v_mul_f32 v35, v35, v249
v_mul_f32 v36, v36, v249
v_mul_f32 v37, v37, v249
v_mul_f32 v38, v38, v249
v_mul_f32 v39, v39, v249
v_mul_f32 v40, v40, v249
v_mul_f32 v41, v41, v249
v_cvt_pk_bf16_f32 v248, v32, v33
v_cvt_pk_bf16_f32 v249, v34, v35
v_cvt_pk_bf16_f32 v250, v36, v37
v_cvt_pk_bf16_f32 v251, v38, v39
v_cvt_pk_bf16_f32 v201, v40, v41
ds_write_b128 v15, v[248:251]
v_cndmask_b32 v201, 0, v201, s[26:27]
s_waitcnt lgkmcnt(0)
s_waitcnt vmcnt(8)
s_barrier
v_mov_b32 v196, s96
s_mul_i32 s92, s72, 2304
s_add_u32 s92, s92, 8388608
s_lshr_b32 s82, s71, 1
s_lshl_b32 s82, s82, 6
s_add_u32 s20, s92, s82
s_lshr_b32 s82, s69, 1
s_lshl_b32 s82, s82, 1
s_add_u32 s82, s82, s70
s_lshl_b32 s82, s82, 6
s_lshl_b32 s83, s71, 3
s_add_u32 s82, s82, s83
v_mov_b32 v198, s82
v_and_b32 v199, 7, v1
v_lshlrev_b32 v199, 3, v199
s_cmp_lg_u32 s87, 0
s_cbranch_scc1 L_f2_B
ds_read_b64_tr_b16 v[212:213], v5 offset:0
ds_read_b64_tr_b16 v[214:215], v5 offset:1024
ds_read_b64_tr_b16 v[216:217], v5 offset:2048
ds_read_b64_tr_b16 v[218:219], v5 offset:3072
ds_read_b64_tr_b16 v[220:221], v5 offset:4096
ds_read_b64_tr_b16 v[222:223], v5 offset:5120
ds_read_b128 v[16:19], v12 offset:0
ds_read_b128 v[20:23], v12 offset:1024
ds_read_b128 v[24:27], v12 offset:2048
ds_read_b128 v[28:31], v12 offset:3072
s_waitcnt vmcnt(6) lgkmcnt(8)
s_barrier
s_waitcnt lgkmcnt(3)
v_mfma_f32_32x32x16_bf16 v[228:243], v[212:215], v[16:19], 0
ds_read_b128 v[32:35], v12 offset:4096
ds_read_b128 v[36:39], v12 offset:5120
ds_read_b64_tr_b16 v[224:225], v5 offset:6144
ds_read_b64_tr_b16 v[226:227], v5 offset:7168
s_waitcnt lgkmcnt(6)
v_mfma_f32_32x32x16_bf16 v[228:243], v[216:219], v[20:23], v[228:243]
ds_read_b128 v[40:43], v12 offset:6144
ds_read_b128 v[44:47], v12 offset:7168
s_lshl_b32 s82, s4, 3
v_add_u32 v254, s82, v13
ds_read_b64_tr_b16 v[212:213], v5 offset:8192
ds_read_b64_tr_b16 v[214:215], v5 offset:9216
s_waitcnt lgkmcnt(9)
v_mfma_f32_32x32x16_bf16 v[228:243], v[220:223], v[24:27], v[228:243]
ds_read_b128 v[48:51], v12 offset:8192
ds_read_b128 v[52:55], v12 offset:9216
ds_read_b64_tr_b16 v[216:217], v5 offset:10240
ds_read_b64_tr_b16 v[218:219], v5 offset:11264
s_waitcnt lgkmcnt(12)
s_waitcnt lgkmcnt(8)
v_mfma_f32_32x32x16_bf16 v[228:243], v[224:227], v[28:31], v[228:243]
ds_read_b128 v[56:59], v12 offset:10240
ds_read_b128 v[60:63], v12 offset:11264
ds_read_b64_tr_b16 v[220:221], v5 offset:12288
ds_read_b64_tr_b16 v[222:223], v5 offset:13312
s_waitcnt lgkmcnt(8)
v_mfma_f32_32x32x16_bf16 v[228:243], v[212:215], v[32:35], v[228:243]
ds_read_b128 v[64:67], v12 offset:12288
ds_read_b128 v[68:71], v12 offset:13312
ds_read_b64_tr_b16 v[224:225], v5 offset:14336
ds_read_b64_tr_b16 v[226:227], v5 offset:15360
s_waitcnt lgkmcnt(8)
v_mfma_f32_32x32x16_bf16 v[228:243], v[216:219], v[36:39], v[228:243]
ds_read_b128 v[72:75], v12 offset:14336
ds_read_b128 v[76:79], v12 offset:15360
ds_read_b64_tr_b16 v[212:213], v5 offset:16384
ds_read_b64_tr_b16 v[214:215], v5 offset:17408
s_waitcnt lgkmcnt(8)
v_mfma_f32_32x32x16_bf16 v[228:243], v[220:223], v[40:43], v[228:243]
ds_read_b128 v[80:83], v12 offset:16384
ds_read_b128 v[84:87], v12 offset:17408
ds_read_b64_tr_b16 v[216:217], v5 offset:18432
ds_read_b64_tr_b16 v[218:219], v5 offset:19456
s_waitcnt lgkmcnt(8)
v_mfma_f32_32x32x16_bf16 v[228:243], v[224:227], v[44:47], v[228:243]
ds_read_b128 v[88:91], v12 offset:18432
ds_read_b128 v[92:95], v12 offset:19456
ds_read_b64_tr_b16 v[220:221], v5 offset:20480
ds_read_b64_tr_b16 v[222:223], v5 offset:21504
s_waitcnt vmcnt(4) lgkmcnt(8)
s_barrier
v_mfma_f32_32x32x16_bf16 v[228:243], v[212:215], v[48:51], v[228:243]
ds_read_b128 v[96:99], v12 offset:20480
ds_read_b128 v[100:103], v12 offset:21504
ds_read_b64_tr_b16 v[224:225], v5 offset:22528
ds_read_b64_tr_b16 v[226:227], v5 offset:23552
s_waitcnt lgkmcnt(8)
v_mfma_f32_32x32x16_bf16 v[228:243], v[216:219], v[52:55], v[228:243]
ds_read_b128 v[104:107], v12 offset:22528
ds_read_b128 v[108:111], v12 offset:23552
ds_read_b64_tr_b16 v[212:213], v5 offset:24576
ds_read_b64_tr_b16 v[214:215], v5 offset:25600
s_waitcnt lgkmcnt(8)
v_mfma_f32_32x32x16_bf16 v[228:243], v[220:223], v[56:59], v[228:243]
ds_read_b128 v[112:115], v12 offset:24576
ds_read_b128 v[116:119], v12 offset:25600
ds_read_b64_tr_b16 v[216:217], v5 offset:26624
ds_read_b64_tr_b16 v[218:219], v5 offset:27648
s_waitcnt lgkmcnt(8)
v_mfma_f32_32x32x16_bf16 v[228:243], v[224:227], v[60:63], v[228:243]
ds_read_b128 v[120:123], v12 offset:26624
ds_read_b128 v[124:127], v12 offset:27648
ds_read_b64_tr_b16 v[220:221], v5 offset:28672
ds_read_b64_tr_b16 v[222:223], v5 offset:29696
s_waitcnt lgkmcnt(8)
v_mfma_f32_32x32x16_bf16 v[228:243], v[212:215], v[64:67], v[228:243]
ds_read_b128 v[128:131], v12 offset:28672
ds_read_b128 v[132:135], v12 offset:29696
ds_read_b64_tr_b16 v[224:225], v5 offset:30720
ds_read_b64_tr_b16 v[226:227], v5 offset:31744
s_waitcnt lgkmcnt(8)
v_mfma_f32_32x32x16_bf16 v[228:243], v[216:219], v[68:71], v[228:243]
ds_read_b128 v[136:139], v12 offset:30720
ds_read_b128 v[140:143], v12 offset:31744
ds_read_b64_tr_b16 v[212:213], v5 offset:32768
ds_read_b64_tr_b16 v[214:215], v5 offset:33792
s_waitcnt lgkmcnt(8)
v_mfma_f32_32x32x16_bf16 v[228:243], v[220:223], v[72:75], v[228:243]
ds_read_b128 v[144:147], v12 offset:32768
ds_read_b128 v[148:151], v12 offset:33792
ds_read_b64_tr_b16 v[216:217], v5 offset:34816
ds_read_b64_tr_b16 v[218:219], v5 offset:35840
s_waitcnt lgkmcnt(8)
v_mfma_f32_32x32x16_bf16 v[228:243], v[224:227], v[76:79], v[228:243]
ds_read_b128 v[152:155], v12 offset:34816
ds_read_b128 v[156:159], v12 offset:35840
ds_read_b64_tr_b16 v[220:221], v5 offset:36864
ds_read_b64_tr_b16 v[222:223], v5 offset:37888
s_waitcnt vmcnt(2) lgkmcnt(8)
s_barrier
v_mfma_f32_32x32x16_bf16 v[228:243], v[212:215], v[80:83], v[228:243]
ds_read_b128 v[160:163], v14 offset:0
ds_read_b128 v[164:167], v14 offset:1024
ds_read_b64_tr_b16 v[224:225], v5 offset:38912
ds_read_b64_tr_b16 v[226:227], v5 offset:39936
s_waitcnt lgkmcnt(8)
v_mfma_f32_32x32x16_bf16 v[228:243], v[216:219], v[84:87], v[228:243]
ds_read_b128 v[168:171], v14 offset:2048
ds_read_b128 v[172:175], v14 offset:3072
ds_read_b64_tr_b16 v[212:213], v5 offset:40960
ds_read_b64_tr_b16 v[214:215], v5 offset:41984
s_waitcnt lgkmcnt(8)
v_mfma_f32_32x32x16_bf16 v[228:243], v[220:223], v[88:91], v[228:243]
ds_read_b64_tr_b16 v[216:217], v5 offset:43008
ds_read_b64_tr_b16 v[218:219], v5 offset:44032
s_waitcnt lgkmcnt(6)
v_mfma_f32_32x32x16_bf16 v[228:243], v[224:227], v[92:95], v[228:243]
ds_read_b64_tr_b16 v[220:221], v5 offset:45056
ds_read_b64_tr_b16 v[222:223], v5 offset:46080
s_waitcnt lgkmcnt(4)
v_mfma_f32_32x32x16_bf16 v[228:243], v[212:215], v[96:99], v[228:243]
ds_read_b64_tr_b16 v[224:225], v5 offset:47104
ds_read_b64_tr_b16 v[226:227], v5 offset:48128
s_waitcnt lgkmcnt(4)
v_mfma_f32_32x32x16_bf16 v[228:243], v[216:219], v[100:103], v[228:243]
ds_read_b64_tr_b16 v[212:213], v5 offset:49152
ds_read_b64_tr_b16 v[214:215], v5 offset:50176
s_waitcnt lgkmcnt(4)
v_mfma_f32_32x32x16_bf16 v[228:243], v[220:223], v[104:107], v[228:243]
ds_read_b64_tr_b16 v[216:217], v5 offset:51200
ds_read_b64_tr_b16 v[218:219], v5 offset:52224
s_waitcnt lgkmcnt(4)
v_mfma_f32_32x32x16_bf16 v[228:243], v[224:227], v[108:111], v[228:243]
ds_read_b64_tr_b16 v[220:221], v5 offset:53248
ds_read_b64_tr_b16 v[222:223], v5 offset:54272
s_waitcnt vmcnt(0) lgkmcnt(4)
s_barrier
v_mfma_f32_32x32x16_bf16 v[228:243], v[212:215], v[112:115], v[228:243]
ds_read_b64_tr_b16 v[224:225], v5 offset:55296
ds_read_b64_tr_b16 v[226:227], v5 offset:56320
s_waitcnt lgkmcnt(4)
v_mfma_f32_32x32x16_bf16 v[228:243], v[216:219], v[116:119], v[228:243]
ds_read_b64_tr_b16 v[212:213], v5 offset:57344
ds_read_b64_tr_b16 v[214:215], v5 offset:58368
s_waitcnt lgkmcnt(4)
v_mfma_f32_32x32x16_bf16 v[228:243], v[220:223], v[120:123], v[228:243]
ds_read_b64_tr_b16 v[216:217], v5 offset:59392
ds_read_b64_tr_b16 v[218:219], v5 offset:60416
s_waitcnt lgkmcnt(4)
v_mfma_f32_32x32x16_bf16 v[228:243], v[224:227], v[124:127], v[228:243]
ds_read_b64_tr_b16 v[220:221], v5 offset:61440
ds_read_b64_tr_b16 v[222:223], v5 offset:62464
s_waitcnt lgkmcnt(4)
v_mfma_f32_32x32x16_bf16 v[228:243], v[212:215], v[128:131], v[228:243]
ds_read_b64_tr_b16 v[224:225], v5 offset:63488
ds_read_b64_tr_b16 v[226:227], v5 offset:64512
s_waitcnt lgkmcnt(4)
v_mfma_f32_32x32x16_bf16 v[228:243], v[216:219], v[132:135], v[228:243]
ds_read_b64_tr_b16 v[212:213], v6 offset:0
ds_read_b64_tr_b16 v[214:215], v6 offset:1024
s_waitcnt lgkmcnt(4)
v_mfma_f32_32x32x16_bf16 v[228:243], v[220:223], v[136:139], v[228:243]
ds_read_b64_tr_b16 v[216:217], v6 offset:2048
ds_read_b64_tr_b16 v[218:219], v6 offset:3072
s_waitcnt lgkmcnt(4)
v_mfma_f32_32x32x16_bf16 v[228:243], v[224:227], v[140:143], v[228:243]
ds_read_b64_tr_b16 v[220:221], v6 offset:4096
ds_read_b64_tr_b16 v[222:223], v6 offset:5120
s_waitcnt lgkmcnt(4)
s_barrier
v_mfma_f32_32x32x16_bf16 v[228:243], v[212:215], v[144:147], v[228:243]
ds_read_b64_tr_b16 v[224:225], v6 offset:6144
ds_read_b64_tr_b16 v[226:227], v6 offset:7168
s_waitcnt lgkmcnt(4)
v_mfma_f32_32x32x16_bf16 v[228:243], v[216:219], v[148:151], v[228:243]
ds_read_b64_tr_b16 v[212:213], v6 offset:8192
ds_read_b64_tr_b16 v[214:215], v6 offset:9216
s_waitcnt lgkmcnt(4)
v_mfma_f32_32x32x16_bf16 v[228:243], v[220:223], v[152:155], v[228:243]
ds_read_b64_tr_b16 v[216:217], v6 offset:10240
ds_read_b64_tr_b16 v[218:219], v6 offset:11264
s_waitcnt lgkmcnt(4)
v_mfma_f32_32x32x16_bf16 v[228:243], v[224:227], v[156:159], v[228:243]
ds_read_b64_tr_b16 v[220:221], v6 offset:12288
ds_read_b64_tr_b16 v[222:223], v6 offset:13312
s_waitcnt lgkmcnt(4)
v_mfma_f32_32x32x16_bf16 v[228:243], v[212:215], v[160:163], v[228:243]
ds_read_b64_tr_b16 v[224:225], v6 offset:14336
ds_read_b64_tr_b16 v[226:227], v6 offset:15360
s_waitcnt lgkmcnt(4)
v_mfma_f32_32x32x16_bf16 v[228:243], v[216:219], v[164:167], v[228:243]
s_waitcnt lgkmcnt(2)
v_mfma_f32_32x32x16_bf16 v[228:243], v[220:223], v[168:171], v[228:243]
s_waitcnt lgkmcnt(0)
v_mfma_f32_32x32x16_bf16 v[228:243], v[224:227], v[172:175], v[228:243]
s_barrier
s_lshl_b32 s82, s70, 10
s_lshl_b32 s83, s69, 2
s_add_u32 s82, s82, 140288
v_add_u32 v14, s82, v9
v_add_u32 v15, s83, v14
ds_write_b32 v15, v201
s_mul_i32 s81, s71, 82944
s_lshl_b32 s82, s69, 8
s_add_u32 s82, s82, s81
s_add_u32 m0, s13, 131072
v_subrev_u32 v15, 896, v11
buffer_load_dwordx4 v11, s[48:51], s82 offen lds
buffer_load_dwordx4 v15, s[48:51], s82 offen offset:1024 lds
s_mov_b32 m0, 139264
s_add_u32 s81, s81, 1024
buffer_load_dwordx4 v11, s[48:51], s81 offen lds
s_add_u32 m0, s13, 65536
s_add_u32 s3, s5, s76
s_add_u32 s3, s3, 589824
buffer_load_dwordx4 v7, s[52:55], s3 offen lds
buffer_load_dwordx4 v8, s[52:55], s3 offen offset:1024 lds
s_add_u32 m0, s13, 81920
s_add_u32 s3, s6, s76
buffer_load_dwordx4 v7, s[52:55], s3 offen lds
buffer_load_dwordx4 v8, s[52:55], s3 offen offset:1024 lds
s_add_u32 m0, s13, 98304
s_add_u32 s3, s3, 147456
buffer_load_dwordx4 v7, s[52:55], s3 offen lds
buffer_load_dwordx4 v8, s[52:55], s3 offen offset:1024 lds
s_add_u32 m0, s13, 114688
s_add_u32 s3, s3, 147456
buffer_load_dwordx4 v7, s[52:55], s3 offen lds
s_nop 7
s_nop 3
buffer_load_dwordx4 v8, s[52:55], s3 offen offset:1024 lds
s_add_u32 m0, s13, 73728
s_add_u32 s3, s5, s78
buffer_load_dwordx4 v7, s[48:51], s3 offen lds
buffer_load_dwordx4 v8, s[48:51], s3 offen offset:1024 lds
s_add_u32 m0, s13, 90112
s_add_u32 s3, s6, s76
s_add_u32 s3, s3, 73728
buffer_load_dwordx4 v7, s[52:55], s3 offen lds
buffer_load_dwordx4 v8, s[52:55], s3 offen offset:1024 lds
s_add_u32 m0, s13, 106496
s_add_u32 s3, s3, 147456
buffer_load_dwordx4 v7, s[52:55], s3 offen lds
buffer_load_dwordx4 v8, s[52:55], s3 offen offset:1024 lds
s_add_u32 m0, s13, 122880
s_add_u32 s3, s3, 147456
buffer_load_dwordx4 v7, s[52:55], s3 offen lds
buffer_load_dwordx4 v8, s[52:55], s3 offen offset:1024 lds
s_waitcnt lgkmcnt(0)
s_barrier
ds_read_b128 v[176:179], v14
s_add_u32 m0, s13, 0
s_add_u32 s3, s3, 73728
buffer_load_dwordx4 v7, s[52:55], s3 offen lds
buffer_load_dwordx4 v8, s[52:55], s3 offen offset:1024 lds
s_add_u32 m0, s13, 8192
s_add_u32 s3, s3, 73728
buffer_load_dwordx4 v7, s[52:55], s3 offen lds
buffer_load_dwordx4 v8, s[52:55], s3 offen offset:1024 lds
s_waitcnt vmcnt(20)
s_barrier
ds_read_b64_tr_b16 v[244:245], v254 offset:0
ds_read_b64_tr_b16 v[246:247], v254 offset:256
s_waitcnt lgkmcnt(0)
v_mfma_f32_32x32x16_bf16 v[228:243], v[244:247], v[176:179], v[228:243]
s_nop 7
s_nop 3
s_add_u32 m0, s13, 16384
s_add_u32 s3, s3, 73728
buffer_load_dwordx4 v7, s[52:55], s3 offen lds
buffer_load_dwordx4 v8, s[52:55], s3 offen offset:1024 lds
v_cvt_pk_bf16_f32 v228, v228, v229
v_cvt_pk_bf16_f32 v229, v230, v231
v_cvt_pk_bf16_f32 v230, v232, v233
v_cvt_pk_bf16_f32 v231, v234, v235
v_cvt_pk_bf16_f32 v232, v236, v237
v_cvt_pk_bf16_f32 v233, v238, v239
s_add_u32 m0, s13, 24576
s_add_u32 s3, s6, s78
buffer_load_dwordx4 v7, s[48:51], s3 offen lds
v_cvt_pk_bf16_f32 v234, v240, v241
v_cvt_pk_bf16_f32 v235, v242, v243
s_nop 0
v_permlane32_swap_b32 v228, v230
v_permlane32_swap_b32 v229, v231
v_permlane32_swap_b32 v232, v234
buffer_load_dwordx4 v8, s[48:51], s3 offen offset:1024 lds
v_permlane32_swap_b32 v233, v235
s_waitcnt vmcnt(14)
s_barrier
s_add_u32 m0, s13, 32768
s_add_u32 s3, s7, s76
buffer_load_dwordx4 v7, s[52:55], s3 offen lds
buffer_load_dwordx4 v8, s[52:55], s3 offen offset:1024 lds
s_add_u32 m0, s13, 40960
s_add_u32 s3, s3, 73728
buffer_load_dwordx4 v7, s[52:55], s3 offen lds
buffer_load_dwordx4 v8, s[52:55], s3 offen offset:1024 lds
s_waitcnt vmcnt(16)
s_barrier
s_add_u32 m0, s13, 49152
s_add_u32 s3, s3, 73728
buffer_load_dwordx4 v7, s[52:55], s3 offen lds
buffer_load_dwordx4 v8, s[52:55], s3 offen offset:1024 lds
ds_read_b64_tr_b16 v[212:213], v6 offset:16384
ds_read_b64_tr_b16 v[214:215], v6 offset:17408
ds_read_b64_tr_b16 v[216:217], v6 offset:18432
ds_read_b64_tr_b16 v[218:219], v6 offset:19456
ds_read_b64_tr_b16 v[220:221], v6 offset:20480
ds_read_b64_tr_b16 v[222:223], v6 offset:21504
s_add_u32 m0, s13, 57344
s_add_u32 s3, s3, 73728
buffer_load_dwordx4 v7, s[52:55], s3 offen lds
buffer_load_dwordx4 v8, s[52:55], s3 offen offset:1024 lds
s_lshl_b32 s84, s4, 6
s_add_u32 s84, s84, s86
buffer_store_dwordx4 v[228:231], v9, s[56:59], s84 offen sc1
buffer_store_dwordx4 v[232:235], v9, s[56:59], s84 offen offset:1024 sc1
s_waitcnt vmcnt(20) lgkmcnt(4)
s_barrier
v_mfma_f32_32x32x16_bf16 v[228:243], v[212:215], v[16:19], 0
ds_read_b64_tr_b16 v[224:225], v6 offset:22528
ds_read_b64_tr_b16 v[226:227], v6 offset:23552
s_waitcnt lgkmcnt(4)
v_mfma_f32_32x32x16_bf16 v[228:243], v[216:219], v[20:23], v[228:243]
s_lshl_b32 s82, s6, 3
v_add_u32 v254, s82, v13
ds_read_b64_tr_b16 v[212:213], v6 offset:24576
ds_read_b64_tr_b16 v[214:215], v6 offset:25600
s_waitcnt lgkmcnt(4)
v_mfma_f32_32x32x16_bf16 v[228:243], v[220:223], v[24:27], v[228:243]
ds_read_b64_tr_b16 v[216:217], v6 offset:26624
ds_read_b64_tr_b16 v[218:219], v6 offset:27648
s_waitcnt lgkmcnt(4)
v_mfma_f32_32x32x16_bf16 v[228:243], v[224:227], v[28:31], v[228:243]
ds_read_b64_tr_b16 v[220:221], v6 offset:28672
ds_read_b64_tr_b16 v[222:223], v6 offset:29696
s_waitcnt lgkmcnt(4)
v_mfma_f32_32x32x16_bf16 v[228:243], v[212:215], v[32:35], v[228:243]
ds_read_b64_tr_b16 v[224:225], v6 offset:30720
ds_read_b64_tr_b16 v[226:227], v6 offset:31744
s_waitcnt lgkmcnt(4)
v_mfma_f32_32x32x16_bf16 v[228:243], v[216:219], v[36:39], v[228:243]
ds_read_b64_tr_b16 v[212:213], v6 offset:32768
ds_read_b64_tr_b16 v[214:215], v6 offset:33792
s_waitcnt lgkmcnt(4)
v_mfma_f32_32x32x16_bf16 v[228:243], v[220:223], v[40:43], v[228:243]
ds_read_b64_tr_b16 v[216:217], v6 offset:34816
ds_read_b64_tr_b16 v[218:219], v6 offset:35840
s_waitcnt lgkmcnt(4)
v_mfma_f32_32x32x16_bf16 v[228:243], v[224:227], v[44:47], v[228:243]
ds_read_b64_tr_b16 v[220:221], v6 offset:36864
ds_read_b64_tr_b16 v[222:223], v6 offset:37888
s_waitcnt vmcnt(18) lgkmcnt(4)
s_barrier
v_mfma_f32_32x32x16_bf16 v[228:243], v[212:215], v[48:51], v[228:243]
ds_read_b64_tr_b16 v[224:225], v6 offset:38912
ds_read_b64_tr_b16 v[226:227], v6 offset:39936
s_waitcnt lgkmcnt(4)
v_mfma_f32_32x32x16_bf16 v[228:243], v[216:219], v[52:55], v[228:243]
ds_read_b64_tr_b16 v[212:213], v6 offset:40960
ds_read_b64_tr_b16 v[214:215], v6 offset:41984
s_waitcnt lgkmcnt(4)
v_mfma_f32_32x32x16_bf16 v[228:243], v[220:223], v[56:59], v[228:243]
ds_read_b64_tr_b16 v[216:217], v6 offset:43008
ds_read_b64_tr_b16 v[218:219], v6 offset:44032
s_waitcnt lgkmcnt(4)
v_mfma_f32_32x32x16_bf16 v[228:243], v[224:227], v[60:63], v[228:243]
ds_read_b64_tr_b16 v[220:221], v6 offset:45056
ds_read_b64_tr_b16 v[222:223], v6 offset:46080
s_waitcnt lgkmcnt(4)
v_mfma_f32_32x32x16_bf16 v[228:243], v[212:215], v[64:67], v[228:243]
ds_read_b64_tr_b16 v[224:225], v6 offset:47104
ds_read_b64_tr_b16 v[226:227], v6 offset:48128
s_waitcnt lgkmcnt(4)
v_mfma_f32_32x32x16_bf16 v[228:243], v[216:219], v[68:71], v[228:243]
ds_read_b64_tr_b16 v[212:213], v6 offset:49152
ds_read_b64_tr_b16 v[214:215], v6 offset:50176
s_waitcnt lgkmcnt(4)
v_mfma_f32_32x32x16_bf16 v[228:243], v[220:223], v[72:75], v[228:243]
ds_read_b64_tr_b16 v[216:217], v6 offset:51200
ds_read_b64_tr_b16 v[218:219], v6 offset:52224
s_waitcnt lgkmcnt(4)
v_mfma_f32_32x32x16_bf16 v[228:243], v[224:227], v[76:79], v[228:243]
ds_read_b64_tr_b16 v[220:221], v6 offset:53248
ds_read_b64_tr_b16 v[222:223], v6 offset:54272
s_waitcnt vmcnt(14) lgkmcnt(4)
s_barrier
v_mfma_f32_32x32x16_bf16 v[228:243], v[212:215], v[80:83], v[228:243]
ds_read_b64_tr_b16 v[224:225], v6 offset:55296
ds_read_b64_tr_b16 v[226:227], v6 offset:56320
s_waitcnt lgkmcnt(4)
v_mfma_f32_32x32x16_bf16 v[228:243], v[216:219], v[84:87], v[228:243]
ds_read_b64_tr_b16 v[212:213], v6 offset:57344
ds_read_b64_tr_b16 v[214:215], v6 offset:58368
s_waitcnt lgkmcnt(4)
v_mfma_f32_32x32x16_bf16 v[228:243], v[220:223], v[88:91], v[228:243]
ds_read_b64_tr_b16 v[216:217], v6 offset:59392
ds_read_b64_tr_b16 v[218:219], v6 offset:60416
s_waitcnt lgkmcnt(4)
v_mfma_f32_32x32x16_bf16 v[228:243], v[224:227], v[92:95], v[228:243]
ds_read_b64_tr_b16 v[220:221], v6 offset:61440
ds_read_b64_tr_b16 v[222:223], v6 offset:62464
s_waitcnt lgkmcnt(4)
v_mfma_f32_32x32x16_bf16 v[228:243], v[212:215], v[96:99], v[228:243]
ds_read_b64_tr_b16 v[224:225], v6 offset:63488
ds_read_b64_tr_b16 v[226:227], v6 offset:64512
s_waitcnt lgkmcnt(4)
v_mfma_f32_32x32x16_bf16 v[228:243], v[216:219], v[100:103], v[228:243]
ds_read_b64_tr_b16 v[212:213], v5 offset:0
ds_read_b64_tr_b16 v[214:215], v5 offset:1024
s_waitcnt lgkmcnt(4)
v_mfma_f32_32x32x16_bf16 v[228:243], v[220:223], v[104:107], v[228:243]
ds_read_b64_tr_b16 v[216:217], v5 offset:2048
ds_read_b64_tr_b16 v[218:219], v5 offset:3072
s_waitcnt lgkmcnt(4)
v_mfma_f32_32x32x16_bf16 v[228:243], v[224:227], v[108:111], v[228:243]
ds_read_b64_tr_b16 v[220:221], v5 offset:4096
ds_read_b64_tr_b16 v[222:223], v5 offset:5120
s_waitcnt vmcnt(10) lgkmcnt(4)
s_barrier
v_mfma_f32_32x32x16_bf16 v[228:243], v[212:215], v[112:115], v[228:243]
ds_read_b64_tr_b16 v[224:225], v5 offset:6144
ds_read_b64_tr_b16 v[226:227], v5 offset:7168
s_waitcnt lgkmcnt(4)
v_mfma_f32_32x32x16_bf16 v[228:243], v[216:219], v[116:119], v[228:243]
ds_read_b64_tr_b16 v[212:213], v5 offset:8192
ds_read_b64_tr_b16 v[214:215], v5 offset:9216
s_waitcnt lgkmcnt(4)
v_mfma_f32_32x32x16_bf16 v[228:243], v[220:223], v[120:123], v[228:243]
ds_read_b64_tr_b16 v[216:217], v5 offset:10240
ds_read_b64_tr_b16 v[218:219], v5 offset:11264
s_waitcnt lgkmcnt(4)
v_mfma_f32_32x32x16_bf16 v[228:243], v[224:227], v[124:127], v[228:243]
ds_read_b64_tr_b16 v[220:221], v5 offset:12288
ds_read_b64_tr_b16 v[222:223], v5 offset:13312
s_waitcnt lgkmcnt(4)
v_mfma_f32_32x32x16_bf16 v[228:243], v[212:215], v[128:131], v[228:243]
ds_read_b64_tr_b16 v[224:225], v5 offset:14336
ds_read_b64_tr_b16 v[226:227], v5 offset:15360
s_waitcnt lgkmcnt(4)
v_mfma_f32_32x32x16_bf16 v[228:243], v[216:219], v[132:135], v[228:243]
ds_read_b64_tr_b16 v[212:213], v5 offset:16384
ds_read_b64_tr_b16 v[214:215], v5 offset:17408
s_waitcnt lgkmcnt(4)
v_mfma_f32_32x32x16_bf16 v[228:243], v[220:223], v[136:139], v[228:243]
ds_read_b64_tr_b16 v[216:217], v5 offset:18432
ds_read_b64_tr_b16 v[218:219], v5 offset:19456
s_waitcnt lgkmcnt(4)
v_mfma_f32_32x32x16_bf16 v[228:243], v[224:227], v[140:143], v[228:243]
ds_read_b64_tr_b16 v[220:221], v5 offset:20480
ds_read_b64_tr_b16 v[222:223], v5 offset:21504
s_waitcnt vmcnt(6) lgkmcnt(4)
s_barrier
v_mfma_f32_32x32x16_bf16 v[228:243], v[212:215], v[144:147], v[228:243]
ds_read_b64_tr_b16 v[224:225], v5 offset:22528
ds_read_b64_tr_b16 v[226:227], v5 offset:23552
s_waitcnt lgkmcnt(4)
v_mfma_f32_32x32x16_bf16 v[228:243], v[216:219], v[148:151], v[228:243]
ds_read_b64_tr_b16 v[212:213], v5 offset:24576
ds_read_b64_tr_b16 v[214:215], v5 offset:25600
s_waitcnt lgkmcnt(4)
v_mfma_f32_32x32x16_bf16 v[228:243], v[220:223], v[152:155], v[228:243]
ds_read_b64_tr_b16 v[216:217], v5 offset:26624
ds_read_b64_tr_b16 v[218:219], v5 offset:27648
s_waitcnt lgkmcnt(4)
v_mfma_f32_32x32x16_bf16 v[228:243], v[224:227], v[156:159], v[228:243]
ds_read_b64_tr_b16 v[244:245], v254 offset:0
ds_read_b64_tr_b16 v[246:247], v254 offset:256
ds_read_b64_tr_b16 v[220:221], v5 offset:28672
ds_read_b64_tr_b16 v[222:223], v5 offset:29696
s_waitcnt lgkmcnt(6)
v_mfma_f32_32x32x16_bf16 v[228:243], v[212:215], v[160:163], v[228:243]
ds_read_b64_tr_b16 v[224:225], v5 offset:30720
ds_read_b64_tr_b16 v[226:227], v5 offset:31744
s_waitcnt lgkmcnt(6)
v_mfma_f32_32x32x16_bf16 v[228:243], v[216:219], v[164:167], v[228:243]
s_waitcnt lgkmcnt(2)
v_mfma_f32_32x32x16_bf16 v[228:243], v[220:223], v[168:171], v[228:243]
s_waitcnt lgkmcnt(0)
v_mfma_f32_32x32x16_bf16 v[228:243], v[224:227], v[172:175], v[228:243]
v_mfma_f32_32x32x16_bf16 v[228:243], v[244:247], v[176:179], v[228:243]
s_waitcnt vmcnt(2)
s_barrier
s_add_u32 m0, s13, 16384
s_add_u32 s3, s8, s76
s_add_u32 s3, s3, 294912
buffer_load_dwordx4 v7, s[52:55], s3 offen lds
s_nop 7
s_nop 3
buffer_load_dwordx4 v8, s[52:55], s3 offen offset:1024 lds
v_cvt_pk_bf16_f32 v228, v228, v229
v_cvt_pk_bf16_f32 v229, v230, v231
v_cvt_pk_bf16_f32 v230, v232, v233
v_cvt_pk_bf16_f32 v231, v234, v235
v_cvt_pk_bf16_f32 v232, v236, v237
v_cvt_pk_bf16_f32 v233, v238, v239
s_add_u32 m0, s13, 24576
s_add_u32 s3, s3, 73728
buffer_load_dwordx4 v7, s[52:55], s3 offen lds
v_cvt_pk_bf16_f32 v234, v240, v241
v_cvt_pk_bf16_f32 v235, v242, v243
s_nop 0
v_permlane32_swap_b32 v228, v230
v_permlane32_swap_b32 v229, v231
v_permlane32_swap_b32 v232, v234
buffer_load_dwordx4 v8, s[52:55], s3 offen offset:1024 lds
v_permlane32_swap_b32 v233, v235
s_barrier
s_add_u32 m0, s13, 32768
s_add_u32 s3, s3, 73728
buffer_load_dwordx4 v7, s[52:55], s3 offen lds
buffer_load_dwordx4 v8, s[52:55], s3 offen offset:1024 lds
s_add_u32 m0, s13, 40960
s_add_u32 s3, s3, 73728
buffer_load_dwordx4 v7, s[52:55], s3 offen lds
buffer_load_dwordx4 v8, s[52:55], s3 offen offset:1024 lds
s_barrier
s_add_u32 m0, s13, 49152
s_add_u32 s3, s3, 73728
buffer_load_dwordx4 v7, s[52:55], s3 offen lds
buffer_load_dwordx4 v8, s[52:55], s3 offen offset:1024 lds
s_add_u32 m0, s13, 57344
s_add_u32 s3, s8, s78
buffer_load_dwordx4 v7, s[48:51], s3 offen lds
buffer_load_dwordx4 v8, s[48:51], s3 offen offset:1024 lds
s_barrier
s_add_u32 m0, s13, 65536
s_add_u32 s3, s9, s76
buffer_load_dwordx4 v7, s[52:55], s3 offen lds
buffer_load_dwordx4 v8, s[52:55], s3 offen offset:1024 lds
s_add_u32 m0, s13, 73728
s_add_u32 s3, s3, 73728
buffer_load_dwordx4 v7, s[52:55], s3 offen lds
buffer_load_dwordx4 v8, s[52:55], s3 offen offset:1024 lds
s_barrier
s_add_u32 m0, s13, 81920
s_add_u32 s3, s3, 73728
buffer_load_dwordx4 v7, s[52:55], s3 offen lds
buffer_load_dwordx4 v8, s[52:55], s3 offen offset:1024 lds
ds_read_b64_tr_b16 v[212:213], v6 offset:49152
ds_read_b64_tr_b16 v[214:215], v6 offset:50176
ds_read_b64_tr_b16 v[216:217], v6 offset:51200
ds_read_b64_tr_b16 v[218:219], v6 offset:52224
ds_read_b64_tr_b16 v[220:221], v6 offset:53248
ds_read_b64_tr_b16 v[222:223], v6 offset:54272
s_add_u32 m0, s13, 90112
s_add_u32 s3, s3, 73728
buffer_load_dwordx4 v7, s[52:55], s3 offen lds
buffer_load_dwordx4 v8, s[52:55], s3 offen offset:1024 lds
s_waitcnt vmcnt(20)
s_mov_b64 exec, 1
buffer_store_dword v196, v198, s[56:59], s92 offen offset:0 sc1
s_mov_b64 exec, -1
s_lshl_b32 s84, s6, 6
s_add_u32 s84, s84, s86
buffer_store_dwordx4 v[228:231], v9, s[56:59], s84 offen sc1
buffer_store_dwordx4 v[232:235], v9, s[56:59], s84 offen offset:1024 sc1
s_waitcnt lgkmcnt(4)
s_barrier
v_mfma_f32_32x32x16_bf16 v[228:243], v[212:215], v[16:19], 0
ds_read_b64_tr_b16 v[224:225], v6 offset:55296
ds_read_b64_tr_b16 v[226:227], v6 offset:56320
s_waitcnt lgkmcnt(4)
v_mfma_f32_32x32x16_bf16 v[228:243], v[216:219], v[20:23], v[228:243]
s_lshl_b32 s82, s8, 3
v_add_u32 v254, s82, v13
ds_read_b64_tr_b16 v[212:213], v6 offset:57344
ds_read_b64_tr_b16 v[214:215], v6 offset:58368
s_waitcnt lgkmcnt(4)
v_mfma_f32_32x32x16_bf16 v[228:243], v[220:223], v[24:27], v[228:243]
ds_read_b64_tr_b16 v[216:217], v6 offset:59392
ds_read_b64_tr_b16 v[218:219], v6 offset:60416
s_waitcnt lgkmcnt(4)
v_mfma_f32_32x32x16_bf16 v[228:243], v[224:227], v[28:31], v[228:243]
ds_read_b64_tr_b16 v[220:221], v6 offset:61440
ds_read_b64_tr_b16 v[222:223], v6 offset:62464
s_waitcnt lgkmcnt(4)
v_mfma_f32_32x32x16_bf16 v[228:243], v[212:215], v[32:35], v[228:243]
ds_read_b64_tr_b16 v[224:225], v6 offset:63488
ds_read_b64_tr_b16 v[226:227], v6 offset:64512
s_waitcnt lgkmcnt(4)
v_mfma_f32_32x32x16_bf16 v[228:243], v[216:219], v[36:39], v[228:243]
ds_read_b64_tr_b16 v[212:213], v5 offset:0
ds_read_b64_tr_b16 v[214:215], v5 offset:1024
s_waitcnt lgkmcnt(4)
v_mfma_f32_32x32x16_bf16 v[228:243], v[220:223], v[40:43], v[228:243]
ds_read_b64_tr_b16 v[216:217], v5 offset:2048
ds_read_b64_tr_b16 v[218:219], v5 offset:3072
s_waitcnt lgkmcnt(4)
v_mfma_f32_32x32x16_bf16 v[228:243], v[224:227], v[44:47], v[228:243]
ds_read_b64_tr_b16 v[220:221], v5 offset:4096
ds_read_b64_tr_b16 v[222:223], v5 offset:5120
s_waitcnt vmcnt(19) lgkmcnt(4)
s_barrier
v_mfma_f32_32x32x16_bf16 v[228:243], v[212:215], v[48:51], v[228:243]
ds_read_b64_tr_b16 v[224:225], v5 offset:6144
ds_read_b64_tr_b16 v[226:227], v5 offset:7168
s_waitcnt lgkmcnt(4)
v_mfma_f32_32x32x16_bf16 v[228:243], v[216:219], v[52:55], v[228:243]
ds_read_b64_tr_b16 v[212:213], v5 offset:8192
ds_read_b64_tr_b16 v[214:215], v5 offset:9216
s_waitcnt lgkmcnt(4)
v_mfma_f32_32x32x16_bf16 v[228:243], v[220:223], v[56:59], v[228:243]
ds_read_b64_tr_b16 v[216:217], v5 offset:10240
ds_read_b64_tr_b16 v[218:219], v5 offset:11264
s_waitcnt lgkmcnt(4)
v_mfma_f32_32x32x16_bf16 v[228:243], v[224:227], v[60:63], v[228:243]
ds_read_b64_tr_b16 v[220:221], v5 offset:12288
ds_read_b64_tr_b16 v[222:223], v5 offset:13312
s_waitcnt lgkmcnt(4)
v_mfma_f32_32x32x16_bf16 v[228:243], v[212:215], v[64:67], v[228:243]
ds_read_b64_tr_b16 v[224:225], v5 offset:14336
ds_read_b64_tr_b16 v[226:227], v5 offset:15360
s_waitcnt lgkmcnt(4)
v_mfma_f32_32x32x16_bf16 v[228:243], v[216:219], v[68:71], v[228:243]
ds_read_b64_tr_b16 v[212:213], v5 offset:16384
ds_read_b64_tr_b16 v[214:215], v5 offset:17408
s_waitcnt lgkmcnt(4)
v_mfma_f32_32x32x16_bf16 v[228:243], v[220:223], v[72:75], v[228:243]
ds_read_b64_tr_b16 v[216:217], v5 offset:18432
ds_read_b64_tr_b16 v[218:219], v5 offset:19456
s_waitcnt lgkmcnt(4)
v_mfma_f32_32x32x16_bf16 v[228:243], v[224:227], v[76:79], v[228:243]
ds_read_b64_tr_b16 v[220:221], v5 offset:20480
ds_read_b64_tr_b16 v[222:223], v5 offset:21504
s_waitcnt vmcnt(15) lgkmcnt(4)
s_barrier
v_mfma_f32_32x32x16_bf16 v[228:243], v[212:215], v[80:83], v[228:243]
ds_read_b64_tr_b16 v[224:225], v5 offset:22528
ds_read_b64_tr_b16 v[226:227], v5 offset:23552
s_waitcnt lgkmcnt(4)
v_mfma_f32_32x32x16_bf16 v[228:243], v[216:219], v[84:87], v[228:243]
ds_read_b64_tr_b16 v[212:213], v5 offset:24576
ds_read_b64_tr_b16 v[214:215], v5 offset:25600
s_waitcnt lgkmcnt(4)
v_mfma_f32_32x32x16_bf16 v[228:243], v[220:223], v[88:91], v[228:243]
ds_read_b64_tr_b16 v[216:217], v5 offset:26624
ds_read_b64_tr_b16 v[218:219], v5 offset:27648
s_waitcnt lgkmcnt(4)
v_mfma_f32_32x32x16_bf16 v[228:243], v[224:227], v[92:95], v[228:243]
ds_read_b64_tr_b16 v[220:221], v5 offset:28672
ds_read_b64_tr_b16 v[222:223], v5 offset:29696
s_waitcnt lgkmcnt(4)
v_mfma_f32_32x32x16_bf16 v[228:243], v[212:215], v[96:99], v[228:243]
ds_read_b64_tr_b16 v[224:225], v5 offset:30720
ds_read_b64_tr_b16 v[226:227], v5 offset:31744
s_waitcnt lgkmcnt(4)
v_mfma_f32_32x32x16_bf16 v[228:243], v[216:219], v[100:103], v[228:243]
ds_read_b64_tr_b16 v[212:213], v5 offset:32768
ds_read_b64_tr_b16 v[214:215], v5 offset:33792
s_waitcnt lgkmcnt(4)
v_mfma_f32_32x32x16_bf16 v[228:243], v[220:223], v[104:107], v[228:243]
ds_read_b64_tr_b16 v[216:217], v5 offset:34816
ds_read_b64_tr_b16 v[218:219], v5 offset:35840
s_waitcnt lgkmcnt(4)
v_mfma_f32_32x32x16_bf16 v[228:243], v[224:227], v[108:111], v[228:243]
ds_read_b64_tr_b16 v[220:221], v5 offset:36864
ds_read_b64_tr_b16 v[222:223], v5 offset:37888
s_waitcnt vmcnt(11) lgkmcnt(4)
s_barrier
v_mfma_f32_32x32x16_bf16 v[228:243], v[212:215], v[112:115], v[228:243]
ds_read_b64_tr_b16 v[224:225], v5 offset:38912
ds_read_b64_tr_b16 v[226:227], v5 offset:39936
s_waitcnt lgkmcnt(4)
v_mfma_f32_32x32x16_bf16 v[228:243], v[216:219], v[116:119], v[228:243]
ds_read_b64_tr_b16 v[212:213], v5 offset:40960
ds_read_b64_tr_b16 v[214:215], v5 offset:41984
s_waitcnt lgkmcnt(4)
v_mfma_f32_32x32x16_bf16 v[228:243], v[220:223], v[120:123], v[228:243]
ds_read_b64_tr_b16 v[216:217], v5 offset:43008
ds_read_b64_tr_b16 v[218:219], v5 offset:44032
s_waitcnt lgkmcnt(4)
v_mfma_f32_32x32x16_bf16 v[228:243], v[224:227], v[124:127], v[228:243]
ds_read_b64_tr_b16 v[220:221], v5 offset:45056
ds_read_b64_tr_b16 v[222:223], v5 offset:46080
s_waitcnt lgkmcnt(4)
v_mfma_f32_32x32x16_bf16 v[228:243], v[212:215], v[128:131], v[228:243]
ds_read_b64_tr_b16 v[224:225], v5 offset:47104
ds_read_b64_tr_b16 v[226:227], v5 offset:48128
s_waitcnt lgkmcnt(4)
v_mfma_f32_32x32x16_bf16 v[228:243], v[216:219], v[132:135], v[228:243]
ds_read_b64_tr_b16 v[212:213], v5 offset:49152
ds_read_b64_tr_b16 v[214:215], v5 offset:50176
s_waitcnt lgkmcnt(4)
v_mfma_f32_32x32x16_bf16 v[228:243], v[220:223], v[136:139], v[228:243]
ds_read_b64_tr_b16 v[216:217], v5 offset:51200
ds_read_b64_tr_b16 v[218:219], v5 offset:52224
s_waitcnt lgkmcnt(4)
v_mfma_f32_32x32x16_bf16 v[228:243], v[224:227], v[140:143], v[228:243]
ds_read_b64_tr_b16 v[220:221], v5 offset:53248
ds_read_b64_tr_b16 v[222:223], v5 offset:54272
s_waitcnt vmcnt(7) lgkmcnt(4)
s_barrier
v_mfma_f32_32x32x16_bf16 v[228:243], v[212:215], v[144:147], v[228:243]
ds_read_b64_tr_b16 v[224:225], v5 offset:55296
ds_read_b64_tr_b16 v[226:227], v5 offset:56320
s_waitcnt lgkmcnt(4)
v_mfma_f32_32x32x16_bf16 v[228:243], v[216:219], v[148:151], v[228:243]
ds_read_b64_tr_b16 v[212:213], v5 offset:57344
ds_read_b64_tr_b16 v[214:215], v5 offset:58368
s_waitcnt lgkmcnt(4)
v_mfma_f32_32x32x16_bf16 v[228:243], v[220:223], v[152:155], v[228:243]
ds_read_b64_tr_b16 v[216:217], v5 offset:59392
ds_read_b64_tr_b16 v[218:219], v5 offset:60416
s_waitcnt lgkmcnt(4)
v_mfma_f32_32x32x16_bf16 v[228:243], v[224:227], v[156:159], v[228:243]
ds_read_b64_tr_b16 v[244:245], v254 offset:0
ds_read_b64_tr_b16 v[246:247], v254 offset:256
ds_read_b64_tr_b16 v[220:221], v5 offset:61440
ds_read_b64_tr_b16 v[222:223], v5 offset:62464
s_waitcnt lgkmcnt(6)
v_mfma_f32_32x32x16_bf16 v[228:243], v[212:215], v[160:163], v[228:243]
ds_read_b64_tr_b16 v[224:225], v5 offset:63488
ds_read_b64_tr_b16 v[226:227], v5 offset:64512
s_waitcnt lgkmcnt(6)
v_mfma_f32_32x32x16_bf16 v[228:243], v[216:219], v[164:167], v[228:243]
s_waitcnt lgkmcnt(2)
v_mfma_f32_32x32x16_bf16 v[228:243], v[220:223], v[168:171], v[228:243]
s_waitcnt lgkmcnt(0)
v_mfma_f32_32x32x16_bf16 v[228:243], v[224:227], v[172:175], v[228:243]
v_mfma_f32_32x32x16_bf16 v[228:243], v[244:247], v[176:179], v[228:243]
s_waitcnt vmcnt(3)
s_barrier
s_add_u32 m0, s13, 49152
s_add_u32 s3, s10, s76
s_add_u32 s3, s3, 294912
buffer_load_dwordx4 v7, s[52:55], s3 offen lds
s_nop 7
s_nop 3
buffer_load_dwordx4 v8, s[52:55], s3 offen offset:1024 lds
v_cvt_pk_bf16_f32 v228, v228, v229
v_cvt_pk_bf16_f32 v229, v230, v231
v_cvt_pk_bf16_f32 v230, v232, v233
v_cvt_pk_bf16_f32 v231, v234, v235
v_cvt_pk_bf16_f32 v232, v236, v237
v_cvt_pk_bf16_f32 v233, v238, v239
s_add_u32 m0, s13, 57344
s_add_u32 s3, s3, 73728
buffer_load_dwordx4 v7, s[52:55], s3 offen lds
v_cvt_pk_bf16_f32 v234, v240, v241
v_cvt_pk_bf16_f32 v235, v242, v243
s_nop 0
v_permlane32_swap_b32 v228, v230
v_permlane32_swap_b32 v229, v231
v_permlane32_swap_b32 v232, v234
buffer_load_dwordx4 v8, s[52:55], s3 offen offset:1024 lds
v_permlane32_swap_b32 v233, v235
s_barrier
s_add_u32 m0, s13, 65536
s_add_u32 s3, s3, 73728
buffer_load_dwordx4 v7, s[52:55], s3 offen lds
buffer_load_dwordx4 v8, s[52:55], s3 offen offset:1024 lds
s_add_u32 m0, s13, 73728
s_add_u32 s3, s3, 73728
buffer_load_dwordx4 v7, s[52:55], s3 offen lds
buffer_load_dwordx4 v8, s[52:55], s3 offen offset:1024 lds
s_barrier
s_add_u32 m0, s13, 81920
s_add_u32 s3, s3, 73728
buffer_load_dwordx4 v7, s[52:55], s3 offen lds
buffer_load_dwordx4 v8, s[52:55], s3 offen offset:1024 lds
s_add_u32 m0, s13, 90112
s_add_u32 s3, s10, s78
buffer_load_dwordx4 v7, s[48:51], s3 offen lds
buffer_load_dwordx4 v8, s[48:51], s3 offen offset:1024 lds
s_barrier
s_add_u32 m0, s13, 98304
s_add_u32 s3, s11, s76
buffer_load_dwordx4 v7, s[52:55], s3 offen lds
buffer_load_dwordx4 v8, s[52:55], s3 offen offset:1024 lds
s_add_u32 m0, s13, 106496
s_add_u32 s3, s3, 73728
buffer_load_dwordx4 v7, s[52:55], s3 offen lds
buffer_load_dwordx4 v8, s[52:55], s3 offen offset:1024 lds
s_barrier
s_add_u32 m0, s13, 114688
s_add_u32 s3, s3, 73728
buffer_load_dwordx4 v7, s[52:55], s3 offen lds
buffer_load_dwordx4 v8, s[52:55], s3 offen offset:1024 lds
ds_read_b64_tr_b16 v[212:213], v5 offset:16384
ds_read_b64_tr_b16 v[214:215], v5 offset:17408
ds_read_b64_tr_b16 v[216:217], v5 offset:18432
ds_read_b64_tr_b16 v[218:219], v5 offset:19456
ds_read_b64_tr_b16 v[220:221], v5 offset:20480
ds_read_b64_tr_b16 v[222:223], v5 offset:21504
s_add_u32 m0, s13, 122880
s_add_u32 s3, s3, 73728
buffer_load_dwordx4 v7, s[52:55], s3 offen lds
buffer_load_dwordx4 v8, s[52:55], s3 offen offset:1024 lds
s_waitcnt vmcnt(20)
s_mov_b64 exec, 1
buffer_store_dword v196, v198, s[56:59], s92 offen offset:512 sc1
s_mov_b64 exec, -1
s_lshl_b32 s84, s8, 6
s_add_u32 s84, s84, s86
buffer_store_dwordx4 v[228:231], v9, s[56:59], s84 offen sc1
buffer_store_dwordx4 v[232:235], v9, s[56:59], s84 offen offset:1024 sc1
s_waitcnt lgkmcnt(4)
s_barrier
v_mfma_f32_32x32x16_bf16 v[228:243], v[212:215], v[16:19], 0
ds_read_b64_tr_b16 v[224:225], v5 offset:22528
ds_read_b64_tr_b16 v[226:227], v5 offset:23552
s_waitcnt lgkmcnt(4)
v_mfma_f32_32x32x16_bf16 v[228:243], v[216:219], v[20:23], v[228:243]
s_lshl_b32 s82, s10, 3
v_add_u32 v254, s82, v13
ds_read_b64_tr_b16 v[212:213], v5 offset:24576
ds_read_b64_tr_b16 v[214:215], v5 offset:25600
s_waitcnt lgkmcnt(4)
v_mfma_f32_32x32x16_bf16 v[228:243], v[220:223], v[24:27], v[228:243]
ds_read_b64_tr_b16 v[216:217], v5 offset:26624
ds_read_b64_tr_b16 v[218:219], v5 offset:27648
s_waitcnt lgkmcnt(4)
v_mfma_f32_32x32x16_bf16 v[228:243], v[224:227], v[28:31], v[228:243]
ds_read_b64_tr_b16 v[220:221], v5 offset:28672
ds_read_b64_tr_b16 v[222:223], v5 offset:29696
s_waitcnt lgkmcnt(4)
v_mfma_f32_32x32x16_bf16 v[228:243], v[212:215], v[32:35], v[228:243]
ds_read_b64_tr_b16 v[224:225], v5 offset:30720
ds_read_b64_tr_b16 v[226:227], v5 offset:31744
s_waitcnt lgkmcnt(4)
v_mfma_f32_32x32x16_bf16 v[228:243], v[216:219], v[36:39], v[228:243]
ds_read_b64_tr_b16 v[212:213], v5 offset:32768
ds_read_b64_tr_b16 v[214:215], v5 offset:33792
s_waitcnt lgkmcnt(4)
v_mfma_f32_32x32x16_bf16 v[228:243], v[220:223], v[40:43], v[228:243]
ds_read_b64_tr_b16 v[216:217], v5 offset:34816
ds_read_b64_tr_b16 v[218:219], v5 offset:35840
s_waitcnt lgkmcnt(4)
v_mfma_f32_32x32x16_bf16 v[228:243], v[224:227], v[44:47], v[228:243]
ds_read_b64_tr_b16 v[220:221], v5 offset:36864
ds_read_b64_tr_b16 v[222:223], v5 offset:37888
s_waitcnt vmcnt(19) lgkmcnt(4)
s_barrier
v_mfma_f32_32x32x16_bf16 v[228:243], v[212:215], v[48:51], v[228:243]
ds_read_b64_tr_b16 v[224:225], v5 offset:38912
ds_read_b64_tr_b16 v[226:227], v5 offset:39936
s_waitcnt lgkmcnt(4)
v_mfma_f32_32x32x16_bf16 v[228:243], v[216:219], v[52:55], v[228:243]
ds_read_b64_tr_b16 v[212:213], v5 offset:40960
ds_read_b64_tr_b16 v[214:215], v5 offset:41984
s_waitcnt lgkmcnt(4)
v_mfma_f32_32x32x16_bf16 v[228:243], v[220:223], v[56:59], v[228:243]
ds_read_b64_tr_b16 v[216:217], v5 offset:43008
ds_read_b64_tr_b16 v[218:219], v5 offset:44032
s_waitcnt lgkmcnt(4)
v_mfma_f32_32x32x16_bf16 v[228:243], v[224:227], v[60:63], v[228:243]
ds_read_b64_tr_b16 v[220:221], v5 offset:45056
ds_read_b64_tr_b16 v[222:223], v5 offset:46080
s_waitcnt lgkmcnt(4)
v_mfma_f32_32x32x16_bf16 v[228:243], v[212:215], v[64:67], v[228:243]
ds_read_b64_tr_b16 v[224:225], v5 offset:47104
ds_read_b64_tr_b16 v[226:227], v5 offset:48128
s_waitcnt lgkmcnt(4)
v_mfma_f32_32x32x16_bf16 v[228:243], v[216:219], v[68:71], v[228:243]
ds_read_b64_tr_b16 v[212:213], v5 offset:49152
ds_read_b64_tr_b16 v[214:215], v5 offset:50176
s_waitcnt lgkmcnt(4)
v_mfma_f32_32x32x16_bf16 v[228:243], v[220:223], v[72:75], v[228:243]
ds_read_b64_tr_b16 v[216:217], v5 offset:51200
ds_read_b64_tr_b16 v[218:219], v5 offset:52224
s_waitcnt lgkmcnt(4)
v_mfma_f32_32x32x16_bf16 v[228:243], v[224:227], v[76:79], v[228:243]
ds_read_b64_tr_b16 v[220:221], v5 offset:53248
ds_read_b64_tr_b16 v[222:223], v5 offset:54272
s_waitcnt vmcnt(15) lgkmcnt(4)
s_barrier
v_mfma_f32_32x32x16_bf16 v[228:243], v[212:215], v[80:83], v[228:243]
ds_read_b64_tr_b16 v[224:225], v5 offset:55296
ds_read_b64_tr_b16 v[226:227], v5 offset:56320
s_waitcnt lgkmcnt(4)
v_mfma_f32_32x32x16_bf16 v[228:243], v[216:219], v[84:87], v[228:243]
ds_read_b64_tr_b16 v[212:213], v5 offset:57344
ds_read_b64_tr_b16 v[214:215], v5 offset:58368
s_waitcnt lgkmcnt(4)
v_mfma_f32_32x32x16_bf16 v[228:243], v[220:223], v[88:91], v[228:243]
ds_read_b64_tr_b16 v[216:217], v5 offset:59392
ds_read_b64_tr_b16 v[218:219], v5 offset:60416
s_waitcnt lgkmcnt(4)
v_mfma_f32_32x32x16_bf16 v[228:243], v[224:227], v[92:95], v[228:243]
ds_read_b64_tr_b16 v[220:221], v5 offset:61440
ds_read_b64_tr_b16 v[222:223], v5 offset:62464
s_waitcnt lgkmcnt(4)
v_mfma_f32_32x32x16_bf16 v[228:243], v[212:215], v[96:99], v[228:243]
ds_read_b64_tr_b16 v[224:225], v5 offset:63488
ds_read_b64_tr_b16 v[226:227], v5 offset:64512
s_waitcnt lgkmcnt(4)
v_mfma_f32_32x32x16_bf16 v[228:243], v[216:219], v[100:103], v[228:243]
ds_read_b64_tr_b16 v[212:213], v6 offset:0
ds_read_b64_tr_b16 v[214:215], v6 offset:1024
s_waitcnt lgkmcnt(4)
v_mfma_f32_32x32x16_bf16 v[228:243], v[220:223], v[104:107], v[228:243]
ds_read_b64_tr_b16 v[216:217], v6 offset:2048
ds_read_b64_tr_b16 v[218:219], v6 offset:3072
s_waitcnt lgkmcnt(4)
v_mfma_f32_32x32x16_bf16 v[228:243], v[224:227], v[108:111], v[228:243]
ds_read_b64_tr_b16 v[220:221], v6 offset:4096
ds_read_b64_tr_b16 v[222:223], v6 offset:5120
s_waitcnt vmcnt(11) lgkmcnt(4)
s_barrier
v_mfma_f32_32x32x16_bf16 v[228:243], v[212:215], v[112:115], v[228:243]
ds_read_b64_tr_b16 v[224:225], v6 offset:6144
ds_read_b64_tr_b16 v[226:227], v6 offset:7168
s_waitcnt lgkmcnt(4)
v_mfma_f32_32x32x16_bf16 v[228:243], v[216:219], v[116:119], v[228:243]
ds_read_b64_tr_b16 v[212:213], v6 offset:8192
ds_read_b64_tr_b16 v[214:215], v6 offset:9216
s_waitcnt lgkmcnt(4)
v_mfma_f32_32x32x16_bf16 v[228:243], v[220:223], v[120:123], v[228:243]
ds_read_b64_tr_b16 v[216:217], v6 offset:10240
ds_read_b64_tr_b16 v[218:219], v6 offset:11264
s_waitcnt lgkmcnt(4)
v_mfma_f32_32x32x16_bf16 v[228:243], v[224:227], v[124:127], v[228:243]
ds_read_b64_tr_b16 v[220:221], v6 offset:12288
ds_read_b64_tr_b16 v[222:223], v6 offset:13312
s_waitcnt lgkmcnt(4)
v_mfma_f32_32x32x16_bf16 v[228:243], v[212:215], v[128:131], v[228:243]
ds_read_b64_tr_b16 v[224:225], v6 offset:14336
ds_read_b64_tr_b16 v[226:227], v6 offset:15360
s_waitcnt lgkmcnt(4)
v_mfma_f32_32x32x16_bf16 v[228:243], v[216:219], v[132:135], v[228:243]
ds_read_b64_tr_b16 v[212:213], v6 offset:16384
ds_read_b64_tr_b16 v[214:215], v6 offset:17408
s_waitcnt lgkmcnt(4)
v_mfma_f32_32x32x16_bf16 v[228:243], v[220:223], v[136:139], v[228:243]
ds_read_b64_tr_b16 v[216:217], v6 offset:18432
ds_read_b64_tr_b16 v[218:219], v6 offset:19456
s_waitcnt lgkmcnt(4)
v_mfma_f32_32x32x16_bf16 v[228:243], v[224:227], v[140:143], v[228:243]
ds_read_b64_tr_b16 v[220:221], v6 offset:20480
ds_read_b64_tr_b16 v[222:223], v6 offset:21504
s_waitcnt vmcnt(7) lgkmcnt(4)
s_barrier
v_mfma_f32_32x32x16_bf16 v[228:243], v[212:215], v[144:147], v[228:243]
ds_read_b64_tr_b16 v[224:225], v6 offset:22528
ds_read_b64_tr_b16 v[226:227], v6 offset:23552
s_waitcnt lgkmcnt(4)
v_mfma_f32_32x32x16_bf16 v[228:243], v[216:219], v[148:151], v[228:243]
ds_read_b64_tr_b16 v[212:213], v6 offset:24576
ds_read_b64_tr_b16 v[214:215], v6 offset:25600
s_waitcnt lgkmcnt(4)
v_mfma_f32_32x32x16_bf16 v[228:243], v[220:223], v[152:155], v[228:243]
ds_read_b64_tr_b16 v[216:217], v6 offset:26624
ds_read_b64_tr_b16 v[218:219], v6 offset:27648
s_waitcnt lgkmcnt(4)
v_mfma_f32_32x32x16_bf16 v[228:243], v[224:227], v[156:159], v[228:243]
ds_read_b64_tr_b16 v[244:245], v254 offset:0
ds_read_b64_tr_b16 v[246:247], v254 offset:256
ds_read_b64_tr_b16 v[220:221], v6 offset:28672
ds_read_b64_tr_b16 v[222:223], v6 offset:29696
s_waitcnt lgkmcnt(6)
v_mfma_f32_32x32x16_bf16 v[228:243], v[212:215], v[160:163], v[228:243]
ds_read_b64_tr_b16 v[224:225], v6 offset:30720
ds_read_b64_tr_b16 v[226:227], v6 offset:31744
s_waitcnt lgkmcnt(6)
v_mfma_f32_32x32x16_bf16 v[228:243], v[216:219], v[164:167], v[228:243]
s_waitcnt lgkmcnt(2)
v_mfma_f32_32x32x16_bf16 v[228:243], v[220:223], v[168:171], v[228:243]
s_waitcnt lgkmcnt(0)
v_mfma_f32_32x32x16_bf16 v[228:243], v[224:227], v[172:175], v[228:243]
v_mfma_f32_32x32x16_bf16 v[228:243], v[244:247], v[176:179], v[228:243]
s_waitcnt vmcnt(3)
s_barrier
s_add_u32 m0, s13, 81920
s_add_u32 s3, s12, s76
s_add_u32 s3, s3, 294912
buffer_load_dwordx4 v7, s[52:55], s3 offen lds
s_nop 7
s_nop 3
buffer_load_dwordx4 v8, s[52:55], s3 offen offset:1024 lds
v_cvt_pk_bf16_f32 v228, v228, v229
v_cvt_pk_bf16_f32 v229, v230, v231
v_cvt_pk_bf16_f32 v230, v232, v233
v_cvt_pk_bf16_f32 v231, v234, v235
v_cvt_pk_bf16_f32 v232, v236, v237
v_cvt_pk_bf16_f32 v233, v238, v239
s_add_u32 m0, s13, 90112
s_add_u32 s3, s3, 73728
buffer_load_dwordx4 v7, s[52:55], s3 offen lds
v_cvt_pk_bf16_f32 v234, v240, v241
v_cvt_pk_bf16_f32 v235, v242, v243
s_nop 0
v_permlane32_swap_b32 v228, v230
v_permlane32_swap_b32 v229, v231
v_permlane32_swap_b32 v232, v234
buffer_load_dwordx4 v8, s[52:55], s3 offen offset:1024 lds
v_permlane32_swap_b32 v233, v235
s_barrier
s_add_u32 m0, s13, 98304
s_add_u32 s3, s3, 73728
buffer_load_dwordx4 v7, s[52:55], s3 offen lds
buffer_load_dwordx4 v8, s[52:55], s3 offen offset:1024 lds
s_add_u32 m0, s13, 106496
s_add_u32 s3, s3, 73728
buffer_load_dwordx4 v7, s[52:55], s3 offen lds
buffer_load_dwordx4 v8, s[52:55], s3 offen offset:1024 lds
s_barrier
s_add_u32 m0, s13, 114688
s_add_u32 s3, s3, 73728
buffer_load_dwordx4 v7, s[52:55], s3 offen lds
buffer_load_dwordx4 v8, s[52:55], s3 offen offset:1024 lds
s_add_u32 m0, s13, 122880
s_add_u32 s3, s12, s78
buffer_load_dwordx4 v7, s[48:51], s3 offen lds
buffer_load_dwordx4 v8, s[48:51], s3 offen offset:1024 lds
s_waitcnt vmcnt(12)
s_mov_b64 exec, 1
buffer_store_dword v196, v198, s[56:59], s92 offen offset:1024 sc1
s_mov_b64 exec, -1
s_lshl_b32 s84, s10, 6
s_add_u32 s84, s84, s86
buffer_store_dwordx4 v[228:231], v9, s[56:59], s84 offen sc1
buffer_store_dwordx4 v[232:235], v9, s[56:59], s84 offen offset:1024 sc1
s_barrier
s_barrier
ds_read_b64_tr_b16 v[212:213], v5 offset:49152
ds_read_b64_tr_b16 v[214:215], v5 offset:50176
ds_read_b64_tr_b16 v[216:217], v5 offset:51200
ds_read_b64_tr_b16 v[218:219], v5 offset:52224
ds_read_b64_tr_b16 v[220:221], v5 offset:53248
ds_read_b64_tr_b16 v[222:223], v5 offset:54272
s_waitcnt vmcnt(3)
s_barrier
s_waitcnt lgkmcnt(4)
v_mfma_f32_32x32x16_bf16 v[228:243], v[212:215], v[16:19], 0
ds_read_b64_tr_b16 v[224:225], v5 offset:55296
ds_read_b64_tr_b16 v[226:227], v5 offset:56320
s_waitcnt lgkmcnt(4)
v_mfma_f32_32x32x16_bf16 v[228:243], v[216:219], v[20:23], v[228:243]
s_lshl_b32 s82, s12, 3
v_add_u32 v254, s82, v13
ds_read_b64_tr_b16 v[212:213], v5 offset:57344
ds_read_b64_tr_b16 v[214:215], v5 offset:58368
s_waitcnt lgkmcnt(4)
v_mfma_f32_32x32x16_bf16 v[228:243], v[220:223], v[24:27], v[228:243]
ds_read_b64_tr_b16 v[216:217], v5 offset:59392
ds_read_b64_tr_b16 v[218:219], v5 offset:60416
s_waitcnt lgkmcnt(4)
v_mfma_f32_32x32x16_bf16 v[228:243], v[224:227], v[28:31], v[228:243]
ds_read_b64_tr_b16 v[220:221], v5 offset:61440
ds_read_b64_tr_b16 v[222:223], v5 offset:62464
s_waitcnt lgkmcnt(4)
v_mfma_f32_32x32x16_bf16 v[228:243], v[212:215], v[32:35], v[228:243]
ds_read_b64_tr_b16 v[224:225], v5 offset:63488
ds_read_b64_tr_b16 v[226:227], v5 offset:64512
s_waitcnt lgkmcnt(4)
v_mfma_f32_32x32x16_bf16 v[228:243], v[216:219], v[36:39], v[228:243]
ds_read_b64_tr_b16 v[212:213], v6 offset:0
ds_read_b64_tr_b16 v[214:215], v6 offset:1024
s_waitcnt lgkmcnt(4)
v_mfma_f32_32x32x16_bf16 v[228:243], v[220:223], v[40:43], v[228:243]
ds_read_b64_tr_b16 v[216:217], v6 offset:2048
ds_read_b64_tr_b16 v[218:219], v6 offset:3072
s_waitcnt lgkmcnt(4)
v_mfma_f32_32x32x16_bf16 v[228:243], v[224:227], v[44:47], v[228:243]
ds_read_b64_tr_b16 v[220:221], v6 offset:4096
ds_read_b64_tr_b16 v[222:223], v6 offset:5120
s_waitcnt lgkmcnt(4)
v_mfma_f32_32x32x16_bf16 v[228:243], v[212:215], v[48:51], v[228:243]
ds_read_b64_tr_b16 v[224:225], v6 offset:6144
ds_read_b64_tr_b16 v[226:227], v6 offset:7168
s_waitcnt lgkmcnt(4)
v_mfma_f32_32x32x16_bf16 v[228:243], v[216:219], v[52:55], v[228:243]
ds_read_b64_tr_b16 v[212:213], v6 offset:8192
ds_read_b64_tr_b16 v[214:215], v6 offset:9216
s_waitcnt lgkmcnt(4)
v_mfma_f32_32x32x16_bf16 v[228:243], v[220:223], v[56:59], v[228:243]
ds_read_b64_tr_b16 v[216:217], v6 offset:10240
ds_read_b64_tr_b16 v[218:219], v6 offset:11264
s_waitcnt lgkmcnt(4)
v_mfma_f32_32x32x16_bf16 v[228:243], v[224:227], v[60:63], v[228:243]
ds_read_b64_tr_b16 v[220:221], v6 offset:12288
ds_read_b64_tr_b16 v[222:223], v6 offset:13312
s_waitcnt lgkmcnt(4)
v_mfma_f32_32x32x16_bf16 v[228:243], v[212:215], v[64:67], v[228:243]
ds_read_b64_tr_b16 v[224:225], v6 offset:14336
ds_read_b64_tr_b16 v[226:227], v6 offset:15360
s_waitcnt lgkmcnt(4)
v_mfma_f32_32x32x16_bf16 v[228:243], v[216:219], v[68:71], v[228:243]
ds_read_b64_tr_b16 v[212:213], v6 offset:16384
ds_read_b64_tr_b16 v[214:215], v6 offset:17408
s_waitcnt lgkmcnt(4)
v_mfma_f32_32x32x16_bf16 v[228:243], v[220:223], v[72:75], v[228:243]
ds_read_b64_tr_b16 v[216:217], v6 offset:18432
ds_read_b64_tr_b16 v[218:219], v6 offset:19456
s_waitcnt lgkmcnt(4)
v_mfma_f32_32x32x16_bf16 v[228:243], v[224:227], v[76:79], v[228:243]
ds_read_b64_tr_b16 v[220:221], v6 offset:20480
ds_read_b64_tr_b16 v[222:223], v6 offset:21504
s_waitcnt lgkmcnt(4)
v_mfma_f32_32x32x16_bf16 v[228:243], v[212:215], v[80:83], v[228:243]
ds_read_b64_tr_b16 v[224:225], v6 offset:22528
ds_read_b64_tr_b16 v[226:227], v6 offset:23552
s_waitcnt lgkmcnt(4)
v_mfma_f32_32x32x16_bf16 v[228:243], v[216:219], v[84:87], v[228:243]
ds_read_b64_tr_b16 v[212:213], v6 offset:24576
ds_read_b64_tr_b16 v[214:215], v6 offset:25600
s_waitcnt lgkmcnt(4)
v_mfma_f32_32x32x16_bf16 v[228:243], v[220:223], v[88:91], v[228:243]
ds_read_b64_tr_b16 v[216:217], v6 offset:26624
ds_read_b64_tr_b16 v[218:219], v6 offset:27648
s_waitcnt lgkmcnt(4)
v_mfma_f32_32x32x16_bf16 v[228:243], v[224:227], v[92:95], v[228:243]
ds_read_b64_tr_b16 v[220:221], v6 offset:28672
ds_read_b64_tr_b16 v[222:223], v6 offset:29696
s_waitcnt lgkmcnt(4)
v_mfma_f32_32x32x16_bf16 v[228:243], v[212:215], v[96:99], v[228:243]
s_waitcnt vmcnt(0)
s_mov_b64 exec, 1
buffer_store_dword v196, v198, s[56:59], s92 offen offset:1536 sc1
s_mov_b64 exec, -1
ds_read_b64_tr_b16 v[224:225], v6 offset:30720
ds_read_b64_tr_b16 v[226:227], v6 offset:31744
s_waitcnt lgkmcnt(4)
v_mfma_f32_32x32x16_bf16 v[228:243], v[216:219], v[100:103], v[228:243]
ds_read_b64_tr_b16 v[212:213], v6 offset:32768
ds_read_b64_tr_b16 v[214:215], v6 offset:33792
s_waitcnt lgkmcnt(4)
v_mfma_f32_32x32x16_bf16 v[228:243], v[220:223], v[104:107], v[228:243]
ds_read_b64_tr_b16 v[216:217], v6 offset:34816
ds_read_b64_tr_b16 v[218:219], v6 offset:35840
s_waitcnt lgkmcnt(4)
v_mfma_f32_32x32x16_bf16 v[228:243], v[224:227], v[108:111], v[228:243]
ds_read_b64_tr_b16 v[220:221], v6 offset:36864
ds_read_b64_tr_b16 v[222:223], v6 offset:37888
s_waitcnt lgkmcnt(4)
v_mfma_f32_32x32x16_bf16 v[228:243], v[212:215], v[112:115], v[228:243]
ds_read_b64_tr_b16 v[224:225], v6 offset:38912
ds_read_b64_tr_b16 v[226:227], v6 offset:39936
s_waitcnt lgkmcnt(4)
v_mfma_f32_32x32x16_bf16 v[228:243], v[216:219], v[116:119], v[228:243]
ds_read_b64_tr_b16 v[212:213], v6 offset:40960
ds_read_b64_tr_b16 v[214:215], v6 offset:41984
s_waitcnt lgkmcnt(4)
v_mfma_f32_32x32x16_bf16 v[228:243], v[220:223], v[120:123], v[228:243]
ds_read_b64_tr_b16 v[216:217], v6 offset:43008
ds_read_b64_tr_b16 v[218:219], v6 offset:44032
s_waitcnt lgkmcnt(4)
v_mfma_f32_32x32x16_bf16 v[228:243], v[224:227], v[124:127], v[228:243]
ds_read_b64_tr_b16 v[220:221], v6 offset:45056
ds_read_b64_tr_b16 v[222:223], v6 offset:46080
s_waitcnt lgkmcnt(4)
v_mfma_f32_32x32x16_bf16 v[228:243], v[212:215], v[128:131], v[228:243]
ds_read_b64_tr_b16 v[224:225], v6 offset:47104
ds_read_b64_tr_b16 v[226:227], v6 offset:48128
s_waitcnt lgkmcnt(4)
v_mfma_f32_32x32x16_bf16 v[228:243], v[216:219], v[132:135], v[228:243]
ds_read_b64_tr_b16 v[212:213], v6 offset:49152
ds_read_b64_tr_b16 v[214:215], v6 offset:50176
s_waitcnt lgkmcnt(4)
v_mfma_f32_32x32x16_bf16 v[228:243], v[220:223], v[136:139], v[228:243]
ds_read_b64_tr_b16 v[216:217], v6 offset:51200
ds_read_b64_tr_b16 v[218:219], v6 offset:52224
s_waitcnt lgkmcnt(4)
v_mfma_f32_32x32x16_bf16 v[228:243], v[224:227], v[140:143], v[228:243]
ds_read_b64_tr_b16 v[220:221], v6 offset:53248
ds_read_b64_tr_b16 v[222:223], v6 offset:54272
s_waitcnt lgkmcnt(4)
v_mfma_f32_32x32x16_bf16 v[228:243], v[212:215], v[144:147], v[228:243]
ds_read_b64_tr_b16 v[224:225], v6 offset:55296
ds_read_b64_tr_b16 v[226:227], v6 offset:56320
s_waitcnt lgkmcnt(4)
v_mfma_f32_32x32x16_bf16 v[228:243], v[216:219], v[148:151], v[228:243]
ds_read_b64_tr_b16 v[212:213], v6 offset:57344
ds_read_b64_tr_b16 v[214:215], v6 offset:58368
s_waitcnt lgkmcnt(4)
v_mfma_f32_32x32x16_bf16 v[228:243], v[220:223], v[152:155], v[228:243]
ds_read_b64_tr_b16 v[216:217], v6 offset:59392
ds_read_b64_tr_b16 v[218:219], v6 offset:60416
s_waitcnt lgkmcnt(4)
v_mfma_f32_32x32x16_bf16 v[228:243], v[224:227], v[156:159], v[228:243]
ds_read_b64_tr_b16 v[244:245], v254 offset:0
ds_read_b64_tr_b16 v[246:247], v254 offset:256
ds_read_b64_tr_b16 v[220:221], v6 offset:61440
ds_read_b64_tr_b16 v[222:223], v6 offset:62464
s_waitcnt lgkmcnt(6)
v_mfma_f32_32x32x16_bf16 v[228:243], v[212:215], v[160:163], v[228:243]
ds_read_b64_tr_b16 v[224:225], v6 offset:63488
ds_read_b64_tr_b16 v[226:227], v6 offset:64512
s_waitcnt lgkmcnt(6)
v_mfma_f32_32x32x16_bf16 v[228:243], v[216:219], v[164:167], v[228:243]
s_waitcnt lgkmcnt(2)
v_mfma_f32_32x32x16_bf16 v[228:243], v[220:223], v[168:171], v[228:243]
s_waitcnt lgkmcnt(0)
v_mfma_f32_32x32x16_bf16 v[228:243], v[224:227], v[172:175], v[228:243]
v_mfma_f32_32x32x16_bf16 v[228:243], v[244:247], v[176:179], v[228:243]
s_nop 7
s_nop 3
v_cvt_pk_bf16_f32 v228, v228, v229
v_cvt_pk_bf16_f32 v229, v230, v231
v_cvt_pk_bf16_f32 v230, v232, v233
v_cvt_pk_bf16_f32 v231, v234, v235
v_cvt_pk_bf16_f32 v232, v236, v237
v_cvt_pk_bf16_f32 v233, v238, v239
v_cvt_pk_bf16_f32 v234, v240, v241
v_cvt_pk_bf16_f32 v235, v242, v243
s_nop 0
v_permlane32_swap_b32 v228, v230
v_permlane32_swap_b32 v229, v231
v_permlane32_swap_b32 v232, v234
v_permlane32_swap_b32 v233, v235
s_lshl_b32 s84, s12, 6
s_add_u32 s84, s84, s86
buffer_store_dwordx4 v[228:231], v9, s[56:59], s84 offen sc1
buffer_store_dwordx4 v[232:235], v9, s[56:59], s84 offen offset:1024 sc1
s_cmp_eq_u32 s69, 0
s_cbranch_scc1 L_f2_r8
s_waitcnt vmcnt(0)
s_mov_b64 exec, 1
buffer_store_dword v196, v198, s[56:59], s92 offen offset:2048 sc1
s_mov_b64 exec, -1
s_branch L_f2_done
L_f2_r8:
s_mov_b32 s82, 8
s_lshl_b32 s79, s82, 8
s_add_u32 s79, s79, s20
s_lshr_b32 s81, s4, 7
s_add_u32 s82, s82, s81
s_sub_u32 s81, s82, 9
s_cmp_ge_u32 s82, 9
s_cselect_b32 s82, s81, s82
s_lshl_b32 s82, s82, 3
s_add_u32 s82, s82, s71
buffer_load_dword v200, v199, s[56:59], s79 offen sc1
s_bfe_u32 s73, s82, 0x10001
s_lshl_b32 s80, s72, 1
s_add_u32 s73, s73, s80
s_mul_i32 s73, s73, 36864
s_lshr_b32 s74, s82, 2
s_lshl_b32 s74, s74, 6
s_and_b32 s80, s82, 1
s_lshl_b32 s80, s80, 5
s_add_u32 s74, s74, s80
s_add_u32 s73, s73, s74
s_mul_i32 s80, s72, 73728
s_lshl_b32 s75, s82, 10
s_add_u32 s75, s75, s80
s_add_u32 s75, s75, 16777216
v_mul_u32_u24 v24, 1152, v2
v_lshl_add_u32 v24, v3, 4, v24
v_lshlrev_b32 v25, 4, v3
buffer_load_dwordx4 v[16:19], v24, s[28:31], s73 offen
buffer_load_dwordx4 v[20:23], v25, s[16:19], s74 offen
s_waitcnt vmcnt(2)
s_mov_b64 exec, 1
buffer_store_dword v196, v198, s[56:59], s92 offen offset:2048 sc1
s_mov_b64 exec, -1
s_mov_b32 s85, 0
L_p4:
v_cmp_eq_u32 s[26:27], v200, v196
s_nop 1
s_cmp_eq_u64 s[26:27], -1
s_cbranch_scc1 L_pd4
s_sleep 1
buffer_load_dword v200, v199, s[56:59], s79 offen sc1
s_waitcnt vmcnt(0)
s_add_u32 s85, s85, 1
s_cmp_lt_u32 s85, 0x100000
s_cbranch_scc1 L_p4
L_pd4:
buffer_load_dwordx4 v[32:35], v9, s[56:59], s75 offen sc1
s_add_u32 s75, s75, 2359296
buffer_load_dwordx4 v[36:39], v9, s[56:59], s75 offen sc1
s_add_u32 s75, s75, 2359296
buffer_load_dwordx4 v[40:43], v9, s[56:59], s75 offen sc1
s_add_u32 s75, s75, 2359296
buffer_load_dwordx4 v[44:47], v9, s[56:59], s75 offen sc1
s_add_u32 s75, s75, 2359296
buffer_load_dwordx4 v[48:51], v9, s[56:59], s75 offen sc1
s_add_u32 s75, s75, 2359296
buffer_load_dwordx4 v[52:55], v9, s[56:59], s75 offen sc1
s_add_u32 s75, s75, 2359296
buffer_load_dwordx4 v[56:59], v9, s[56:59], s75 offen sc1
s_add_u32 s75, s75, 2359296
buffer_load_dwordx4 v[60:63], v9, s[56:59], s75 offen sc1
s_waitcnt vmcnt(8)
v_lshlrev_b32 v64, 16, v16
v_and_b32 v65, 0xffff0000, v16
v_lshlrev_b32 v66, 16, v17
v_and_b32 v67, 0xffff0000, v17
v_lshlrev_b32 v68, 16, v18
v_and_b32 v69, 0xffff0000, v18
v_lshlrev_b32 v70, 16, v19
v_and_b32 v71, 0xffff0000, v19
v_lshlrev_b32 v248, 16, v20
v_and_b32 v249, 0xffff0000, v20
v_add_f32 v64, v64, v248
v_add_f32 v65, v65, v249
v_lshlrev_b32 v250, 16, v21
v_and_b32 v251, 0xffff0000, v21
v_add_f32 v66, v66, v250
v_add_f32 v67, v67, v251
v_lshlrev_b32 v248, 16, v22
v_and_b32 v249, 0xffff0000, v22
v_add_f32 v68, v68, v248
v_add_f32 v69, v69, v249
v_lshlrev_b32 v250, 16, v23
v_and_b32 v251, 0xffff0000, v23
v_add_f32 v70, v70, v250
v_add_f32 v71, v71, v251
s_waitcnt vmcnt(7)
v_lshlrev_b32 v248, 16, v32
v_and_b32 v249, 0xffff0000, v32
v_add_f32 v64, v64, v248
v_add_f32 v65, v65, v249
v_lshlrev_b32 v250, 16, v33
v_and_b32 v251, 0xffff0000, v33
v_add_f32 v66, v66, v250
v_add_f32 v67, v67, v251
v_lshlrev_b32 v248, 16, v34
v_and_b32 v249, 0xffff0000, v34
v_add_f32 v68, v68, v248
v_add_f32 v69, v69, v249
v_lshlrev_b32 v250, 16, v35
v_and_b32 v251, 0xffff0000, v35
v_add_f32 v70, v70, v250
v_add_f32 v71, v71, v251
s_waitcnt vmcnt(6)
v_lshlrev_b32 v248, 16, v36
v_and_b32 v249, 0xffff0000, v36
v_add_f32 v64, v64, v248
v_add_f32 v65, v65, v249
v_lshlrev_b32 v250, 16, v37
v_and_b32 v251, 0xffff0000, v37
v_add_f32 v66, v66, v250
v_add_f32 v67, v67, v251
v_lshlrev_b32 v248, 16, v38
v_and_b32 v249, 0xffff0000, v38
v_add_f32 v68, v68, v248
v_add_f32 v69, v69, v249
v_lshlrev_b32 v250, 16, v39
v_and_b32 v251, 0xffff0000, v39
v_add_f32 v70, v70, v250
v_add_f32 v71, v71, v251
s_waitcnt vmcnt(5)
v_lshlrev_b32 v248, 16, v40
v_and_b32 v249, 0xffff0000, v40
v_add_f32 v64, v64, v248
v_add_f32 v65, v65, v249
v_lshlrev_b32 v250, 16, v41
v_and_b32 v251, 0xffff0000, v41
v_add_f32 v66, v66, v250
v_add_f32 v67, v67, v251
v_lshlrev_b32 v248, 16, v42
v_and_b32 v249, 0xffff0000, v42
v_add_f32 v68, v68, v248
v_add_f32 v69, v69, v249
v_lshlrev_b32 v250, 16, v43
v_and_b32 v251, 0xffff0000, v43
v_add_f32 v70, v70, v250
v_add_f32 v71, v71, v251
s_waitcnt vmcnt(4)
v_lshlrev_b32 v248, 16, v44
v_and_b32 v249, 0xffff0000, v44
v_add_f32 v64, v64, v248
v_add_f32 v65, v65, v249
v_lshlrev_b32 v250, 16, v45
v_and_b32 v251, 0xffff0000, v45
v_add_f32 v66, v66, v250
v_add_f32 v67, v67, v251
v_lshlrev_b32 v248, 16, v46
v_and_b32 v249, 0xffff0000, v46
v_add_f32 v68, v68, v248
v_add_f32 v69, v69, v249
v_lshlrev_b32 v250, 16, v47
v_and_b32 v251, 0xffff0000, v47
v_add_f32 v70, v70, v250
v_add_f32 v71, v71, v251
s_waitcnt vmcnt(3)
v_lshlrev_b32 v248, 16, v48
v_and_b32 v249, 0xffff0000, v48
v_add_f32 v64, v64, v248
v_add_f32 v65, v65, v249
v_lshlrev_b32 v250, 16, v49
v_and_b32 v251, 0xffff0000, v49
v_add_f32 v66, v66, v250
v_add_f32 v67, v67, v251
v_lshlrev_b32 v248, 16, v50
v_and_b32 v249, 0xffff0000, v50
v_add_f32 v68, v68, v248
v_add_f32 v69, v69, v249
v_lshlrev_b32 v250, 16, v51
v_and_b32 v251, 0xffff0000, v51
v_add_f32 v70, v70, v250
v_add_f32 v71, v71, v251
s_waitcnt vmcnt(2)
v_lshlrev_b32 v248, 16, v52
v_and_b32 v249, 0xffff0000, v52
v_add_f32 v64, v64, v248
v_add_f32 v65, v65, v249
v_lshlrev_b32 v250, 16, v53
v_and_b32 v251, 0xffff0000, v53
v_add_f32 v66, v66, v250
v_add_f32 v67, v67, v251
v_lshlrev_b32 v248, 16, v54
v_and_b32 v249, 0xffff0000, v54
v_add_f32 v68, v68, v248
v_add_f32 v69, v69, v249
v_lshlrev_b32 v250, 16, v55
v_and_b32 v251, 0xffff0000, v55
v_add_f32 v70, v70, v250
v_add_f32 v71, v71, v251
s_waitcnt vmcnt(1)
v_lshlrev_b32 v248, 16, v56
v_and_b32 v249, 0xffff0000, v56
v_add_f32 v64, v64, v248
v_add_f32 v65, v65, v249
v_lshlrev_b32 v250, 16, v57
v_and_b32 v251, 0xffff0000, v57
v_add_f32 v66, v66, v250
v_add_f32 v67, v67, v251
v_lshlrev_b32 v248, 16, v58
v_and_b32 v249, 0xffff0000, v58
v_add_f32 v68, v68, v248
v_add_f32 v69, v69, v249
v_lshlrev_b32 v250, 16, v59
v_and_b32 v251, 0xffff0000, v59
v_add_f32 v70, v70, v250
v_add_f32 v71, v71, v251
s_waitcnt vmcnt(0)
v_lshlrev_b32 v248, 16, v60
v_and_b32 v249, 0xffff0000, v60
v_add_f32 v64, v64, v248
v_add_f32 v65, v65, v249
v_lshlrev_b32 v250, 16, v61
v_and_b32 v251, 0xffff0000, v61
v_add_f32 v66, v66, v250
v_add_f32 v67, v67, v251
v_lshlrev_b32 v248, 16, v62
v_and_b32 v249, 0xffff0000, v62
v_add_f32 v68, v68, v248
v_add_f32 v69, v69, v249
v_lshlrev_b32 v250, 16, v63
v_and_b32 v251, 0xffff0000, v63
v_add_f32 v70, v70, v250
v_add_f32 v71, v71, v251
v_cvt_pk_bf16_f32 v16, v64, v65
v_cvt_pk_bf16_f32 v17, v66, v67
v_cvt_pk_bf16_f32 v18, v68, v69
v_cvt_pk_bf16_f32 v19, v70, v71
buffer_store_dwordx4 v[16:19], v24, s[64:67], s73 offen
s_nop 1
s_branch L_f2_done
L_f2_B:
ds_read_b128 v[16:19], v12 offset:0
ds_read_b128 v[20:23], v12 offset:1024
ds_read_b128 v[24:27], v12 offset:2048
ds_read_b128 v[28:31], v12 offset:3072
s_waitcnt vmcnt(6)
s_barrier
s_waitcnt vmcnt(4)
s_barrier
s_add_u32 m0, s13, 0
s_add_u32 s3, s5, s76
buffer_load_dwordx4 v7, s[52:55], s3 offen lds
buffer_load_dwordx4 v8, s[52:55], s3 offen offset:1024 lds
s_add_u32 m0, s13, 8192
s_add_u32 s3, s3, 73728
buffer_load_dwordx4 v7, s[52:55], s3 offen lds
ds_read_b128 v[32:35], v12 offset:4096
ds_read_b128 v[36:39], v12 offset:5120
ds_read_b128 v[40:43], v12 offset:6144
ds_read_b128 v[44:47], v12 offset:7168
buffer_load_dwordx4 v8, s[52:55], s3 offen offset:1024 lds
ds_read_b128 v[48:51], v12 offset:8192
ds_read_b128 v[52:55], v12 offset:9216
ds_read_b128 v[56:59], v12 offset:10240
ds_read_b128 v[60:63], v12 offset:11264
s_waitcnt vmcnt(6)
s_barrier
s_add_u32 m0, s13, 16384
s_add_u32 s3, s3, 73728
buffer_load_dwordx4 v7, s[52:55], s3 offen lds
ds_read_b128 v[64:67], v12 offset:12288
ds_read_b128 v[68:71], v12 offset:13312
ds_read_b128 v[72:75], v12 offset:14336
ds_read_b128 v[76:79], v12 offset:15360
buffer_load_dwordx4 v8, s[52:55], s3 offen offset:1024 lds
ds_read_b128 v[80:83], v12 offset:16384
ds_read_b128 v[84:87], v12 offset:17408
ds_read_b128 v[88:91], v12 offset:18432
ds_read_b128 v[92:95], v12 offset:19456
s_add_u32 m0, s13, 24576
s_add_u32 s3, s3, 73728
buffer_load_dwordx4 v7, s[52:55], s3 offen lds
ds_read_b128 v[96:99], v12 offset:20480
ds_read_b128 v[100:103], v12 offset:21504
ds_read_b128 v[104:107], v12 offset:22528
ds_read_b128 v[108:111], v12 offset:23552
buffer_load_dwordx4 v8, s[52:55], s3 offen offset:1024 lds
ds_read_b128 v[112:115], v12 offset:24576
ds_read_b128 v[116:119], v12 offset:25600
ds_read_b128 v[120:123], v12 offset:26624
ds_read_b128 v[124:127], v12 offset:27648
s_waitcnt vmcnt(8)
s_barrier
s_add_u32 m0, s13, 32768
s_add_u32 s3, s3, 73728
buffer_load_dwordx4 v7, s[52:55], s3 offen lds
ds_read_b128 v[128:131], v12 offset:28672
ds_read_b128 v[132:135], v12 offset:29696
ds_read_b128 v[136:139], v12 offset:30720
ds_read_b128 v[140:143], v12 offset:31744
buffer_load_dwordx4 v8, s[52:55], s3 offen offset:1024 lds
ds_read_b128 v[144:147], v12 offset:32768
ds_read_b128 v[148:151], v12 offset:33792
ds_read_b128 v[152:155], v12 offset:34816
ds_read_b128 v[156:159], v12 offset:35840
s_add_u32 m0, s13, 40960
s_add_u32 s3, s3, 73728
buffer_load_dwordx4 v7, s[52:55], s3 offen lds
ds_read_b128 v[160:163], v14 offset:0
ds_read_b128 v[164:167], v14 offset:1024
ds_read_b128 v[168:171], v14 offset:2048
ds_read_b128 v[172:175], v14 offset:3072
buffer_load_dwordx4 v8, s[52:55], s3 offen offset:1024 lds
s_waitcnt vmcnt(8)
s_barrier
s_add_u32 m0, s13, 49152
s_add_u32 s3, s3, 73728
buffer_load_dwordx4 v7, s[52:55], s3 offen lds
buffer_load_dwordx4 v8, s[52:55], s3 offen offset:1024 lds
ds_read_b64_tr_b16 v[212:213], v5 offset:0
ds_read_b64_tr_b16 v[214:215], v5 offset:1024
ds_read_b64_tr_b16 v[216:217], v5 offset:2048
ds_read_b64_tr_b16 v[218:219], v5 offset:3072
ds_read_b64_tr_b16 v[220:221], v5 offset:4096
ds_read_b64_tr_b16 v[222:223], v5 offset:5120
s_add_u32 m0, s13, 57344
s_add_u32 s3, s3, 73728
buffer_load_dwordx4 v7, s[52:55], s3 offen lds
buffer_load_dwordx4 v8, s[52:55], s3 offen offset:1024 lds
s_waitcnt lgkmcnt(6)
s_waitcnt vmcnt(8) lgkmcnt(4)
s_barrier
s_lshl_b32 s82, s70, 10
s_lshl_b32 s83, s69, 2
s_add_u32 s82, s82, 140288
v_add_u32 v14, s82, v9
v_add_u32 v15, s83, v14
ds_write_b32 v15, v201
v_mfma_f32_32x32x16_bf16 v[228:243], v[212:215], v[16:19], 0
ds_read_b64_tr_b16 v[224:225], v5 offset:6144
ds_read_b64_tr_b16 v[226:227], v5 offset:7168
s_waitcnt lgkmcnt(5)
v_mfma_f32_32x32x16_bf16 v[228:243], v[216:219], v[20:23], v[228:243]
s_lshl_b32 s82, s5, 3
v_add_u32 v254, s82, v13
ds_read_b64_tr_b16 v[212:213], v5 offset:8192
ds_read_b64_tr_b16 v[214:215], v5 offset:9216
s_waitcnt lgkmcnt(5)
v_mfma_f32_32x32x16_bf16 v[228:243], v[220:223], v[24:27], v[228:243]
ds_read_b64_tr_b16 v[216:217], v5 offset:10240
ds_read_b64_tr_b16 v[218:219], v5 offset:11264
s_waitcnt lgkmcnt(4)
v_mfma_f32_32x32x16_bf16 v[228:243], v[224:227], v[28:31], v[228:243]
ds_read_b64_tr_b16 v[220:221], v5 offset:12288
ds_read_b64_tr_b16 v[222:223], v5 offset:13312
s_waitcnt lgkmcnt(4)
v_mfma_f32_32x32x16_bf16 v[228:243], v[212:215], v[32:35], v[228:243]
ds_read_b64_tr_b16 v[224:225], v5 offset:14336
ds_read_b64_tr_b16 v[226:227], v5 offset:15360
s_waitcnt lgkmcnt(4)
v_mfma_f32_32x32x16_bf16 v[228:243], v[216:219], v[36:39], v[228:243]
ds_read_b64_tr_b16 v[212:213], v5 offset:16384
ds_read_b64_tr_b16 v[214:215], v5 offset:17408
s_waitcnt lgkmcnt(4)
v_mfma_f32_32x32x16_bf16 v[228:243], v[220:223], v[40:43], v[228:243]
ds_read_b64_tr_b16 v[216:217], v5 offset:18432
ds_read_b64_tr_b16 v[218:219], v5 offset:19456
s_waitcnt lgkmcnt(4)
v_mfma_f32_32x32x16_bf16 v[228:243], v[224:227], v[44:47], v[228:243]
ds_read_b64_tr_b16 v[220:221], v5 offset:20480
ds_read_b64_tr_b16 v[222:223], v5 offset:21504
s_waitcnt vmcnt(4) lgkmcnt(4)
s_barrier
ds_read_b128 v[176:179], v14
v_mfma_f32_32x32x16_bf16 v[228:243], v[212:215], v[48:51], v[228:243]
ds_read_b64_tr_b16 v[224:225], v5 offset:22528
ds_read_b64_tr_b16 v[226:227], v5 offset:23552
s_waitcnt lgkmcnt(5)
v_mfma_f32_32x32x16_bf16 v[228:243], v[216:219], v[52:55], v[228:243]
ds_read_b64_tr_b16 v[212:213], v5 offset:24576
ds_read_b64_tr_b16 v[214:215], v5 offset:25600
s_waitcnt lgkmcnt(5)
v_mfma_f32_32x32x16_bf16 v[228:243], v[220:223], v[56:59], v[228:243]
ds_read_b64_tr_b16 v[216:217], v5 offset:26624
ds_read_b64_tr_b16 v[218:219], v5 offset:27648
s_waitcnt lgkmcnt(4)
v_mfma_f32_32x32x16_bf16 v[228:243], v[224:227], v[60:63], v[228:243]
ds_read_b64_tr_b16 v[220:221], v5 offset:28672
ds_read_b64_tr_b16 v[222:223], v5 offset:29696
s_waitcnt lgkmcnt(4)
v_mfma_f32_32x32x16_bf16 v[228:243], v[212:215], v[64:67], v[228:243]
ds_read_b64_tr_b16 v[224:225], v5 offset:30720
ds_read_b64_tr_b16 v[226:227], v5 offset:31744
s_waitcnt lgkmcnt(4)
v_mfma_f32_32x32x16_bf16 v[228:243], v[216:219], v[68:71], v[228:243]
ds_read_b64_tr_b16 v[212:213], v5 offset:32768
ds_read_b64_tr_b16 v[214:215], v5 offset:33792
s_waitcnt lgkmcnt(4)
v_mfma_f32_32x32x16_bf16 v[228:243], v[220:223], v[72:75], v[228:243]
ds_read_b64_tr_b16 v[216:217], v5 offset:34816
ds_read_b64_tr_b16 v[218:219], v5 offset:35840
s_waitcnt lgkmcnt(4)
v_mfma_f32_32x32x16_bf16 v[228:243], v[224:227], v[76:79], v[228:243]
ds_read_b64_tr_b16 v[220:221], v5 offset:36864
ds_read_b64_tr_b16 v[222:223], v5 offset:37888
s_waitcnt vmcnt(0) lgkmcnt(4)
s_barrier
v_mfma_f32_32x32x16_bf16 v[228:243], v[212:215], v[80:83], v[228:243]
ds_read_b64_tr_b16 v[224:225], v5 offset:38912
ds_read_b64_tr_b16 v[226:227], v5 offset:39936
s_waitcnt lgkmcnt(4)
v_mfma_f32_32x32x16_bf16 v[228:243], v[216:219], v[84:87], v[228:243]
ds_read_b64_tr_b16 v[212:213], v5 offset:40960
ds_read_b64_tr_b16 v[214:215], v5 offset:41984
s_waitcnt lgkmcnt(4)
v_mfma_f32_32x32x16_bf16 v[228:243], v[220:223], v[88:91], v[228:243]
ds_read_b64_tr_b16 v[216:217], v5 offset:43008
ds_read_b64_tr_b16 v[218:219], v5 offset:44032
s_waitcnt lgkmcnt(4)
v_mfma_f32_32x32x16_bf16 v[228:243], v[224:227], v[92:95], v[228:243]
ds_read_b64_tr_b16 v[220:221], v5 offset:45056
ds_read_b64_tr_b16 v[222:223], v5 offset:46080
s_waitcnt lgkmcnt(4)
v_mfma_f32_32x32x16_bf16 v[228:243], v[212:215], v[96:99], v[228:243]
ds_read_b64_tr_b16 v[224:225], v5 offset:47104
ds_read_b64_tr_b16 v[226:227], v5 offset:48128
s_waitcnt lgkmcnt(4)
v_mfma_f32_32x32x16_bf16 v[228:243], v[216:219], v[100:103], v[228:243]
ds_read_b64_tr_b16 v[212:213], v5 offset:49152
ds_read_b64_tr_b16 v[214:215], v5 offset:50176
s_waitcnt lgkmcnt(4)
v_mfma_f32_32x32x16_bf16 v[228:243], v[220:223], v[104:107], v[228:243]
ds_read_b64_tr_b16 v[216:217], v5 offset:51200
ds_read_b64_tr_b16 v[218:219], v5 offset:52224
s_waitcnt lgkmcnt(4)
v_mfma_f32_32x32x16_bf16 v[228:243], v[224:227], v[108:111], v[228:243]
ds_read_b64_tr_b16 v[220:221], v5 offset:53248
ds_read_b64_tr_b16 v[222:223], v5 offset:54272
s_waitcnt lgkmcnt(4)
s_barrier
v_mfma_f32_32x32x16_bf16 v[228:243], v[212:215], v[112:115], v[228:243]
ds_read_b64_tr_b16 v[224:225], v5 offset:55296
ds_read_b64_tr_b16 v[226:227], v5 offset:56320
s_waitcnt lgkmcnt(4)
v_mfma_f32_32x32x16_bf16 v[228:243], v[216:219], v[116:119], v[228:243]
ds_read_b64_tr_b16 v[212:213], v5 offset:57344
ds_read_b64_tr_b16 v[214:215], v5 offset:58368
s_waitcnt lgkmcnt(4)
v_mfma_f32_32x32x16_bf16 v[228:243], v[220:223], v[120:123], v[228:243]
ds_read_b64_tr_b16 v[216:217], v5 offset:59392
ds_read_b64_tr_b16 v[218:219], v5 offset:60416
s_waitcnt lgkmcnt(4)
v_mfma_f32_32x32x16_bf16 v[228:243], v[224:227], v[124:127], v[228:243]
ds_read_b64_tr_b16 v[220:221], v5 offset:61440
ds_read_b64_tr_b16 v[222:223], v5 offset:62464
s_waitcnt lgkmcnt(4)
v_mfma_f32_32x32x16_bf16 v[228:243], v[212:215], v[128:131], v[228:243]
ds_read_b64_tr_b16 v[224:225], v5 offset:63488
ds_read_b64_tr_b16 v[226:227], v5 offset:64512
s_waitcnt lgkmcnt(4)
v_mfma_f32_32x32x16_bf16 v[228:243], v[216:219], v[132:135], v[228:243]
ds_read_b64_tr_b16 v[212:213], v6 offset:0
ds_read_b64_tr_b16 v[214:215], v6 offset:1024
s_waitcnt lgkmcnt(4)
v_mfma_f32_32x32x16_bf16 v[228:243], v[220:223], v[136:139], v[228:243]
ds_read_b64_tr_b16 v[216:217], v6 offset:2048
ds_read_b64_tr_b16 v[218:219], v6 offset:3072
s_waitcnt lgkmcnt(4)
v_mfma_f32_32x32x16_bf16 v[228:243], v[224:227], v[140:143], v[228:243]
ds_read_b64_tr_b16 v[220:221], v6 offset:4096
ds_read_b64_tr_b16 v[222:223], v6 offset:5120
s_waitcnt lgkmcnt(4)
s_barrier
v_mfma_f32_32x32x16_bf16 v[228:243], v[212:215], v[144:147], v[228:243]
ds_read_b64_tr_b16 v[224:225], v6 offset:6144
ds_read_b64_tr_b16 v[226:227], v6 offset:7168
s_waitcnt lgkmcnt(4)
v_mfma_f32_32x32x16_bf16 v[228:243], v[216:219], v[148:151], v[228:243]
ds_read_b64_tr_b16 v[212:213], v6 offset:8192
ds_read_b64_tr_b16 v[214:215], v6 offset:9216
s_waitcnt lgkmcnt(4)
v_mfma_f32_32x32x16_bf16 v[228:243], v[220:223], v[152:155], v[228:243]
ds_read_b64_tr_b16 v[216:217], v6 offset:10240
ds_read_b64_tr_b16 v[218:219], v6 offset:11264
s_waitcnt lgkmcnt(4)
v_mfma_f32_32x32x16_bf16 v[228:243], v[224:227], v[156:159], v[228:243]
ds_read_b64_tr_b16 v[244:245], v254 offset:0
ds_read_b64_tr_b16 v[246:247], v254 offset:256
ds_read_b64_tr_b16 v[220:221], v6 offset:12288
ds_read_b64_tr_b16 v[222:223], v6 offset:13312
s_waitcnt lgkmcnt(6)
v_mfma_f32_32x32x16_bf16 v[228:243], v[212:215], v[160:163], v[228:243]
ds_read_b64_tr_b16 v[224:225], v6 offset:14336
ds_read_b64_tr_b16 v[226:227], v6 offset:15360
s_waitcnt lgkmcnt(6)
v_mfma_f32_32x32x16_bf16 v[228:243], v[216:219], v[164:167], v[228:243]
s_waitcnt lgkmcnt(2)
v_mfma_f32_32x32x16_bf16 v[228:243], v[220:223], v[168:171], v[228:243]
s_waitcnt lgkmcnt(0)
v_mfma_f32_32x32x16_bf16 v[228:243], v[224:227], v[172:175], v[228:243]
v_mfma_f32_32x32x16_bf16 v[228:243], v[244:247], v[176:179], v[228:243]
s_barrier
s_add_u32 m0, s13, 65536
s_add_u32 s3, s7, s76
s_add_u32 s3, s3, 294912
buffer_load_dwordx4 v7, s[52:55], s3 offen lds
s_nop 7
s_nop 3
buffer_load_dwordx4 v8, s[52:55], s3 offen offset:1024 lds
v_cvt_pk_bf16_f32 v228, v228, v229
v_cvt_pk_bf16_f32 v229, v230, v231
v_cvt_pk_bf16_f32 v230, v232, v233
v_cvt_pk_bf16_f32 v231, v234, v235
v_cvt_pk_bf16_f32 v232, v236, v237
v_cvt_pk_bf16_f32 v233, v238, v239
s_add_u32 m0, s13, 73728
s_add_u32 s3, s3, 73728
buffer_load_dwordx4 v7, s[52:55], s3 offen lds
v_cvt_pk_bf16_f32 v234, v240, v241
v_cvt_pk_bf16_f32 v235, v242, v243
s_nop 0
v_permlane32_swap_b32 v228, v230
v_permlane32_swap_b32 v229, v231
v_permlane32_swap_b32 v232, v234
buffer_load_dwordx4 v8, s[52:55], s3 offen offset:1024 lds
v_permlane32_swap_b32 v233, v235
s_barrier
s_add_u32 m0, s13, 81920
s_add_u32 s3, s3, 73728
buffer_load_dwordx4 v7, s[52:55], s3 offen lds
buffer_load_dwordx4 v8, s[52:55], s3 offen offset:1024 lds
s_add_u32 m0, s13, 90112
s_add_u32 s3, s3, 73728
buffer_load_dwordx4 v7, s[52:55], s3 offen lds
buffer_load_dwordx4 v8, s[52:55], s3 offen offset:1024 lds
s_barrier
s_add_u32 m0, s13, 98304
s_add_u32 s3, s3, 73728
buffer_load_dwordx4 v7, s[52:55], s3 offen lds
buffer_load_dwordx4 v8, s[52:55], s3 offen offset:1024 lds
s_add_u32 m0, s13, 106496
s_add_u32 s3, s7, s78
buffer_load_dwordx4 v7, s[48:51], s3 offen lds
buffer_load_dwordx4 v8, s[48:51], s3 offen offset:1024 lds
s_barrier
s_add_u32 m0, s13, 114688
s_add_u32 s3, s8, s76
buffer_load_dwordx4 v7, s[52:55], s3 offen lds
buffer_load_dwordx4 v8, s[52:55], s3 offen offset:1024 lds
s_add_u32 m0, s13, 122880
s_add_u32 s3, s3, 73728
buffer_load_dwordx4 v7, s[52:55], s3 offen lds
buffer_load_dwordx4 v8, s[52:55], s3 offen offset:1024 lds
s_barrier
s_add_u32 m0, s13, 0
s_add_u32 s3, s3, 73728
buffer_load_dwordx4 v7, s[52:55], s3 offen lds
buffer_load_dwordx4 v8, s[52:55], s3 offen offset:1024 lds
ds_read_b64_tr_b16 v[212:213], v5 offset:32768
ds_read_b64_tr_b16 v[214:215], v5 offset:33792
ds_read_b64_tr_b16 v[216:217], v5 offset:34816
ds_read_b64_tr_b16 v[218:219], v5 offset:35840
ds_read_b64_tr_b16 v[220:221], v5 offset:36864
ds_read_b64_tr_b16 v[222:223], v5 offset:37888
s_add_u32 m0, s13, 8192
s_add_u32 s3, s3, 73728
buffer_load_dwordx4 v7, s[52:55], s3 offen lds
buffer_load_dwordx4 v8, s[52:55], s3 offen offset:1024 lds
s_lshl_b32 s84, s5, 6
s_add_u32 s84, s84, s86
buffer_store_dwordx4 v[228:231], v9, s[56:59], s84 offen sc1
buffer_store_dwordx4 v[232:235], v9, s[56:59], s84 offen offset:1024 sc1
s_waitcnt lgkmcnt(4)
s_barrier
v_mfma_f32_32x32x16_bf16 v[228:243], v[212:215], v[16:19], 0
ds_read_b64_tr_b16 v[224:225], v5 offset:38912
ds_read_b64_tr_b16 v[226:227], v5 offset:39936
s_waitcnt lgkmcnt(4)
v_mfma_f32_32x32x16_bf16 v[228:243], v[216:219], v[20:23], v[228:243]
s_lshl_b32 s82, s7, 3
v_add_u32 v254, s82, v13
ds_read_b64_tr_b16 v[212:213], v5 offset:40960
ds_read_b64_tr_b16 v[214:215], v5 offset:41984
s_waitcnt lgkmcnt(4)
v_mfma_f32_32x32x16_bf16 v[228:243], v[220:223], v[24:27], v[228:243]
ds_read_b64_tr_b16 v[216:217], v5 offset:43008
ds_read_b64_tr_b16 v[218:219], v5 offset:44032
s_waitcnt lgkmcnt(4)
v_mfma_f32_32x32x16_bf16 v[228:243], v[224:227], v[28:31], v[228:243]
ds_read_b64_tr_b16 v[220:221], v5 offset:45056
ds_read_b64_tr_b16 v[222:223], v5 offset:46080
s_waitcnt lgkmcnt(4)
v_mfma_f32_32x32x16_bf16 v[228:243], v[212:215], v[32:35], v[228:243]
ds_read_b64_tr_b16 v[224:225], v5 offset:47104
ds_read_b64_tr_b16 v[226:227], v5 offset:48128
s_waitcnt lgkmcnt(4)
v_mfma_f32_32x32x16_bf16 v[228:243], v[216:219], v[36:39], v[228:243]
ds_read_b64_tr_b16 v[212:213], v5 offset:49152
ds_read_b64_tr_b16 v[214:215], v5 offset:50176
s_waitcnt lgkmcnt(4)
v_mfma_f32_32x32x16_bf16 v[228:243], v[220:223], v[40:43], v[228:243]
ds_read_b64_tr_b16 v[216:217], v5 offset:51200
ds_read_b64_tr_b16 v[218:219], v5 offset:52224
s_waitcnt lgkmcnt(4)
v_mfma_f32_32x32x16_bf16 v[228:243], v[224:227], v[44:47], v[228:243]
ds_read_b64_tr_b16 v[220:221], v5 offset:53248
ds_read_b64_tr_b16 v[222:223], v5 offset:54272
s_waitcnt vmcnt(18) lgkmcnt(4)
s_barrier
v_mfma_f32_32x32x16_bf16 v[228:243], v[212:215], v[48:51], v[228:243]
ds_read_b64_tr_b16 v[224:225], v5 offset:55296
ds_read_b64_tr_b16 v[226:227], v5 offset:56320
s_waitcnt lgkmcnt(4)
v_mfma_f32_32x32x16_bf16 v[228:243], v[216:219], v[52:55], v[228:243]
ds_read_b64_tr_b16 v[212:213], v5 offset:57344
ds_read_b64_tr_b16 v[214:215], v5 offset:58368
s_waitcnt lgkmcnt(4)
v_mfma_f32_32x32x16_bf16 v[228:243], v[220:223], v[56:59], v[228:243]
ds_read_b64_tr_b16 v[216:217], v5 offset:59392
ds_read_b64_tr_b16 v[218:219], v5 offset:60416
s_waitcnt lgkmcnt(4)
v_mfma_f32_32x32x16_bf16 v[228:243], v[224:227], v[60:63], v[228:243]
ds_read_b64_tr_b16 v[220:221], v5 offset:61440
ds_read_b64_tr_b16 v[222:223], v5 offset:62464
s_waitcnt lgkmcnt(4)
v_mfma_f32_32x32x16_bf16 v[228:243], v[212:215], v[64:67], v[228:243]
ds_read_b64_tr_b16 v[224:225], v5 offset:63488
ds_read_b64_tr_b16 v[226:227], v5 offset:64512
s_waitcnt lgkmcnt(4)
v_mfma_f32_32x32x16_bf16 v[228:243], v[216:219], v[68:71], v[228:243]
ds_read_b64_tr_b16 v[212:213], v6 offset:0
ds_read_b64_tr_b16 v[214:215], v6 offset:1024
s_waitcnt lgkmcnt(4)
v_mfma_f32_32x32x16_bf16 v[228:243], v[220:223], v[72:75], v[228:243]
ds_read_b64_tr_b16 v[216:217], v6 offset:2048
ds_read_b64_tr_b16 v[218:219], v6 offset:3072
s_waitcnt lgkmcnt(4)
v_mfma_f32_32x32x16_bf16 v[228:243], v[224:227], v[76:79], v[228:243]
ds_read_b64_tr_b16 v[220:221], v6 offset:4096
ds_read_b64_tr_b16 v[222:223], v6 offset:5120
s_waitcnt vmcnt(14) lgkmcnt(4)
s_barrier
v_mfma_f32_32x32x16_bf16 v[228:243], v[212:215], v[80:83], v[228:243]
ds_read_b64_tr_b16 v[224:225], v6 offset:6144
ds_read_b64_tr_b16 v[226:227], v6 offset:7168
s_waitcnt lgkmcnt(4)
v_mfma_f32_32x32x16_bf16 v[228:243], v[216:219], v[84:87], v[228:243]
ds_read_b64_tr_b16 v[212:213], v6 offset:8192
ds_read_b64_tr_b16 v[214:215], v6 offset:9216
s_waitcnt lgkmcnt(4)
v_mfma_f32_32x32x16_bf16 v[228:243], v[220:223], v[88:91], v[228:243]
ds_read_b64_tr_b16 v[216:217], v6 offset:10240
ds_read_b64_tr_b16 v[218:219], v6 offset:11264
s_waitcnt lgkmcnt(4)
v_mfma_f32_32x32x16_bf16 v[228:243], v[224:227], v[92:95], v[228:243]
ds_read_b64_tr_b16 v[220:221], v6 offset:12288
ds_read_b64_tr_b16 v[222:223], v6 offset:13312
s_waitcnt lgkmcnt(4)
v_mfma_f32_32x32x16_bf16 v[228:243], v[212:215], v[96:99], v[228:243]
ds_read_b64_tr_b16 v[224:225], v6 offset:14336
ds_read_b64_tr_b16 v[226:227], v6 offset:15360
s_waitcnt lgkmcnt(4)
v_mfma_f32_32x32x16_bf16 v[228:243], v[216:219], v[100:103], v[228:243]
ds_read_b64_tr_b16 v[212:213], v6 offset:16384
ds_read_b64_tr_b16 v[214:215], v6 offset:17408
s_waitcnt lgkmcnt(4)
v_mfma_f32_32x32x16_bf16 v[228:243], v[220:223], v[104:107], v[228:243]
ds_read_b64_tr_b16 v[216:217], v6 offset:18432
ds_read_b64_tr_b16 v[218:219], v6 offset:19456
s_waitcnt lgkmcnt(4)
v_mfma_f32_32x32x16_bf16 v[228:243], v[224:227], v[108:111], v[228:243]
ds_read_b64_tr_b16 v[220:221], v6 offset:20480
ds_read_b64_tr_b16 v[222:223], v6 offset:21504
s_waitcnt vmcnt(10) lgkmcnt(4)
s_barrier
v_mfma_f32_32x32x16_bf16 v[228:243], v[212:215], v[112:115], v[228:243]
ds_read_b64_tr_b16 v[224:225], v6 offset:22528
ds_read_b64_tr_b16 v[226:227], v6 offset:23552
s_waitcnt lgkmcnt(4)
v_mfma_f32_32x32x16_bf16 v[228:243], v[216:219], v[116:119], v[228:243]
ds_read_b64_tr_b16 v[212:213], v6 offset:24576
ds_read_b64_tr_b16 v[214:215], v6 offset:25600
s_waitcnt lgkmcnt(4)
v_mfma_f32_32x32x16_bf16 v[228:243], v[220:223], v[120:123], v[228:243]
ds_read_b64_tr_b16 v[216:217], v6 offset:26624
ds_read_b64_tr_b16 v[218:219], v6 offset:27648
s_waitcnt lgkmcnt(4)
v_mfma_f32_32x32x16_bf16 v[228:243], v[224:227], v[124:127], v[228:243]
ds_read_b64_tr_b16 v[220:221], v6 offset:28672
ds_read_b64_tr_b16 v[222:223], v6 offset:29696
s_waitcnt lgkmcnt(4)
v_mfma_f32_32x32x16_bf16 v[228:243], v[212:215], v[128:131], v[228:243]
ds_read_b64_tr_b16 v[224:225], v6 offset:30720
ds_read_b64_tr_b16 v[226:227], v6 offset:31744
s_waitcnt lgkmcnt(4)
v_mfma_f32_32x32x16_bf16 v[228:243], v[216:219], v[132:135], v[228:243]
ds_read_b64_tr_b16 v[212:213], v6 offset:32768
ds_read_b64_tr_b16 v[214:215], v6 offset:33792
s_waitcnt lgkmcnt(4)
v_mfma_f32_32x32x16_bf16 v[228:243], v[220:223], v[136:139], v[228:243]
ds_read_b64_tr_b16 v[216:217], v6 offset:34816
ds_read_b64_tr_b16 v[218:219], v6 offset:35840
s_waitcnt lgkmcnt(4)
v_mfma_f32_32x32x16_bf16 v[228:243], v[224:227], v[140:143], v[228:243]
ds_read_b64_tr_b16 v[220:221], v6 offset:36864
ds_read_b64_tr_b16 v[222:223], v6 offset:37888
s_waitcnt vmcnt(6) lgkmcnt(4)
s_barrier
v_mfma_f32_32x32x16_bf16 v[228:243], v[212:215], v[144:147], v[228:243]
ds_read_b64_tr_b16 v[224:225], v6 offset:38912
ds_read_b64_tr_b16 v[226:227], v6 offset:39936
s_waitcnt lgkmcnt(4)
v_mfma_f32_32x32x16_bf16 v[228:243], v[216:219], v[148:151], v[228:243]
ds_read_b64_tr_b16 v[212:213], v6 offset:40960
ds_read_b64_tr_b16 v[214:215], v6 offset:41984
s_waitcnt lgkmcnt(4)
v_mfma_f32_32x32x16_bf16 v[228:243], v[220:223], v[152:155], v[228:243]
ds_read_b64_tr_b16 v[216:217], v6 offset:43008
ds_read_b64_tr_b16 v[218:219], v6 offset:44032
s_waitcnt lgkmcnt(4)
v_mfma_f32_32x32x16_bf16 v[228:243], v[224:227], v[156:159], v[228:243]
ds_read_b64_tr_b16 v[244:245], v254 offset:0
ds_read_b64_tr_b16 v[246:247], v254 offset:256
ds_read_b64_tr_b16 v[220:221], v6 offset:45056
ds_read_b64_tr_b16 v[222:223], v6 offset:46080
s_waitcnt lgkmcnt(6)
v_mfma_f32_32x32x16_bf16 v[228:243], v[212:215], v[160:163], v[228:243]
ds_read_b64_tr_b16 v[224:225], v6 offset:47104
ds_read_b64_tr_b16 v[226:227], v6 offset:48128
s_waitcnt lgkmcnt(6)
v_mfma_f32_32x32x16_bf16 v[228:243], v[216:219], v[164:167], v[228:243]
s_waitcnt lgkmcnt(2)
v_mfma_f32_32x32x16_bf16 v[228:243], v[220:223], v[168:171], v[228:243]
s_waitcnt lgkmcnt(0)
v_mfma_f32_32x32x16_bf16 v[228:243], v[224:227], v[172:175], v[228:243]
v_mfma_f32_32x32x16_bf16 v[228:243], v[244:247], v[176:179], v[228:243]
s_waitcnt vmcnt(2)
s_barrier
s_add_u32 m0, s13, 98304
s_add_u32 s3, s9, s76
s_add_u32 s3, s3, 294912
buffer_load_dwordx4 v7, s[52:55], s3 offen lds
s_nop 7
s_nop 3
buffer_load_dwordx4 v8, s[52:55], s3 offen offset:1024 lds
v_cvt_pk_bf16_f32 v228, v228, v229
v_cvt_pk_bf16_f32 v229, v230, v231
v_cvt_pk_bf16_f32 v230, v232, v233
v_cvt_pk_bf16_f32 v231, v234, v235
v_cvt_pk_bf16_f32 v232, v236, v237
v_cvt_pk_bf16_f32 v233, v238, v239
s_add_u32 m0, s13, 106496
s_add_u32 s3, s3, 73728
buffer_load_dwordx4 v7, s[52:55], s3 offen lds
v_cvt_pk_bf16_f32 v234, v240, v241
v_cvt_pk_bf16_f32 v235, v242, v243
s_nop 0
v_permlane32_swap_b32 v228, v230
v_permlane32_swap_b32 v229, v231
v_permlane32_swap_b32 v232, v234
buffer_load_dwordx4 v8, s[52:55], s3 offen offset:1024 lds
v_permlane32_swap_b32 v233, v235
s_barrier
s_add_u32 m0, s13, 114688
s_add_u32 s3, s3, 73728
buffer_load_dwordx4 v7, s[52:55], s3 offen lds
buffer_load_dwordx4 v8, s[52:55], s3 offen offset:1024 lds
s_add_u32 m0, s13, 122880
s_add_u32 s3, s3, 73728
buffer_load_dwordx4 v7, s[52:55], s3 offen lds
buffer_load_dwordx4 v8, s[52:55], s3 offen offset:1024 lds
s_barrier
s_add_u32 m0, s13, 0
s_add_u32 s3, s3, 73728
buffer_load_dwordx4 v7, s[52:55], s3 offen lds
buffer_load_dwordx4 v8, s[52:55], s3 offen offset:1024 lds
s_add_u32 m0, s13, 8192
s_add_u32 s3, s9, s78
buffer_load_dwordx4 v7, s[48:51], s3 offen lds
buffer_load_dwordx4 v8, s[48:51], s3 offen offset:1024 lds
s_barrier
s_add_u32 m0, s13, 16384
s_add_u32 s3, s10, s76
buffer_load_dwordx4 v7, s[52:55], s3 offen lds
buffer_load_dwordx4 v8, s[52:55], s3 offen offset:1024 lds
s_add_u32 m0, s13, 24576
s_add_u32 s3, s3, 73728
buffer_load_dwordx4 v7, s[52:55], s3 offen lds
buffer_load_dwordx4 v8, s[52:55], s3 offen offset:1024 lds
s_barrier
s_add_u32 m0, s13, 32768
s_add_u32 s3, s3, 73728
buffer_load_dwordx4 v7, s[52:55], s3 offen lds
buffer_load_dwordx4 v8, s[52:55], s3 offen offset:1024 lds
ds_read_b64_tr_b16 v[212:213], v6 offset:0
ds_read_b64_tr_b16 v[214:215], v6 offset:1024
ds_read_b64_tr_b16 v[216:217], v6 offset:2048
ds_read_b64_tr_b16 v[218:219], v6 offset:3072
ds_read_b64_tr_b16 v[220:221], v6 offset:4096
ds_read_b64_tr_b16 v[222:223], v6 offset:5120
s_add_u32 m0, s13, 40960
s_add_u32 s3, s3, 73728
buffer_load_dwordx4 v7, s[52:55], s3 offen lds
buffer_load_dwordx4 v8, s[52:55], s3 offen offset:1024 lds
s_waitcnt vmcnt(20)
s_mov_b64 exec, 1
buffer_store_dword v196, v198, s[56:59], s92 offen offset:256 sc1
s_mov_b64 exec, -1
s_lshl_b32 s84, s7, 6
s_add_u32 s84, s84, s86
buffer_store_dwordx4 v[228:231], v9, s[56:59], s84 offen sc1
buffer_store_dwordx4 v[232:235], v9, s[56:59], s84 offen offset:1024 sc1
s_waitcnt lgkmcnt(4)
s_barrier
v_mfma_f32_32x32x16_bf16 v[228:243], v[212:215], v[16:19], 0
ds_read_b64_tr_b16 v[224:225], v6 offset:6144
ds_read_b64_tr_b16 v[226:227], v6 offset:7168
s_waitcnt lgkmcnt(4)
v_mfma_f32_32x32x16_bf16 v[228:243], v[216:219], v[20:23], v[228:243]
s_lshl_b32 s82, s9, 3
v_add_u32 v254, s82, v13
ds_read_b64_tr_b16 v[212:213], v6 offset:8192
ds_read_b64_tr_b16 v[214:215], v6 offset:9216
s_waitcnt lgkmcnt(4)
v_mfma_f32_32x32x16_bf16 v[228:243], v[220:223], v[24:27], v[228:243]
ds_read_b64_tr_b16 v[216:217], v6 offset:10240
ds_read_b64_tr_b16 v[218:219], v6 offset:11264
s_waitcnt lgkmcnt(4)
v_mfma_f32_32x32x16_bf16 v[228:243], v[224:227], v[28:31], v[228:243]
ds_read_b64_tr_b16 v[220:221], v6 offset:12288
ds_read_b64_tr_b16 v[222:223], v6 offset:13312
s_waitcnt lgkmcnt(4)
v_mfma_f32_32x32x16_bf16 v[228:243], v[212:215], v[32:35], v[228:243]
ds_read_b64_tr_b16 v[224:225], v6 offset:14336
ds_read_b64_tr_b16 v[226:227], v6 offset:15360
s_waitcnt lgkmcnt(4)
v_mfma_f32_32x32x16_bf16 v[228:243], v[216:219], v[36:39], v[228:243]
ds_read_b64_tr_b16 v[212:213], v6 offset:16384
ds_read_b64_tr_b16 v[214:215], v6 offset:17408
s_waitcnt lgkmcnt(4)
v_mfma_f32_32x32x16_bf16 v[228:243], v[220:223], v[40:43], v[228:243]
ds_read_b64_tr_b16 v[216:217], v6 offset:18432
ds_read_b64_tr_b16 v[218:219], v6 offset:19456
s_waitcnt lgkmcnt(4)
v_mfma_f32_32x32x16_bf16 v[228:243], v[224:227], v[44:47], v[228:243]
ds_read_b64_tr_b16 v[220:221], v6 offset:20480
ds_read_b64_tr_b16 v[222:223], v6 offset:21504
s_waitcnt vmcnt(19) lgkmcnt(4)
s_barrier
v_mfma_f32_32x32x16_bf16 v[228:243], v[212:215], v[48:51], v[228:243]
ds_read_b64_tr_b16 v[224:225], v6 offset:22528
ds_read_b64_tr_b16 v[226:227], v6 offset:23552
s_waitcnt lgkmcnt(4)
v_mfma_f32_32x32x16_bf16 v[228:243], v[216:219], v[52:55], v[228:243]
ds_read_b64_tr_b16 v[212:213], v6 offset:24576
ds_read_b64_tr_b16 v[214:215], v6 offset:25600
s_waitcnt lgkmcnt(4)
v_mfma_f32_32x32x16_bf16 v[228:243], v[220:223], v[56:59], v[228:243]
ds_read_b64_tr_b16 v[216:217], v6 offset:26624
ds_read_b64_tr_b16 v[218:219], v6 offset:27648
s_waitcnt lgkmcnt(4)
v_mfma_f32_32x32x16_bf16 v[228:243], v[224:227], v[60:63], v[228:243]
ds_read_b64_tr_b16 v[220:221], v6 offset:28672
ds_read_b64_tr_b16 v[222:223], v6 offset:29696
s_waitcnt lgkmcnt(4)
v_mfma_f32_32x32x16_bf16 v[228:243], v[212:215], v[64:67], v[228:243]
ds_read_b64_tr_b16 v[224:225], v6 offset:30720
ds_read_b64_tr_b16 v[226:227], v6 offset:31744
s_waitcnt lgkmcnt(4)
v_mfma_f32_32x32x16_bf16 v[228:243], v[216:219], v[68:71], v[228:243]
ds_read_b64_tr_b16 v[212:213], v6 offset:32768
ds_read_b64_tr_b16 v[214:215], v6 offset:33792
s_waitcnt lgkmcnt(4)
v_mfma_f32_32x32x16_bf16 v[228:243], v[220:223], v[72:75], v[228:243]
ds_read_b64_tr_b16 v[216:217], v6 offset:34816
ds_read_b64_tr_b16 v[218:219], v6 offset:35840
s_waitcnt lgkmcnt(4)
v_mfma_f32_32x32x16_bf16 v[228:243], v[224:227], v[76:79], v[228:243]
ds_read_b64_tr_b16 v[220:221], v6 offset:36864
ds_read_b64_tr_b16 v[222:223], v6 offset:37888
s_waitcnt vmcnt(15) lgkmcnt(4)
s_barrier
v_mfma_f32_32x32x16_bf16 v[228:243], v[212:215], v[80:83], v[228:243]
ds_read_b64_tr_b16 v[224:225], v6 offset:38912
ds_read_b64_tr_b16 v[226:227], v6 offset:39936
s_waitcnt lgkmcnt(4)
v_mfma_f32_32x32x16_bf16 v[228:243], v[216:219], v[84:87], v[228:243]
ds_read_b64_tr_b16 v[212:213], v6 offset:40960
ds_read_b64_tr_b16 v[214:215], v6 offset:41984
s_waitcnt lgkmcnt(4)
v_mfma_f32_32x32x16_bf16 v[228:243], v[220:223], v[88:91], v[228:243]
ds_read_b64_tr_b16 v[216:217], v6 offset:43008
ds_read_b64_tr_b16 v[218:219], v6 offset:44032
s_waitcnt lgkmcnt(4)
v_mfma_f32_32x32x16_bf16 v[228:243], v[224:227], v[92:95], v[228:243]
ds_read_b64_tr_b16 v[220:221], v6 offset:45056
ds_read_b64_tr_b16 v[222:223], v6 offset:46080
s_waitcnt lgkmcnt(4)
v_mfma_f32_32x32x16_bf16 v[228:243], v[212:215], v[96:99], v[228:243]
ds_read_b64_tr_b16 v[224:225], v6 offset:47104
ds_read_b64_tr_b16 v[226:227], v6 offset:48128
s_waitcnt lgkmcnt(4)
v_mfma_f32_32x32x16_bf16 v[228:243], v[216:219], v[100:103], v[228:243]
ds_read_b64_tr_b16 v[212:213], v6 offset:49152
ds_read_b64_tr_b16 v[214:215], v6 offset:50176
s_waitcnt lgkmcnt(4)
v_mfma_f32_32x32x16_bf16 v[228:243], v[220:223], v[104:107], v[228:243]
ds_read_b64_tr_b16 v[216:217], v6 offset:51200
ds_read_b64_tr_b16 v[218:219], v6 offset:52224
s_waitcnt lgkmcnt(4)
v_mfma_f32_32x32x16_bf16 v[228:243], v[224:227], v[108:111], v[228:243]
ds_read_b64_tr_b16 v[220:221], v6 offset:53248
ds_read_b64_tr_b16 v[222:223], v6 offset:54272
s_waitcnt vmcnt(11) lgkmcnt(4)
s_barrier
v_mfma_f32_32x32x16_bf16 v[228:243], v[212:215], v[112:115], v[228:243]
ds_read_b64_tr_b16 v[224:225], v6 offset:55296
ds_read_b64_tr_b16 v[226:227], v6 offset:56320
s_waitcnt lgkmcnt(4)
v_mfma_f32_32x32x16_bf16 v[228:243], v[216:219], v[116:119], v[228:243]
ds_read_b64_tr_b16 v[212:213], v6 offset:57344
ds_read_b64_tr_b16 v[214:215], v6 offset:58368
s_waitcnt lgkmcnt(4)
v_mfma_f32_32x32x16_bf16 v[228:243], v[220:223], v[120:123], v[228:243]
ds_read_b64_tr_b16 v[216:217], v6 offset:59392
ds_read_b64_tr_b16 v[218:219], v6 offset:60416
s_waitcnt lgkmcnt(4)
v_mfma_f32_32x32x16_bf16 v[228:243], v[224:227], v[124:127], v[228:243]
ds_read_b64_tr_b16 v[220:221], v6 offset:61440
ds_read_b64_tr_b16 v[222:223], v6 offset:62464
s_waitcnt lgkmcnt(4)
v_mfma_f32_32x32x16_bf16 v[228:243], v[212:215], v[128:131], v[228:243]
ds_read_b64_tr_b16 v[224:225], v6 offset:63488
ds_read_b64_tr_b16 v[226:227], v6 offset:64512
s_waitcnt lgkmcnt(4)
v_mfma_f32_32x32x16_bf16 v[228:243], v[216:219], v[132:135], v[228:243]
ds_read_b64_tr_b16 v[212:213], v5 offset:0
ds_read_b64_tr_b16 v[214:215], v5 offset:1024
s_waitcnt lgkmcnt(4)
v_mfma_f32_32x32x16_bf16 v[228:243], v[220:223], v[136:139], v[228:243]
ds_read_b64_tr_b16 v[216:217], v5 offset:2048
ds_read_b64_tr_b16 v[218:219], v5 offset:3072
s_waitcnt lgkmcnt(4)
v_mfma_f32_32x32x16_bf16 v[228:243], v[224:227], v[140:143], v[228:243]
ds_read_b64_tr_b16 v[220:221], v5 offset:4096
ds_read_b64_tr_b16 v[222:223], v5 offset:5120
s_waitcnt vmcnt(7) lgkmcnt(4)
s_barrier
v_mfma_f32_32x32x16_bf16 v[228:243], v[212:215], v[144:147], v[228:243]
ds_read_b64_tr_b16 v[224:225], v5 offset:6144
ds_read_b64_tr_b16 v[226:227], v5 offset:7168
s_waitcnt lgkmcnt(4)
v_mfma_f32_32x32x16_bf16 v[228:243], v[216:219], v[148:151], v[228:243]
ds_read_b64_tr_b16 v[212:213], v5 offset:8192
ds_read_b64_tr_b16 v[214:215], v5 offset:9216
s_waitcnt lgkmcnt(4)
v_mfma_f32_32x32x16_bf16 v[228:243], v[220:223], v[152:155], v[228:243]
ds_read_b64_tr_b16 v[216:217], v5 offset:10240
ds_read_b64_tr_b16 v[218:219], v5 offset:11264
s_waitcnt lgkmcnt(4)
v_mfma_f32_32x32x16_bf16 v[228:243], v[224:227], v[156:159], v[228:243]
ds_read_b64_tr_b16 v[244:245], v254 offset:0
ds_read_b64_tr_b16 v[246:247], v254 offset:256
ds_read_b64_tr_b16 v[220:221], v5 offset:12288
ds_read_b64_tr_b16 v[222:223], v5 offset:13312
s_waitcnt lgkmcnt(6)
v_mfma_f32_32x32x16_bf16 v[228:243], v[212:215], v[160:163], v[228:243]
ds_read_b64_tr_b16 v[224:225], v5 offset:14336
ds_read_b64_tr_b16 v[226:227], v5 offset:15360
s_waitcnt lgkmcnt(6)
v_mfma_f32_32x32x16_bf16 v[228:243], v[216:219], v[164:167], v[228:243]
s_waitcnt lgkmcnt(2)
v_mfma_f32_32x32x16_bf16 v[228:243], v[220:223], v[168:171], v[228:243]
s_waitcnt lgkmcnt(0)
v_mfma_f32_32x32x16_bf16 v[228:243], v[224:227], v[172:175], v[228:243]
v_mfma_f32_32x32x16_bf16 v[228:243], v[244:247], v[176:179], v[228:243]
s_waitcnt vmcnt(3)
s_barrier
s_add_u32 m0, s13, 0
s_add_u32 s3, s11, s76
s_add_u32 s3, s3, 294912
buffer_load_dwordx4 v7, s[52:55], s3 offen lds
s_nop 7
s_nop 3
buffer_load_dwordx4 v8, s[52:55], s3 offen offset:1024 lds
v_cvt_pk_bf16_f32 v228, v228, v229
v_cvt_pk_bf16_f32 v229, v230, v231
v_cvt_pk_bf16_f32 v230, v232, v233
v_cvt_pk_bf16_f32 v231, v234, v235
v_cvt_pk_bf16_f32 v232, v236, v237
v_cvt_pk_bf16_f32 v233, v238, v239
s_add_u32 m0, s13, 8192
s_add_u32 s3, s3, 73728
buffer_load_dwordx4 v7, s[52:55], s3 offen lds
v_cvt_pk_bf16_f32 v234, v240, v241
v_cvt_pk_bf16_f32 v235, v242, v243
s_nop 0
v_permlane32_swap_b32 v228, v230
v_permlane32_swap_b32 v229, v231
v_permlane32_swap_b32 v232, v234
buffer_load_dwordx4 v8, s[52:55], s3 offen offset:1024 lds
v_permlane32_swap_b32 v233, v235
s_barrier
s_add_u32 m0, s13, 16384
s_add_u32 s3, s3, 73728
buffer_load_dwordx4 v7, s[52:55], s3 offen lds
buffer_load_dwordx4 v8, s[52:55], s3 offen offset:1024 lds
s_add_u32 m0, s13, 24576
s_add_u32 s3, s3, 73728
buffer_load_dwordx4 v7, s[52:55], s3 offen lds
buffer_load_dwordx4 v8, s[52:55], s3 offen offset:1024 lds
s_barrier
s_add_u32 m0, s13, 32768
s_add_u32 s3, s3, 73728
buffer_load_dwordx4 v7, s[52:55], s3 offen lds
buffer_load_dwordx4 v8, s[52:55], s3 offen offset:1024 lds
s_add_u32 m0, s13, 40960
s_add_u32 s3, s11, s78
buffer_load_dwordx4 v7, s[48:51], s3 offen lds
buffer_load_dwordx4 v8, s[48:51], s3 offen offset:1024 lds
s_barrier
s_add_u32 m0, s13, 49152
s_add_u32 s3, s12, s76
buffer_load_dwordx4 v7, s[52:55], s3 offen lds
buffer_load_dwordx4 v8, s[52:55], s3 offen offset:1024 lds
s_add_u32 m0, s13, 57344
s_add_u32 s3, s3, 73728
buffer_load_dwordx4 v7, s[52:55], s3 offen lds
buffer_load_dwordx4 v8, s[52:55], s3 offen offset:1024 lds
s_barrier
s_add_u32 m0, s13, 65536
s_add_u32 s3, s3, 73728
buffer_load_dwordx4 v7, s[52:55], s3 offen lds
buffer_load_dwordx4 v8, s[52:55], s3 offen offset:1024 lds
ds_read_b64_tr_b16 v[212:213], v6 offset:32768
ds_read_b64_tr_b16 v[214:215], v6 offset:33792
ds_read_b64_tr_b16 v[216:217], v6 offset:34816
ds_read_b64_tr_b16 v[218:219], v6 offset:35840
ds_read_b64_tr_b16 v[220:221], v6 offset:36864
ds_read_b64_tr_b16 v[222:223], v6 offset:37888
s_add_u32 m0, s13, 73728
s_add_u32 s3, s3, 73728
buffer_load_dwordx4 v7, s[52:55], s3 offen lds
buffer_load_dwordx4 v8, s[52:55], s3 offen offset:1024 lds
s_waitcnt vmcnt(20)
s_mov_b64 exec, 1
buffer_store_dword v196, v198, s[56:59], s92 offen offset:768 sc1
s_mov_b64 exec, -1
s_lshl_b32 s84, s9, 6
s_add_u32 s84, s84, s86
buffer_store_dwordx4 v[228:231], v9, s[56:59], s84 offen sc1
buffer_store_dwordx4 v[232:235], v9, s[56:59], s84 offen offset:1024 sc1
s_waitcnt lgkmcnt(4)
s_barrier
v_mfma_f32_32x32x16_bf16 v[228:243], v[212:215], v[16:19], 0
ds_read_b64_tr_b16 v[224:225], v6 offset:38912
ds_read_b64_tr_b16 v[226:227], v6 offset:39936
s_waitcnt lgkmcnt(4)
v_mfma_f32_32x32x16_bf16 v[228:243], v[216:219], v[20:23], v[228:243]
s_lshl_b32 s82, s11, 3
v_add_u32 v254, s82, v13
ds_read_b64_tr_b16 v[212:213], v6 offset:40960
ds_read_b64_tr_b16 v[214:215], v6 offset:41984
s_waitcnt lgkmcnt(4)
v_mfma_f32_32x32x16_bf16 v[228:243], v[220:223], v[24:27], v[228:243]
ds_read_b64_tr_b16 v[216:217], v6 offset:43008
ds_read_b64_tr_b16 v[218:219], v6 offset:44032
s_waitcnt lgkmcnt(4)
v_mfma_f32_32x32x16_bf16 v[228:243], v[224:227], v[28:31], v[228:243]
ds_read_b64_tr_b16 v[220:221], v6 offset:45056
ds_read_b64_tr_b16 v[222:223], v6 offset:46080
s_waitcnt lgkmcnt(4)
v_mfma_f32_32x32x16_bf16 v[228:243], v[212:215], v[32:35], v[228:243]
ds_read_b64_tr_b16 v[224:225], v6 offset:47104
ds_read_b64_tr_b16 v[226:227], v6 offset:48128
s_waitcnt lgkmcnt(4)
v_mfma_f32_32x32x16_bf16 v[228:243], v[216:219], v[36:39], v[228:243]
ds_read_b64_tr_b16 v[212:213], v6 offset:49152
ds_read_b64_tr_b16 v[214:215], v6 offset:50176
s_waitcnt lgkmcnt(4)
v_mfma_f32_32x32x16_bf16 v[228:243], v[220:223], v[40:43], v[228:243]
ds_read_b64_tr_b16 v[216:217], v6 offset:51200
ds_read_b64_tr_b16 v[218:219], v6 offset:52224
s_waitcnt lgkmcnt(4)
v_mfma_f32_32x32x16_bf16 v[228:243], v[224:227], v[44:47], v[228:243]
ds_read_b64_tr_b16 v[220:221], v6 offset:53248
ds_read_b64_tr_b16 v[222:223], v6 offset:54272
s_waitcnt vmcnt(19) lgkmcnt(4)
s_barrier
v_mfma_f32_32x32x16_bf16 v[228:243], v[212:215], v[48:51], v[228:243]
ds_read_b64_tr_b16 v[224:225], v6 offset:55296
ds_read_b64_tr_b16 v[226:227], v6 offset:56320
s_waitcnt lgkmcnt(4)
v_mfma_f32_32x32x16_bf16 v[228:243], v[216:219], v[52:55], v[228:243]
ds_read_b64_tr_b16 v[212:213], v6 offset:57344
ds_read_b64_tr_b16 v[214:215], v6 offset:58368
s_waitcnt lgkmcnt(4)
v_mfma_f32_32x32x16_bf16 v[228:243], v[220:223], v[56:59], v[228:243]
ds_read_b64_tr_b16 v[216:217], v6 offset:59392
ds_read_b64_tr_b16 v[218:219], v6 offset:60416
s_waitcnt lgkmcnt(4)
v_mfma_f32_32x32x16_bf16 v[228:243], v[224:227], v[60:63], v[228:243]
ds_read_b64_tr_b16 v[220:221], v6 offset:61440
ds_read_b64_tr_b16 v[222:223], v6 offset:62464
s_waitcnt lgkmcnt(4)
v_mfma_f32_32x32x16_bf16 v[228:243], v[212:215], v[64:67], v[228:243]
ds_read_b64_tr_b16 v[224:225], v6 offset:63488
ds_read_b64_tr_b16 v[226:227], v6 offset:64512
s_waitcnt lgkmcnt(4)
v_mfma_f32_32x32x16_bf16 v[228:243], v[216:219], v[68:71], v[228:243]
ds_read_b64_tr_b16 v[212:213], v5 offset:0
ds_read_b64_tr_b16 v[214:215], v5 offset:1024
s_waitcnt lgkmcnt(4)
v_mfma_f32_32x32x16_bf16 v[228:243], v[220:223], v[72:75], v[228:243]
ds_read_b64_tr_b16 v[216:217], v5 offset:2048
ds_read_b64_tr_b16 v[218:219], v5 offset:3072
s_waitcnt lgkmcnt(4)
v_mfma_f32_32x32x16_bf16 v[228:243], v[224:227], v[76:79], v[228:243]
ds_read_b64_tr_b16 v[220:221], v5 offset:4096
ds_read_b64_tr_b16 v[222:223], v5 offset:5120
s_waitcnt vmcnt(15) lgkmcnt(4)
s_barrier
v_mfma_f32_32x32x16_bf16 v[228:243], v[212:215], v[80:83], v[228:243]
ds_read_b64_tr_b16 v[224:225], v5 offset:6144
ds_read_b64_tr_b16 v[226:227], v5 offset:7168
s_waitcnt lgkmcnt(4)
v_mfma_f32_32x32x16_bf16 v[228:243], v[216:219], v[84:87], v[228:243]
ds_read_b64_tr_b16 v[212:213], v5 offset:8192
ds_read_b64_tr_b16 v[214:215], v5 offset:9216
s_waitcnt lgkmcnt(4)
v_mfma_f32_32x32x16_bf16 v[228:243], v[220:223], v[88:91], v[228:243]
ds_read_b64_tr_b16 v[216:217], v5 offset:10240
ds_read_b64_tr_b16 v[218:219], v5 offset:11264
s_waitcnt lgkmcnt(4)
v_mfma_f32_32x32x16_bf16 v[228:243], v[224:227], v[92:95], v[228:243]
ds_read_b64_tr_b16 v[220:221], v5 offset:12288
ds_read_b64_tr_b16 v[222:223], v5 offset:13312
s_waitcnt lgkmcnt(4)
v_mfma_f32_32x32x16_bf16 v[228:243], v[212:215], v[96:99], v[228:243]
ds_read_b64_tr_b16 v[224:225], v5 offset:14336
ds_read_b64_tr_b16 v[226:227], v5 offset:15360
s_waitcnt lgkmcnt(4)
v_mfma_f32_32x32x16_bf16 v[228:243], v[216:219], v[100:103], v[228:243]
ds_read_b64_tr_b16 v[212:213], v5 offset:16384
ds_read_b64_tr_b16 v[214:215], v5 offset:17408
s_waitcnt lgkmcnt(4)
v_mfma_f32_32x32x16_bf16 v[228:243], v[220:223], v[104:107], v[228:243]
ds_read_b64_tr_b16 v[216:217], v5 offset:18432
ds_read_b64_tr_b16 v[218:219], v5 offset:19456
s_waitcnt lgkmcnt(4)
v_mfma_f32_32x32x16_bf16 v[228:243], v[224:227], v[108:111], v[228:243]
ds_read_b64_tr_b16 v[220:221], v5 offset:20480
ds_read_b64_tr_b16 v[222:223], v5 offset:21504
s_waitcnt vmcnt(11) lgkmcnt(4)
s_barrier
v_mfma_f32_32x32x16_bf16 v[228:243], v[212:215], v[112:115], v[228:243]
ds_read_b64_tr_b16 v[224:225], v5 offset:22528
ds_read_b64_tr_b16 v[226:227], v5 offset:23552
s_waitcnt lgkmcnt(4)
v_mfma_f32_32x32x16_bf16 v[228:243], v[216:219], v[116:119], v[228:243]
ds_read_b64_tr_b16 v[212:213], v5 offset:24576
ds_read_b64_tr_b16 v[214:215], v5 offset:25600
s_waitcnt lgkmcnt(4)
v_mfma_f32_32x32x16_bf16 v[228:243], v[220:223], v[120:123], v[228:243]
ds_read_b64_tr_b16 v[216:217], v5 offset:26624
ds_read_b64_tr_b16 v[218:219], v5 offset:27648
s_waitcnt lgkmcnt(4)
v_mfma_f32_32x32x16_bf16 v[228:243], v[224:227], v[124:127], v[228:243]
ds_read_b64_tr_b16 v[220:221], v5 offset:28672
ds_read_b64_tr_b16 v[222:223], v5 offset:29696
s_waitcnt lgkmcnt(4)
v_mfma_f32_32x32x16_bf16 v[228:243], v[212:215], v[128:131], v[228:243]
ds_read_b64_tr_b16 v[224:225], v5 offset:30720
ds_read_b64_tr_b16 v[226:227], v5 offset:31744
s_waitcnt lgkmcnt(4)
v_mfma_f32_32x32x16_bf16 v[228:243], v[216:219], v[132:135], v[228:243]
ds_read_b64_tr_b16 v[212:213], v5 offset:32768
ds_read_b64_tr_b16 v[214:215], v5 offset:33792
s_waitcnt lgkmcnt(4)
v_mfma_f32_32x32x16_bf16 v[228:243], v[220:223], v[136:139], v[228:243]
ds_read_b64_tr_b16 v[216:217], v5 offset:34816
ds_read_b64_tr_b16 v[218:219], v5 offset:35840
s_waitcnt lgkmcnt(4)
v_mfma_f32_32x32x16_bf16 v[228:243], v[224:227], v[140:143], v[228:243]
ds_read_b64_tr_b16 v[220:221], v5 offset:36864
ds_read_b64_tr_b16 v[222:223], v5 offset:37888
s_waitcnt vmcnt(7) lgkmcnt(4)
s_barrier
v_mfma_f32_32x32x16_bf16 v[228:243], v[212:215], v[144:147], v[228:243]
ds_read_b64_tr_b16 v[224:225], v5 offset:38912
ds_read_b64_tr_b16 v[226:227], v5 offset:39936
s_waitcnt lgkmcnt(4)
v_mfma_f32_32x32x16_bf16 v[228:243], v[216:219], v[148:151], v[228:243]
ds_read_b64_tr_b16 v[212:213], v5 offset:40960
ds_read_b64_tr_b16 v[214:215], v5 offset:41984
s_waitcnt lgkmcnt(4)
v_mfma_f32_32x32x16_bf16 v[228:243], v[220:223], v[152:155], v[228:243]
ds_read_b64_tr_b16 v[216:217], v5 offset:43008
ds_read_b64_tr_b16 v[218:219], v5 offset:44032
s_waitcnt lgkmcnt(4)
v_mfma_f32_32x32x16_bf16 v[228:243], v[224:227], v[156:159], v[228:243]
ds_read_b64_tr_b16 v[244:245], v254 offset:0
ds_read_b64_tr_b16 v[246:247], v254 offset:256
ds_read_b64_tr_b16 v[220:221], v5 offset:45056
ds_read_b64_tr_b16 v[222:223], v5 offset:46080
s_waitcnt lgkmcnt(6)
v_mfma_f32_32x32x16_bf16 v[228:243], v[212:215], v[160:163], v[228:243]
ds_read_b64_tr_b16 v[224:225], v5 offset:47104
ds_read_b64_tr_b16 v[226:227], v5 offset:48128
s_waitcnt lgkmcnt(6)
v_mfma_f32_32x32x16_bf16 v[228:243], v[216:219], v[164:167], v[228:243]
s_waitcnt lgkmcnt(2)
v_mfma_f32_32x32x16_bf16 v[228:243], v[220:223], v[168:171], v[228:243]
s_waitcnt lgkmcnt(0)
v_mfma_f32_32x32x16_bf16 v[228:243], v[224:227], v[172:175], v[228:243]
v_mfma_f32_32x32x16_bf16 v[228:243], v[244:247], v[176:179], v[228:243]
s_waitcnt vmcnt(3)
s_barrier
s_nop 7
s_nop 3
v_cvt_pk_bf16_f32 v228, v228, v229
v_cvt_pk_bf16_f32 v229, v230, v231
v_cvt_pk_bf16_f32 v230, v232, v233
v_cvt_pk_bf16_f32 v231, v234, v235
v_cvt_pk_bf16_f32 v232, v236, v237
v_cvt_pk_bf16_f32 v233, v238, v239
v_cvt_pk_bf16_f32 v234, v240, v241
v_cvt_pk_bf16_f32 v235, v242, v243
s_nop 0
v_permlane32_swap_b32 v228, v230
v_permlane32_swap_b32 v229, v231
v_permlane32_swap_b32 v232, v234
v_permlane32_swap_b32 v233, v235
s_lshl_b32 s84, s11, 6
s_add_u32 s84, s84, s86
buffer_store_dwordx4 v[228:231], v9, s[56:59], s84 offen sc1
buffer_store_dwordx4 v[232:235], v9, s[56:59], s84 offen offset:1024 sc1
s_waitcnt vmcnt(2)
s_mov_b64 exec, 1
buffer_store_dword v196, v198, s[56:59], s92 offen offset:1280 sc1
s_mov_b64 exec, -1
s_mov_b32 s82, s69
s_lshl_b32 s79, s82, 8
s_add_u32 s79, s79, s20
s_lshr_b32 s81, s4, 7
s_add_u32 s82, s82, s81
s_sub_u32 s81, s82, 9
s_cmp_ge_u32 s82, 9
s_cselect_b32 s82, s81, s82
s_lshl_b32 s82, s82, 3
s_add_u32 s82, s82, s71
buffer_load_dword v200, v199, s[56:59], s79 offen sc1
s_bfe_u32 s73, s82, 0x10001
s_lshl_b32 s80, s72, 1
s_add_u32 s73, s73, s80
s_mul_i32 s73, s73, 36864
s_lshr_b32 s74, s82, 2
s_lshl_b32 s74, s74, 6
s_and_b32 s80, s82, 1
s_lshl_b32 s80, s80, 5
s_add_u32 s74, s74, s80
s_add_u32 s73, s73, s74
s_mul_i32 s80, s72, 73728
s_lshl_b32 s75, s82, 10
s_add_u32 s75, s75, s80
s_add_u32 s75, s75, 16777216
v_mul_u32_u24 v24, 1152, v2
v_lshl_add_u32 v24, v3, 4, v24
v_lshlrev_b32 v25, 4, v3
buffer_load_dwordx4 v[16:19], v24, s[28:31], s73 offen
buffer_load_dwordx4 v[20:23], v25, s[16:19], s74 offen
s_waitcnt vmcnt(2)
s_mov_b64 exec, 1
buffer_store_dword v196, v198, s[56:59], s92 offen offset:1792 sc1
s_mov_b64 exec, -1
s_mov_b32 s85, 0
L_p5:
v_cmp_eq_u32 s[26:27], v200, v196
s_nop 1
s_cmp_eq_u64 s[26:27], -1
s_cbranch_scc1 L_pd5
s_sleep 1
buffer_load_dword v200, v199, s[56:59], s79 offen sc1
s_waitcnt vmcnt(0)
s_add_u32 s85, s85, 1
s_cmp_lt_u32 s85, 0x100000
s_cbranch_scc1 L_p5
L_pd5:
buffer_load_dwordx4 v[32:35], v9, s[56:59], s75 offen sc1
s_add_u32 s75, s75, 2359296
buffer_load_dwordx4 v[36:39], v9, s[56:59], s75 offen sc1
s_add_u32 s75, s75, 2359296
buffer_load_dwordx4 v[40:43], v9, s[56:59], s75 offen sc1
s_add_u32 s75, s75, 2359296
buffer_load_dwordx4 v[44:47], v9, s[56:59], s75 offen sc1
s_add_u32 s75, s75, 2359296
buffer_load_dwordx4 v[48:51], v9, s[56:59], s75 offen sc1
s_add_u32 s75, s75, 2359296
buffer_load_dwordx4 v[52:55], v9, s[56:59], s75 offen sc1
s_add_u32 s75, s75, 2359296
buffer_load_dwordx4 v[56:59], v9, s[56:59], s75 offen sc1
s_add_u32 s75, s75, 2359296
buffer_load_dwordx4 v[60:63], v9, s[56:59], s75 offen sc1
s_waitcnt vmcnt(8)
v_lshlrev_b32 v64, 16, v16
v_and_b32 v65, 0xffff0000, v16
v_lshlrev_b32 v66, 16, v17
v_and_b32 v67, 0xffff0000, v17
v_lshlrev_b32 v68, 16, v18
v_and_b32 v69, 0xffff0000, v18
v_lshlrev_b32 v70, 16, v19
v_and_b32 v71, 0xffff0000, v19
v_lshlrev_b32 v248, 16, v20
v_and_b32 v249, 0xffff0000, v20
v_add_f32 v64, v64, v248
v_add_f32 v65, v65, v249
v_lshlrev_b32 v250, 16, v21
v_and_b32 v251, 0xffff0000, v21
v_add_f32 v66, v66, v250
v_add_f32 v67, v67, v251
v_lshlrev_b32 v248, 16, v22
v_and_b32 v249, 0xffff0000, v22
v_add_f32 v68, v68, v248
v_add_f32 v69, v69, v249
v_lshlrev_b32 v250, 16, v23
v_and_b32 v251, 0xffff0000, v23
v_add_f32 v70, v70, v250
v_add_f32 v71, v71, v251
s_waitcnt vmcnt(7)
v_lshlrev_b32 v248, 16, v32
v_and_b32 v249, 0xffff0000, v32
v_add_f32 v64, v64, v248
v_add_f32 v65, v65, v249
v_lshlrev_b32 v250, 16, v33
v_and_b32 v251, 0xffff0000, v33
v_add_f32 v66, v66, v250
v_add_f32 v67, v67, v251
v_lshlrev_b32 v248, 16, v34
v_and_b32 v249, 0xffff0000, v34
v_add_f32 v68, v68, v248
v_add_f32 v69, v69, v249
v_lshlrev_b32 v250, 16, v35
v_and_b32 v251, 0xffff0000, v35
v_add_f32 v70, v70, v250
v_add_f32 v71, v71, v251
s_waitcnt vmcnt(6)
v_lshlrev_b32 v248, 16, v36
v_and_b32 v249, 0xffff0000, v36
v_add_f32 v64, v64, v248
v_add_f32 v65, v65, v249
v_lshlrev_b32 v250, 16, v37
v_and_b32 v251, 0xffff0000, v37
v_add_f32 v66, v66, v250
v_add_f32 v67, v67, v251
v_lshlrev_b32 v248, 16, v38
v_and_b32 v249, 0xffff0000, v38
v_add_f32 v68, v68, v248
v_add_f32 v69, v69, v249
v_lshlrev_b32 v250, 16, v39
v_and_b32 v251, 0xffff0000, v39
v_add_f32 v70, v70, v250
v_add_f32 v71, v71, v251
s_waitcnt vmcnt(5)
v_lshlrev_b32 v248, 16, v40
v_and_b32 v249, 0xffff0000, v40
v_add_f32 v64, v64, v248
v_add_f32 v65, v65, v249
v_lshlrev_b32 v250, 16, v41
v_and_b32 v251, 0xffff0000, v41
v_add_f32 v66, v66, v250
v_add_f32 v67, v67, v251
v_lshlrev_b32 v248, 16, v42
v_and_b32 v249, 0xffff0000, v42
v_add_f32 v68, v68, v248
v_add_f32 v69, v69, v249
v_lshlrev_b32 v250, 16, v43
v_and_b32 v251, 0xffff0000, v43
v_add_f32 v70, v70, v250
v_add_f32 v71, v71, v251
s_waitcnt vmcnt(4)
v_lshlrev_b32 v248, 16, v44
v_and_b32 v249, 0xffff0000, v44
v_add_f32 v64, v64, v248
v_add_f32 v65, v65, v249
v_lshlrev_b32 v250, 16, v45
v_and_b32 v251, 0xffff0000, v45
v_add_f32 v66, v66, v250
v_add_f32 v67, v67, v251
v_lshlrev_b32 v248, 16, v46
v_and_b32 v249, 0xffff0000, v46
v_add_f32 v68, v68, v248
v_add_f32 v69, v69, v249
v_lshlrev_b32 v250, 16, v47
v_and_b32 v251, 0xffff0000, v47
v_add_f32 v70, v70, v250
v_add_f32 v71, v71, v251
s_waitcnt vmcnt(3)
v_lshlrev_b32 v248, 16, v48
v_and_b32 v249, 0xffff0000, v48
v_add_f32 v64, v64, v248
v_add_f32 v65, v65, v249
v_lshlrev_b32 v250, 16, v49
v_and_b32 v251, 0xffff0000, v49
v_add_f32 v66, v66, v250
v_add_f32 v67, v67, v251
v_lshlrev_b32 v248, 16, v50
v_and_b32 v249, 0xffff0000, v50
v_add_f32 v68, v68, v248
v_add_f32 v69, v69, v249
v_lshlrev_b32 v250, 16, v51
v_and_b32 v251, 0xffff0000, v51
v_add_f32 v70, v70, v250
v_add_f32 v71, v71, v251
s_waitcnt vmcnt(2)
v_lshlrev_b32 v248, 16, v52
v_and_b32 v249, 0xffff0000, v52
v_add_f32 v64, v64, v248
v_add_f32 v65, v65, v249
v_lshlrev_b32 v250, 16, v53
v_and_b32 v251, 0xffff0000, v53
v_add_f32 v66, v66, v250
v_add_f32 v67, v67, v251
v_lshlrev_b32 v248, 16, v54
v_and_b32 v249, 0xffff0000, v54
v_add_f32 v68, v68, v248
v_add_f32 v69, v69, v249
v_lshlrev_b32 v250, 16, v55
v_and_b32 v251, 0xffff0000, v55
v_add_f32 v70, v70, v250
v_add_f32 v71, v71, v251
s_waitcnt vmcnt(1)
v_lshlrev_b32 v248, 16, v56
v_and_b32 v249, 0xffff0000, v56
v_add_f32 v64, v64, v248
v_add_f32 v65, v65, v249
v_lshlrev_b32 v250, 16, v57
v_and_b32 v251, 0xffff0000, v57
v_add_f32 v66, v66, v250
v_add_f32 v67, v67, v251
v_lshlrev_b32 v248, 16, v58
v_and_b32 v249, 0xffff0000, v58
v_add_f32 v68, v68, v248
v_add_f32 v69, v69, v249
v_lshlrev_b32 v250, 16, v59
v_and_b32 v251, 0xffff0000, v59
v_add_f32 v70, v70, v250
v_add_f32 v71, v71, v251
s_waitcnt vmcnt(0)
v_lshlrev_b32 v248, 16, v60
v_and_b32 v249, 0xffff0000, v60
v_add_f32 v64, v64, v248
v_add_f32 v65, v65, v249
v_lshlrev_b32 v250, 16, v61
v_and_b32 v251, 0xffff0000, v61
v_add_f32 v66, v66, v250
v_add_f32 v67, v67, v251
v_lshlrev_b32 v248, 16, v62
v_and_b32 v249, 0xffff0000, v62
v_add_f32 v68, v68, v248
v_add_f32 v69, v69, v249
v_lshlrev_b32 v250, 16, v63
v_and_b32 v251, 0xffff0000, v63
v_add_f32 v70, v70, v250
v_add_f32 v71, v71, v251
v_cvt_pk_bf16_f32 v16, v64, v65
v_cvt_pk_bf16_f32 v17, v66, v67
v_cvt_pk_bf16_f32 v18, v68, v69
v_cvt_pk_bf16_f32 v19, v70, v71
buffer_store_dwordx4 v[16:19], v24, s[64:67], s73 offen
s_nop 1
s_add_u32 s82, s69, 4
s_lshl_b32 s79, s82, 8
s_add_u32 s79, s79, s20
s_lshr_b32 s81, s4, 7
s_add_u32 s82, s82, s81
s_sub_u32 s81, s82, 9
s_cmp_ge_u32 s82, 9
s_cselect_b32 s82, s81, s82
s_lshl_b32 s82, s82, 3
s_add_u32 s82, s82, s71
buffer_load_dword v200, v199, s[56:59], s79 offen sc1
s_bfe_u32 s73, s82, 0x10001
s_lshl_b32 s80, s72, 1
s_add_u32 s73, s73, s80
s_mul_i32 s73, s73, 36864
s_lshr_b32 s74, s82, 2
s_lshl_b32 s74, s74, 6
s_and_b32 s80, s82, 1
s_lshl_b32 s80, s80, 5
s_add_u32 s74, s74, s80
s_add_u32 s73, s73, s74
s_mul_i32 s80, s72, 73728
s_lshl_b32 s75, s82, 10
s_add_u32 s75, s75, s80
s_add_u32 s75, s75, 16777216
v_mul_u32_u24 v24, 1152, v2
v_lshl_add_u32 v24, v3, 4, v24
v_lshlrev_b32 v25, 4, v3
buffer_load_dwordx4 v[16:19], v24, s[28:31], s73 offen
buffer_load_dwordx4 v[20:23], v25, s[16:19], s74 offen
s_waitcnt vmcnt(2)
s_mov_b32 s85, 0
L_p6:
v_cmp_eq_u32 s[26:27], v200, v196
s_nop 1
s_cmp_eq_u64 s[26:27], -1
s_cbranch_scc1 L_pd6
s_sleep 1
buffer_load_dword v200, v199, s[56:59], s79 offen sc1
s_waitcnt vmcnt(0)
s_add_u32 s85, s85, 1
s_cmp_lt_u32 s85, 0x100000
s_cbranch_scc1 L_p6
L_pd6:
buffer_load_dwordx4 v[32:35], v9, s[56:59], s75 offen sc1
s_add_u32 s75, s75, 2359296
buffer_load_dwordx4 v[36:39], v9, s[56:59], s75 offen sc1
s_add_u32 s75, s75, 2359296
buffer_load_dwordx4 v[40:43], v9, s[56:59], s75 offen sc1
s_add_u32 s75, s75, 2359296
buffer_load_dwordx4 v[44:47], v9, s[56:59], s75 offen sc1
s_add_u32 s75, s75, 2359296
buffer_load_dwordx4 v[48:51], v9, s[56:59], s75 offen sc1
s_add_u32 s75, s75, 2359296
buffer_load_dwordx4 v[52:55], v9, s[56:59], s75 offen sc1
s_add_u32 s75, s75, 2359296
buffer_load_dwordx4 v[56:59], v9, s[56:59], s75 offen sc1
s_add_u32 s75, s75, 2359296
buffer_load_dwordx4 v[60:63], v9, s[56:59], s75 offen sc1
s_waitcnt vmcnt(8)
v_lshlrev_b32 v64, 16, v16
v_and_b32 v65, 0xffff0000, v16
v_lshlrev_b32 v66, 16, v17
v_and_b32 v67, 0xffff0000, v17
v_lshlrev_b32 v68, 16, v18
v_and_b32 v69, 0xffff0000, v18
v_lshlrev_b32 v70, 16, v19
v_and_b32 v71, 0xffff0000, v19
v_lshlrev_b32 v248, 16, v20
v_and_b32 v249, 0xffff0000, v20
v_add_f32 v64, v64, v248
v_add_f32 v65, v65, v249
v_lshlrev_b32 v250, 16, v21
v_and_b32 v251, 0xffff0000, v21
v_add_f32 v66, v66, v250
v_add_f32 v67, v67, v251
v_lshlrev_b32 v248, 16, v22
v_and_b32 v249, 0xffff0000, v22
v_add_f32 v68, v68, v248
v_add_f32 v69, v69, v249
v_lshlrev_b32 v250, 16, v23
v_and_b32 v251, 0xffff0000, v23
v_add_f32 v70, v70, v250
v_add_f32 v71, v71, v251
s_waitcnt vmcnt(7)
v_lshlrev_b32 v248, 16, v32
v_and_b32 v249, 0xffff0000, v32
v_add_f32 v64, v64, v248
v_add_f32 v65, v65, v249
v_lshlrev_b32 v250, 16, v33
v_and_b32 v251, 0xffff0000, v33
v_add_f32 v66, v66, v250
v_add_f32 v67, v67, v251
v_lshlrev_b32 v248, 16, v34
v_and_b32 v249, 0xffff0000, v34
v_add_f32 v68, v68, v248
v_add_f32 v69, v69, v249
v_lshlrev_b32 v250, 16, v35
v_and_b32 v251, 0xffff0000, v35
v_add_f32 v70, v70, v250
v_add_f32 v71, v71, v251
s_waitcnt vmcnt(6)
v_lshlrev_b32 v248, 16, v36
v_and_b32 v249, 0xffff0000, v36
v_add_f32 v64, v64, v248
v_add_f32 v65, v65, v249
v_lshlrev_b32 v250, 16, v37
v_and_b32 v251, 0xffff0000, v37
v_add_f32 v66, v66, v250
v_add_f32 v67, v67, v251
v_lshlrev_b32 v248, 16, v38
v_and_b32 v249, 0xffff0000, v38
v_add_f32 v68, v68, v248
v_add_f32 v69, v69, v249
v_lshlrev_b32 v250, 16, v39
v_and_b32 v251, 0xffff0000, v39
v_add_f32 v70, v70, v250
v_add_f32 v71, v71, v251
s_waitcnt vmcnt(5)
v_lshlrev_b32 v248, 16, v40
v_and_b32 v249, 0xffff0000, v40
v_add_f32 v64, v64, v248
v_add_f32 v65, v65, v249
v_lshlrev_b32 v250, 16, v41
v_and_b32 v251, 0xffff0000, v41
v_add_f32 v66, v66, v250
v_add_f32 v67, v67, v251
v_lshlrev_b32 v248, 16, v42
v_and_b32 v249, 0xffff0000, v42
v_add_f32 v68, v68, v248
v_add_f32 v69, v69, v249
v_lshlrev_b32 v250, 16, v43
v_and_b32 v251, 0xffff0000, v43
v_add_f32 v70, v70, v250
v_add_f32 v71, v71, v251
s_waitcnt vmcnt(4)
v_lshlrev_b32 v248, 16, v44
v_and_b32 v249, 0xffff0000, v44
v_add_f32 v64, v64, v248
v_add_f32 v65, v65, v249
v_lshlrev_b32 v250, 16, v45
v_and_b32 v251, 0xffff0000, v45
v_add_f32 v66, v66, v250
v_add_f32 v67, v67, v251
v_lshlrev_b32 v248, 16, v46
v_and_b32 v249, 0xffff0000, v46
v_add_f32 v68, v68, v248
v_add_f32 v69, v69, v249
v_lshlrev_b32 v250, 16, v47
v_and_b32 v251, 0xffff0000, v47
v_add_f32 v70, v70, v250
v_add_f32 v71, v71, v251
s_waitcnt vmcnt(3)
v_lshlrev_b32 v248, 16, v48
v_and_b32 v249, 0xffff0000, v48
v_add_f32 v64, v64, v248
v_add_f32 v65, v65, v249
v_lshlrev_b32 v250, 16, v49
v_and_b32 v251, 0xffff0000, v49
v_add_f32 v66, v66, v250
v_add_f32 v67, v67, v251
v_lshlrev_b32 v248, 16, v50
v_and_b32 v249, 0xffff0000, v50
v_add_f32 v68, v68, v248
v_add_f32 v69, v69, v249
v_lshlrev_b32 v250, 16, v51
v_and_b32 v251, 0xffff0000, v51
v_add_f32 v70, v70, v250
v_add_f32 v71, v71, v251
s_waitcnt vmcnt(2)
v_lshlrev_b32 v248, 16, v52
v_and_b32 v249, 0xffff0000, v52
v_add_f32 v64, v64, v248
v_add_f32 v65, v65, v249
v_lshlrev_b32 v250, 16, v53
v_and_b32 v251, 0xffff0000, v53
v_add_f32 v66, v66, v250
v_add_f32 v67, v67, v251
v_lshlrev_b32 v248, 16, v54
v_and_b32 v249, 0xffff0000, v54
v_add_f32 v68, v68, v248
v_add_f32 v69, v69, v249
v_lshlrev_b32 v250, 16, v55
v_and_b32 v251, 0xffff0000, v55
v_add_f32 v70, v70, v250
v_add_f32 v71, v71, v251
s_waitcnt vmcnt(1)
v_lshlrev_b32 v248, 16, v56
v_and_b32 v249, 0xffff0000, v56
v_add_f32 v64, v64, v248
v_add_f32 v65, v65, v249
v_lshlrev_b32 v250, 16, v57
v_and_b32 v251, 0xffff0000, v57
v_add_f32 v66, v66, v250
v_add_f32 v67, v67, v251
v_lshlrev_b32 v248, 16, v58
v_and_b32 v249, 0xffff0000, v58
v_add_f32 v68, v68, v248
v_add_f32 v69, v69, v249
v_lshlrev_b32 v250, 16, v59
v_and_b32 v251, 0xffff0000, v59
v_add_f32 v70, v70, v250
v_add_f32 v71, v71, v251
s_waitcnt vmcnt(0)
v_lshlrev_b32 v248, 16, v60
v_and_b32 v249, 0xffff0000, v60
v_add_f32 v64, v64, v248
v_add_f32 v65, v65, v249
v_lshlrev_b32 v250, 16, v61
v_and_b32 v251, 0xffff0000, v61
v_add_f32 v66, v66, v250
v_add_f32 v67, v67, v251
v_lshlrev_b32 v248, 16, v62
v_and_b32 v249, 0xffff0000, v62
v_add_f32 v68, v68, v248
v_add_f32 v69, v69, v249
v_lshlrev_b32 v250, 16, v63
v_and_b32 v251, 0xffff0000, v63
v_add_f32 v70, v70, v250
v_add_f32 v71, v71, v251
v_cvt_pk_bf16_f32 v16, v64, v65
v_cvt_pk_bf16_f32 v17, v66, v67
v_cvt_pk_bf16_f32 v18, v68, v69
v_cvt_pk_bf16_f32 v19, v70, v71
buffer_store_dwordx4 v[16:19], v24, s[64:67], s73 offen
s_nop 1
L_f2_done:
L_main_end:
s_endpgm
L_code_end:
.section .rodata,"a"
.p2align 6
.amdhsa_kernel parallel_sum__sliding_block__dense_activation_gelu__prompt_kernel
  .amdhsa_next_free_vgpr 256
  .amdhsa_next_free_sgpr 102
  .amdhsa_accum_offset 256
  .amdhsa_group_segment_fixed_size 0
  .amdhsa_kernarg_size 88
  .amdhsa_user_sgpr_count 2
  .amdhsa_user_sgpr_kernarg_segment_ptr 1
  .amdhsa_system_sgpr_workgroup_id_x 1
.end_amdhsa_kernel
```
